```python
import torch

def _softmax(x, axis=-1):
    return torch.softmax(x, dim=axis)
def _gelu(x):
    return torch.nn.functional.gelu(x, approximate="tanh")
def _silu(x):
    return torch.nn.functional.silu(x)
def _sigmoid(x):
    return torch.sigmoid(x)
def _layernorm(x, axis=-1, eps=1e-5):
    m = x.mean(dim=axis, keepdim=True)
    v = x.var(dim=axis, keepdim=True, unbiased=False)
    return (x - m) / torch.sqrt(v + eps)
def _scatter_add(tgt, idx, src, axis=0):
    return tgt.clone().index_add_(axis, idx, src)
def _segment_sum(src, seg, n):
    out = torch.zeros((n,) + src.shape[1:], dtype=src.dtype)
    return out.index_add_(0, seg, src)
def _pad(x, pw):
    flat = tuple(v for pair in reversed(pw) for v in pair)
    return torch.nn.functional.pad(x, flat)

kernel_name = 'recurrent_scan__softmax_full_mha__mixer_channel_mlp__prompt'

def setup_inputs():

    _w = (lambda a: (lambda t: t.to(torch.bfloat16) if t.is_floating_point() else t)(torch.as_tensor(a)))
    def _A_setup():
        B, S, D = 1, 2048, 512
        return {
            "x": _w((lambda *s: torch.randn(*s, dtype=torch.bfloat16) * 0.05)(B, S, D)),
            "wqkv": _w((lambda *s: torch.randn(*s, dtype=torch.bfloat16) * 0.1)(D, 3 * D)),
            "wo": _w((lambda *s: torch.randn(*s, dtype=torch.bfloat16) * 0.05)(D, D)),
        }
    _A_in = _A_setup()

    def _B_setup():
        B, S, D, F = 1, 2048, 512, 1792
        return {
            "x": _w((lambda *s: torch.randn(*s, dtype=torch.bfloat16) * 0.05)(B, S, D)),
            "w1": _w((lambda *s: torch.randn(*s, dtype=torch.bfloat16) * 3.2)(D, F) * (D ** -0.5)),
            "b1": _w((lambda *s: torch.randn(*s, dtype=torch.bfloat16) * 1.6)(F)),
            "w2": _w((lambda *s: torch.randn(*s, dtype=torch.bfloat16) * 0.8)(F, D) * (F ** -0.5)),
            "b2": _w((lambda *s: torch.randn(*s, dtype=torch.bfloat16) * 0.8)(D)),
        }
    _B_in = _B_setup()

    return {
        "A_x": _A_in["x"],
        "A_wqkv": _A_in["wqkv"],
        "A_wo": _A_in["wo"],
        "B_x": _B_in["x"],
        "B_w1": _B_in["w1"],
        "B_b1": _B_in["b1"],
        "B_w2": _B_in["w2"],
        "B_b2": _B_in["b2"],
    }

def reference(A_x, A_wqkv, A_wo, B_x, B_w1, B_b1, B_w2, B_b2):
    def _A_ref(x, wqkv, wo):
        B, S, D = x.shape
        H = 32; Dh = D // H
        qkv = (lambda x, *d: x.permute(*d))((x @ wqkv).reshape(B, S, 3, H, Dh), 2, 0, 3, 1, 4)
        q, k, v = qkv[0], qkv[1], qkv[2]
        scale = Dh ** -0.5
        scores = torch.einsum("bhqd,bhkd->bhqk", q, k) * scale
        p = _softmax(scores, axis=-1)
        o = torch.einsum("bhqk,bhkd->bhqd", p, v)
        return (lambda x, *d: x.permute(*d))(o, 0, 2, 1, 3).reshape(B, S, D) @ wo

    def _B_ref(x, w1, b1, w2, b2):
        y = _layernorm(x, axis=-1)
        h = _gelu(torch.einsum("bsd,df->bsf", y, w1) + b1)
        return torch.einsum("bsf,fd->bsd", h, w2) + b2

    x = A_x
    xn = _layernorm(x, axis=-1)
    s = _A_ref(xn, A_wqkv, A_wo)
    g = _silu(_B_ref(xn, B_w1, B_b1, B_w2, B_b2))
    return x + s * g
```

```asm
; @launch grid=(256,1,1) block=(512,1,1) lds=163840
.amdgcn_target "amdgcn-amd-amdhsa--gfx950"
.text
.globl recurrent_scan__softmax_full_mha__mixer_channel_mlp__prompt_kernel
.p2align 8
.type recurrent_scan__softmax_full_mha__mixer_channel_mlp__prompt_kernel,@function
recurrent_scan__softmax_full_mha__mixer_channel_mlp__prompt_kernel:
  s_load_dwordx16 s[68:83], s[0:1], 0
  s_load_dwordx4 s[84:87], s[0:1], 64
  s_load_dwordx2 s[88:89], s[0:1], 80
  s_cmp_ge_u32 s2, 256
s_cbranch_scc1 recurrent_scan__softmax_full_mha__mixer_channel_mlp__prompt_kernel_end
  v_lshrrev_b32 v1, 6, v0
  v_and_b32 v0, 63, v0
  v_readfirstlane_b32 s44, v1
  s_and_b32 s47, s2, 7
  s_lshr_b32 s48, s2, 3
s_nop 1
  s_and_b32 s45, s44, 3
  s_lshr_b32 s46, s44, 2
  s_mov_b32 s6, 0x200000
  s_mov_b32 s7, 0x20000
  s_mov_b32 s10, 0x180000
  s_mov_b32 s11, 0x20000
  s_and_b32 s52, s47, 1
  s_lshl_b32 s52, s52, 3
  s_and_b32 s53, s48, 7
  s_add_u32 s49, s52, s53
  s_lshr_b32 s52, s47, 1
  s_lshl_b32 s52, s52, 2
  s_lshr_b32 s53, s48, 3
  s_add_u32 s50, s52, s53
  s_xor_b32 s50, s50, 0
  s_mul_i32 s52, s50, 7
  s_and_b32 s53, s50, 1
  s_add_u32 s52, s52, s53
  s_lshr_b32 s51, s52, 1
  s_and_b32 s53, s53, s46
  s_lshl_b32 s53, s53, 6
  s_sub_u32 s64, 64, s53
  s_lshl_b32 s65, s49, 2
  s_add_u32 s65, s65, s45
  s_mov_b32 s60, 0xffff0000
  s_lshl_b32 s61, s44, 11
  s_lshl_b32 s62, s45, 10
  s_add_u32 s62, s62, 81920
  s_lshl_b32 s63, s46, 13
  s_lshl_b32 s52, s45, 11
  s_add_u32 s63, s63, s52
  v_lshrrev_b32 v1, 3, v0
  v_lshrrev_b32 v2, 4, v0
  v_and_b32 v3, 7, v0
  v_xor_b32 v2, v2, v3
  s_lshl_b32 s52, s49, 7
  s_lshl_b32 s53, s44, 4
  s_add_u32 s52, s52, s53
  v_add_u32 v1, s52, v1
  v_lshlrev_b32 v1, 10, v1
  v_lshlrev_b32 v2, 4, v2
  v_add_u32 v4, v1, v2
  v_xor_b32 v2, 64, v2
  v_add_u32 v1, 0x2000, v1
  v_add_u32 v5, v1, v2
  v_lshrrev_b32 v1, 2, v0
  v_and_b32 v2, 3, v0
  v_lshlrev_b32 v2, 4, v2
  s_lshl_b32 s52, s45, 4
  v_add_u32 v3, s52, v1
  v_mul_u32_u24 v3, 0xc00, v3
  s_lshl_b32 s52, s50, 6
  s_sub_u32 s53, 1, s46
  s_lshl_b32 s53, s53, 11
  s_add_u32 s52, s52, s53
  v_add3_u32 v6, v3, v2, s52
  s_and_b32 s52, s45, 1
  s_lshl_b32 s52, s52, 5
  v_add_u32 v3, s52, v1
  v_mul_u32_u24 v3, 0xe00, v3
  s_lshl_b32 s52, s46, 1
  s_add_u32 s52, s52, s51
  s_lshl_b32 s52, s52, 6
  v_add3_u32 v7, v3, v2, s52
  s_lshr_b32 s93, s48, 3
  s_mul_i32 s93, s93, 3
  s_add_u32 s93, s93, s49
  s_and_b32 s93, s93, 7
  s_lshr_b32 s98, s45, 1
  s_add_u32 s98, s98, s93
  s_mov_b32 s14, 0x1c0000
  s_mov_b32 s15, 0x20000
  s_mov_b32 s18, 0x1400000
  s_mov_b32 s19, 0x20000
  s_mov_b32 s22, 0x1c0000
  s_mov_b32 s23, 0x20000
  s_mov_b32 s26, 0x80000
  s_mov_b32 s27, 0x20000
  s_mov_b32 s30, 0xe00
  s_mov_b32 s31, 0x20000
  s_mov_b32 s34, 0x400
  s_mov_b32 s35, 0x20000
  s_mov_b32 s38, 0x200000
  s_mov_b32 s39, 0x20000
  s_mov_b32 s42, 0x100
  s_mov_b32 s43, 0x20000
  s_waitcnt lgkmcnt(0)
  s_mov_b32 s4, s68
  s_mov_b32 s5, s69
  s_mov_b32 s8, s70
  s_mov_b32 s9, s71
  s_cmp_eq_u32 s46, 1
s_cbranch_scc1 recurrent_scan__softmax_full_mha__mixer_channel_mlp__prompt_kernel_g1
  s_add_u32 s58, s93, 0
  s_and_b32 s58, s58, 7
  s_lshl_b32 s57, s58, 7
  s_mul_i32 s58, s58, 196608
  s_add_u32 m0, s61, 0
s_nop 0
  buffer_load_dwordx4 v4, s[4:7], s57 offen lds
  s_add_u32 m0, s61, 1024
s_nop 0
  buffer_load_dwordx4 v5, s[4:7], s57 offen lds
  s_add_u32 m0, s62, 8192
s_nop 0
  buffer_load_dwordx4 v6, s[8:11], s58 offen lds
  s_mov_b32 s16, s88
  s_mov_b32 s17, s89
  s_mov_b32 s40, s86
  s_mov_b32 s41, s87
  s_mov_b32 s12, s76
  s_mov_b32 s13, s77
  s_mov_b32 s20, s80
  s_mov_b32 s21, s81
  s_mov_b32 s24, s72
  s_mov_b32 s25, s73
  s_mov_b32 s28, s78
  s_mov_b32 s29, s79
  s_mov_b32 s32, s82
  s_mov_b32 s33, s83
  s_mov_b32 s36, s84
  s_mov_b32 s37, s85
  v_mov_b32 v20, 0
  v_mov_b32 v21, 0
  v_mov_b32 v22, 0
  v_mov_b32 v23, 0
  v_mov_b32 v24, 163824
  ds_write_b32 v24, v20
  s_or_b32 s52, s2, s44
  s_cmp_lg_u32 s52, 0
s_cbranch_scc1 noinit_1
  v_lshrrev_b32 v1, 2, v0
  v_lshlrev_b32 v1, 8, v1
  v_and_b32 v2, 3, v0
  v_lshlrev_b32 v2, 4, v2
  v_add_u32 v1, v1, v2
  s_mov_b32 s52, 18874368
  s_mov_b32 s53, 18878464
  s_mov_b32 s54, 18882560
  buffer_store_dwordx4 v[20:23], v1, s[16:19], s52 offen sc1
  buffer_store_dwordx4 v[20:23], v1, s[16:19], s53 offen sc1
  buffer_store_dwordx4 v[20:23], v1, s[16:19], s54 offen sc1
s_nop 1
noinit_1:
  v_and_b32 v1, 31, v0
  v_lshrrev_b32 v2, 5, v0
  v_bfe_u32 v3, v0, 1, 3
  v_xor_b32 v2, v2, v3
  v_lshlrev_b32 v2, 4, v2
  s_lshl_b32 s52, s45, 5
  v_add_u32 v1, s52, v1
  v_lshlrev_b32 v1, 7, v1
  s_xor_b32 s52, s45, 0
  s_lshl_b32 s52, s52, 5
  v_xor_b32 v3, s52, v2
  v_add_u32 v8, v1, v3
  s_xor_b32 s52, s45, 1
  s_lshl_b32 s52, s52, 5
  v_xor_b32 v3, s52, v2
  v_add_u32 v9, v1, v3
  s_xor_b32 s52, s45, 2
  s_lshl_b32 s52, s52, 5
  v_xor_b32 v3, s52, v2
  v_add_u32 v10, v1, v3
  s_xor_b32 s52, s45, 3
  s_lshl_b32 s52, s52, 5
  v_xor_b32 v3, s52, v2
  v_add_u32 v11, v1, v3
  v_lshrrev_b32 v1, 5, v0
  v_lshlrev_b32 v1, 9, v1
  v_bfe_u32 v2, v0, 2, 2
  v_lshlrev_b32 v2, 6, v2
  v_add_u32 v1, v1, v2
  v_bfe_u32 v2, v0, 4, 1
  v_lshlrev_b32 v2, 5, v2
  v_add_u32 v1, v1, v2
  v_and_b32 v2, 1, v0
  v_lshlrev_b32 v2, 4, v2
  v_add_u32 v1, v1, v2
  v_and_b32 v2, 2, v0
  v_lshlrev_b32 v2, 2, v2
  v_add_u32 v1, v1, v2
  s_xor_b32 s52, s45, 0
  s_lshl_b32 s52, s52, 10
  s_add_u32 s52, s52, 81920
  v_add_u32 v12, s52, v1
  s_xor_b32 s52, s45, 1
  s_lshl_b32 s52, s52, 10
  s_add_u32 s52, s52, 81920
  v_add_u32 v13, s52, v1
  s_xor_b32 s52, s45, 2
  s_lshl_b32 s52, s52, 10
  s_add_u32 s52, s52, 81920
  v_add_u32 v14, s52, v1
  s_xor_b32 s52, s45, 3
  s_lshl_b32 s52, s52, 10
  s_add_u32 s52, s52, 81920
  v_add_u32 v15, s52, v1
  v_and_b32 v1, 15, v0
  v_bfe_u32 v2, v0, 4, 1
  v_cmp_eq_u32 vcc, v1, v2
  v_mov_b32 v1, 0x3f803f80
s_nop 0
  v_cndmask_b32 v40, 0, v1, vcc
  v_cndmask_b32 v41, 0, v1, vcc
  v_cndmask_b32 v42, 0, v1, vcc
  v_cndmask_b32 v43, 0, v1, vcc
  v_mov_b32 v16, 0
  v_mov_b32 v17, 0
  v_mov_b32 v18, 0
  v_mov_b32 v19, 0
  v_lshlrev_b32 v1, 4, v0
  v_and_b32 v18, 15, v0
  v_lshlrev_b32 v19, 6, v18
  v_lshlrev_b32 v18, 8, v18
  v_lshrrev_b32 v2, 4, v0
  v_lshlrev_b32 v3, 6, v2
  s_lshl_b32 s52, s45, 2
  s_add_u32 s52, s52, 147456
  v_add3_u32 v18, v18, v3, s52
  v_lshlrev_b32 v3, 4, v2
  s_lshl_b32 s52, s45, 7
  s_add_u32 s52, s52, 145408
  v_add3_u32 v19, v19, v3, s52
  s_mov_b32 s96, 0x00030003
  s_mov_b32 s97, 0x00030003
  s_add_u32 s58, s93, 1
  s_and_b32 s58, s58, 7
  s_lshl_b32 s57, s58, 7
  s_mul_i32 s58, s58, 196608
  s_add_u32 m0, s61, 16384
s_nop 0
  buffer_load_dwordx4 v4, s[4:7], s57 offen lds
  s_add_u32 m0, s61, 17408
s_nop 0
  buffer_load_dwordx4 v5, s[4:7], s57 offen lds
  s_add_u32 m0, s62, 20480
s_nop 0
  buffer_load_dwordx4 v6, s[8:11], s58 offen lds
  s_add_u32 s58, s93, 2
  s_and_b32 s58, s58, 7
  s_lshl_b32 s57, s58, 7
  s_mul_i32 s58, s58, 196608
  s_add_u32 m0, s61, 32768
s_nop 0
  buffer_load_dwordx4 v4, s[4:7], s57 offen lds
  s_add_u32 m0, s61, 33792
s_nop 0
  buffer_load_dwordx4 v5, s[4:7], s57 offen lds
  s_add_u32 m0, s62, 32768
s_nop 0
  buffer_load_dwordx4 v6, s[8:11], s58 offen lds
  s_waitcnt vmcnt(6)
  s_barrier
  s_or_b32 s52, s2, s44
  s_cmp_lg_u32 s52, 0
s_cbranch_scc1 noinit2_2
  s_mov_b64 exec, 1
  v_mov_b32 v20, 1
  buffer_store_dword v20, off, s[40:43], 0 sc1
  s_mov_b64 exec, -1
noinit2_2:
  ds_read_b128 v[128:131], v8 offset:0
  ds_read_b64_tr_b16 v[96:97], v12 offset:0
  ds_read_b64_tr_b16 v[98:99], v12 offset:256
  ds_read_b64_tr_b16 v[100:101], v12 offset:4096
  ds_read_b64_tr_b16 v[102:103], v12 offset:4352
  ds_read_b128 v[132:135], v9 offset:0
  ds_read_b64_tr_b16 v[104:105], v13 offset:0
  ds_read_b64_tr_b16 v[106:107], v13 offset:256
  ds_read_b64_tr_b16 v[108:109], v13 offset:4096
  ds_read_b64_tr_b16 v[110:111], v13 offset:4352
  s_waitcnt lgkmcnt(5)
  v_mfma_f32_32x32x16_bf16 v[64:79], v[96:99], v[128:131], 0
  ds_read_b128 v[136:139], v10 offset:0
  ds_read_b64_tr_b16 v[112:113], v14 offset:0
  ds_read_b64_tr_b16 v[114:115], v14 offset:256
  v_and_b32 v20, s60, v128
  v_lshlrev_b32 v21, 16, v128
  v_fmac_f32 v16, v20, v20
  v_fmac_f32 v17, v21, v21
  v_mfma_f32_32x32x16_bf16 v[80:95], v[100:103], v[128:131], 0
  ds_read_b64_tr_b16 v[116:117], v14 offset:4096
  ds_read_b64_tr_b16 v[118:119], v14 offset:4352
  v_and_b32 v22, s60, v129
  v_lshlrev_b32 v23, 16, v129
  v_fmac_f32 v16, v22, v22
  v_fmac_f32 v17, v23, v23
  v_mfma_f32_16x16x32_bf16 v[24:27], v[96:99], v[40:43], 0
  s_add_u32 s58, s93, 3
  s_and_b32 s58, s58, 7
  s_lshl_b32 s57, s58, 7
  s_mul_i32 s58, s58, 196608
  s_add_u32 m0, s61, 49152
s_nop 0
  buffer_load_dwordx4 v4, s[4:7], s57 offen lds
  s_add_u32 m0, s61, 50176
s_nop 0
  buffer_load_dwordx4 v5, s[4:7], s57 offen lds
  v_mfma_f32_16x16x32_bf16 v[28:31], v[100:103], v[40:43], 0
  ds_read_b128 v[140:143], v11 offset:0
  ds_read_b64_tr_b16 v[120:121], v15 offset:0
  ds_read_b64_tr_b16 v[122:123], v15 offset:256
  s_waitcnt lgkmcnt(8)
  v_mfma_f32_32x32x16_bf16 v[64:79], v[104:107], v[132:135], v[64:79]
  ds_read_b64_tr_b16 v[124:125], v15 offset:4096
  ds_read_b64_tr_b16 v[126:127], v15 offset:4352
  v_and_b32 v20, s60, v132
  v_lshlrev_b32 v21, 16, v132
  v_fmac_f32 v16, v20, v20
  v_fmac_f32 v17, v21, v21
  v_mfma_f32_32x32x16_bf16 v[80:95], v[108:111], v[132:135], v[80:95]
  s_add_u32 m0, s62, 45056
s_nop 0
  buffer_load_dwordx4 v6, s[8:11], s58 offen lds
  v_and_b32 v22, s60, v133
  v_lshlrev_b32 v23, 16, v133
  v_fmac_f32 v16, v22, v22
  v_fmac_f32 v17, v23, v23
  s_waitcnt vmcnt(6)
  s_barrier
  s_waitcnt lgkmcnt(5)
  v_mfma_f32_32x32x16_bf16 v[64:79], v[112:115], v[136:139], v[64:79]
  ds_read_b128 v[144:147], v8 offset:16384
  ds_read_b64_tr_b16 v[96:97], v12 offset:12288
  ds_read_b64_tr_b16 v[98:99], v12 offset:12544
  v_and_b32 v20, s60, v136
  v_lshlrev_b32 v21, 16, v136
  v_fmac_f32 v16, v20, v20
  v_fmac_f32 v17, v21, v21
  v_mfma_f32_32x32x16_bf16 v[80:95], v[116:119], v[136:139], v[80:95]
  ds_read_b64_tr_b16 v[100:101], v12 offset:16384
  ds_read_b64_tr_b16 v[102:103], v12 offset:16640
  v_and_b32 v22, s60, v137
  v_lshlrev_b32 v23, 16, v137
  v_fmac_f32 v16, v22, v22
  v_fmac_f32 v17, v23, v23
  s_waitcnt lgkmcnt(5)
  v_mfma_f32_32x32x16_bf16 v[64:79], v[120:123], v[140:143], v[64:79]
  ds_read_b128 v[148:151], v9 offset:16384
  ds_read_b64_tr_b16 v[104:105], v13 offset:12288
  ds_read_b64_tr_b16 v[106:107], v13 offset:12544
  v_and_b32 v20, s60, v140
  v_lshlrev_b32 v21, 16, v140
  v_fmac_f32 v16, v20, v20
  v_fmac_f32 v17, v21, v21
  v_mfma_f32_32x32x16_bf16 v[80:95], v[124:127], v[140:143], v[80:95]
  ds_read_b64_tr_b16 v[108:109], v13 offset:16384
  ds_read_b64_tr_b16 v[110:111], v13 offset:16640
  v_and_b32 v22, s60, v141
  v_lshlrev_b32 v23, 16, v141
  v_fmac_f32 v16, v22, v22
  v_fmac_f32 v17, v23, v23
  s_waitcnt lgkmcnt(5)
  v_mfma_f32_32x32x16_bf16 v[64:79], v[96:99], v[144:147], v[64:79]
  ds_read_b128 v[152:155], v10 offset:16384
  ds_read_b64_tr_b16 v[112:113], v14 offset:12288
  ds_read_b64_tr_b16 v[114:115], v14 offset:12544
  v_and_b32 v20, s60, v144
  v_lshlrev_b32 v21, 16, v144
  v_fmac_f32 v16, v20, v20
  v_fmac_f32 v17, v21, v21
  v_mfma_f32_32x32x16_bf16 v[80:95], v[100:103], v[144:147], v[80:95]
  ds_read_b64_tr_b16 v[116:117], v14 offset:16384
  ds_read_b64_tr_b16 v[118:119], v14 offset:16640
  v_and_b32 v22, s60, v145
  v_lshlrev_b32 v23, 16, v145
  v_fmac_f32 v16, v22, v22
  v_fmac_f32 v17, v23, v23
  v_mfma_f32_16x16x32_bf16 v[24:27], v[96:99], v[40:43], v[24:27]
  s_add_u32 s58, s93, 4
  s_and_b32 s58, s58, 7
  s_lshl_b32 s57, s58, 7
  s_mul_i32 s58, s58, 196608
  s_add_u32 m0, s61, 65536
s_nop 0
  buffer_load_dwordx4 v4, s[4:7], s57 offen lds
  s_add_u32 m0, s61, 66560
s_nop 0
  buffer_load_dwordx4 v5, s[4:7], s57 offen lds
  v_mfma_f32_16x16x32_bf16 v[28:31], v[100:103], v[40:43], v[28:31]
  ds_read_b128 v[156:159], v11 offset:16384
  ds_read_b64_tr_b16 v[120:121], v15 offset:12288
  ds_read_b64_tr_b16 v[122:123], v15 offset:12544
  s_waitcnt lgkmcnt(8)
  v_mfma_f32_32x32x16_bf16 v[64:79], v[104:107], v[148:151], v[64:79]
  ds_read_b64_tr_b16 v[124:125], v15 offset:16384
  ds_read_b64_tr_b16 v[126:127], v15 offset:16640
  v_and_b32 v20, s60, v148
  v_lshlrev_b32 v21, 16, v148
  v_fmac_f32 v16, v20, v20
  v_fmac_f32 v17, v21, v21
  v_mfma_f32_32x32x16_bf16 v[80:95], v[108:111], v[148:151], v[80:95]
  s_add_u32 m0, s62, 57344
s_nop 0
  buffer_load_dwordx4 v6, s[8:11], s58 offen lds
  v_and_b32 v22, s60, v149
  v_lshlrev_b32 v23, 16, v149
  v_fmac_f32 v16, v22, v22
  v_fmac_f32 v17, v23, v23
  s_waitcnt vmcnt(6)
  s_barrier
  s_waitcnt lgkmcnt(5)
  v_mfma_f32_32x32x16_bf16 v[64:79], v[112:115], v[152:155], v[64:79]
  ds_read_b128 v[160:163], v8 offset:32768
  ds_read_b64_tr_b16 v[96:97], v12 offset:24576
  ds_read_b64_tr_b16 v[98:99], v12 offset:24832
  v_and_b32 v20, s60, v152
  v_lshlrev_b32 v21, 16, v152
  v_fmac_f32 v16, v20, v20
  v_fmac_f32 v17, v21, v21
  v_mfma_f32_32x32x16_bf16 v[80:95], v[116:119], v[152:155], v[80:95]
  ds_read_b64_tr_b16 v[100:101], v12 offset:28672
  ds_read_b64_tr_b16 v[102:103], v12 offset:28928
  v_and_b32 v22, s60, v153
  v_lshlrev_b32 v23, 16, v153
  v_fmac_f32 v16, v22, v22
  v_fmac_f32 v17, v23, v23
  s_waitcnt lgkmcnt(5)
  v_mfma_f32_32x32x16_bf16 v[64:79], v[120:123], v[156:159], v[64:79]
  ds_read_b128 v[164:167], v9 offset:32768
  ds_read_b64_tr_b16 v[104:105], v13 offset:24576
  ds_read_b64_tr_b16 v[106:107], v13 offset:24832
  v_and_b32 v20, s60, v156
  v_lshlrev_b32 v21, 16, v156
  v_fmac_f32 v16, v20, v20
  v_fmac_f32 v17, v21, v21
  v_mfma_f32_32x32x16_bf16 v[80:95], v[124:127], v[156:159], v[80:95]
  ds_read_b64_tr_b16 v[108:109], v13 offset:28672
  ds_read_b64_tr_b16 v[110:111], v13 offset:28928
  v_and_b32 v22, s60, v157
  v_lshlrev_b32 v23, 16, v157
  v_fmac_f32 v16, v22, v22
  v_fmac_f32 v17, v23, v23
  s_waitcnt lgkmcnt(5)
  v_mfma_f32_32x32x16_bf16 v[64:79], v[96:99], v[160:163], v[64:79]
  ds_read_b128 v[168:171], v10 offset:32768
  ds_read_b64_tr_b16 v[112:113], v14 offset:24576
  ds_read_b64_tr_b16 v[114:115], v14 offset:24832
  v_and_b32 v20, s60, v160
  v_lshlrev_b32 v21, 16, v160
  v_fmac_f32 v16, v20, v20
  v_fmac_f32 v17, v21, v21
  v_mfma_f32_32x32x16_bf16 v[80:95], v[100:103], v[160:163], v[80:95]
  ds_read_b64_tr_b16 v[116:117], v14 offset:28672
  ds_read_b64_tr_b16 v[118:119], v14 offset:28928
  v_and_b32 v22, s60, v161
  v_lshlrev_b32 v23, 16, v161
  v_fmac_f32 v16, v22, v22
  v_fmac_f32 v17, v23, v23
  v_mfma_f32_16x16x32_bf16 v[24:27], v[96:99], v[40:43], v[24:27]
  s_add_u32 s58, s93, 5
  s_and_b32 s58, s58, 7
  s_lshl_b32 s57, s58, 7
  s_mul_i32 s58, s58, 196608
  s_add_u32 m0, s61, 0
s_nop 0
  buffer_load_dwordx4 v4, s[4:7], s57 offen lds
  s_add_u32 m0, s61, 1024
s_nop 0
  buffer_load_dwordx4 v5, s[4:7], s57 offen lds
  v_mfma_f32_16x16x32_bf16 v[28:31], v[100:103], v[40:43], v[28:31]
  ds_read_b128 v[172:175], v11 offset:32768
  ds_read_b64_tr_b16 v[120:121], v15 offset:24576
  ds_read_b64_tr_b16 v[122:123], v15 offset:24832
  s_waitcnt lgkmcnt(8)
  v_mfma_f32_32x32x16_bf16 v[64:79], v[104:107], v[164:167], v[64:79]
  ds_read_b64_tr_b16 v[124:125], v15 offset:28672
  ds_read_b64_tr_b16 v[126:127], v15 offset:28928
  v_and_b32 v20, s60, v164
  v_lshlrev_b32 v21, 16, v164
  v_fmac_f32 v16, v20, v20
  v_fmac_f32 v17, v21, v21
  v_mfma_f32_32x32x16_bf16 v[80:95], v[108:111], v[164:167], v[80:95]
  s_add_u32 m0, s62, 8192
s_nop 0
  buffer_load_dwordx4 v6, s[8:11], s58 offen lds
  v_and_b32 v22, s60, v165
  v_lshlrev_b32 v23, 16, v165
  v_fmac_f32 v16, v22, v22
  v_fmac_f32 v17, v23, v23
  s_waitcnt vmcnt(6)
  s_barrier
  s_waitcnt lgkmcnt(5)
  v_mfma_f32_32x32x16_bf16 v[64:79], v[112:115], v[168:171], v[64:79]
  ds_read_b128 v[176:179], v8 offset:49152
  ds_read_b64_tr_b16 v[96:97], v12 offset:36864
  ds_read_b64_tr_b16 v[98:99], v12 offset:37120
  v_and_b32 v20, s60, v168
  v_lshlrev_b32 v21, 16, v168
  v_fmac_f32 v16, v20, v20
  v_fmac_f32 v17, v21, v21
  v_mfma_f32_32x32x16_bf16 v[80:95], v[116:119], v[168:171], v[80:95]
  ds_read_b64_tr_b16 v[100:101], v12 offset:40960
  ds_read_b64_tr_b16 v[102:103], v12 offset:41216
  v_and_b32 v22, s60, v169
  v_lshlrev_b32 v23, 16, v169
  v_fmac_f32 v16, v22, v22
  v_fmac_f32 v17, v23, v23
  s_waitcnt lgkmcnt(5)
  v_mfma_f32_32x32x16_bf16 v[64:79], v[120:123], v[172:175], v[64:79]
  ds_read_b128 v[180:183], v9 offset:49152
  ds_read_b64_tr_b16 v[104:105], v13 offset:36864
  ds_read_b64_tr_b16 v[106:107], v13 offset:37120
  v_and_b32 v20, s60, v172
  v_lshlrev_b32 v21, 16, v172
  v_fmac_f32 v16, v20, v20
  v_fmac_f32 v17, v21, v21
  v_mfma_f32_32x32x16_bf16 v[80:95], v[124:127], v[172:175], v[80:95]
  ds_read_b64_tr_b16 v[108:109], v13 offset:40960
  ds_read_b64_tr_b16 v[110:111], v13 offset:41216
  v_and_b32 v22, s60, v173
  v_lshlrev_b32 v23, 16, v173
  v_fmac_f32 v16, v22, v22
  v_fmac_f32 v17, v23, v23
  s_waitcnt lgkmcnt(5)
  v_mfma_f32_32x32x16_bf16 v[64:79], v[96:99], v[176:179], v[64:79]
  ds_read_b128 v[184:187], v10 offset:49152
  ds_read_b64_tr_b16 v[112:113], v14 offset:36864
  ds_read_b64_tr_b16 v[114:115], v14 offset:37120
  v_and_b32 v20, s60, v176
  v_lshlrev_b32 v21, 16, v176
  v_fmac_f32 v16, v20, v20
  v_fmac_f32 v17, v21, v21
  v_mfma_f32_32x32x16_bf16 v[80:95], v[100:103], v[176:179], v[80:95]
  ds_read_b64_tr_b16 v[116:117], v14 offset:40960
  ds_read_b64_tr_b16 v[118:119], v14 offset:41216
  v_and_b32 v22, s60, v177
  v_lshlrev_b32 v23, 16, v177
  v_fmac_f32 v16, v22, v22
  v_fmac_f32 v17, v23, v23
  v_mfma_f32_16x16x32_bf16 v[24:27], v[96:99], v[40:43], v[24:27]
  s_add_u32 s58, s93, 6
  s_and_b32 s58, s58, 7
  s_lshl_b32 s57, s58, 7
  s_mul_i32 s58, s58, 196608
  s_add_u32 m0, s61, 16384
s_nop 0
  buffer_load_dwordx4 v4, s[4:7], s57 offen lds
  s_add_u32 m0, s61, 17408
s_nop 0
  buffer_load_dwordx4 v5, s[4:7], s57 offen lds
  v_mfma_f32_16x16x32_bf16 v[28:31], v[100:103], v[40:43], v[28:31]
  ds_read_b128 v[188:191], v11 offset:49152
  ds_read_b64_tr_b16 v[120:121], v15 offset:36864
  ds_read_b64_tr_b16 v[122:123], v15 offset:37120
  s_waitcnt lgkmcnt(8)
  v_mfma_f32_32x32x16_bf16 v[64:79], v[104:107], v[180:183], v[64:79]
  ds_read_b64_tr_b16 v[124:125], v15 offset:40960
  ds_read_b64_tr_b16 v[126:127], v15 offset:41216
  v_and_b32 v20, s60, v180
  v_lshlrev_b32 v21, 16, v180
  v_fmac_f32 v16, v20, v20
  v_fmac_f32 v17, v21, v21
  v_mfma_f32_32x32x16_bf16 v[80:95], v[108:111], v[180:183], v[80:95]
  s_add_u32 m0, s62, 20480
s_nop 0
  buffer_load_dwordx4 v6, s[8:11], s58 offen lds
  v_and_b32 v22, s60, v181
  v_lshlrev_b32 v23, 16, v181
  v_fmac_f32 v16, v22, v22
  v_fmac_f32 v17, v23, v23
  s_waitcnt vmcnt(6)
  s_barrier
  v_add_u32 v8, 0x10000, v8
  v_add_u32 v9, 0x10000, v9
  v_add_u32 v10, 0x10000, v10
  v_add_u32 v11, 0x10000, v11
  s_waitcnt lgkmcnt(5)
  v_mfma_f32_32x32x16_bf16 v[64:79], v[112:115], v[184:187], v[64:79]
  ds_read_b128 v[192:195], v8 offset:0
  ds_read_b64_tr_b16 v[96:97], v12 offset:49152
  ds_read_b64_tr_b16 v[98:99], v12 offset:49408
  v_and_b32 v20, s60, v184
  v_lshlrev_b32 v21, 16, v184
  v_fmac_f32 v16, v20, v20
  v_fmac_f32 v17, v21, v21
  v_mfma_f32_32x32x16_bf16 v[80:95], v[116:119], v[184:187], v[80:95]
  ds_read_b64_tr_b16 v[100:101], v12 offset:53248
  ds_read_b64_tr_b16 v[102:103], v12 offset:53504
  v_and_b32 v22, s60, v185
  v_lshlrev_b32 v23, 16, v185
  v_fmac_f32 v16, v22, v22
  v_fmac_f32 v17, v23, v23
  s_waitcnt lgkmcnt(5)
  v_mfma_f32_32x32x16_bf16 v[64:79], v[120:123], v[188:191], v[64:79]
  ds_read_b128 v[196:199], v9 offset:0
  ds_read_b64_tr_b16 v[104:105], v13 offset:49152
  ds_read_b64_tr_b16 v[106:107], v13 offset:49408
  v_and_b32 v20, s60, v188
  v_lshlrev_b32 v21, 16, v188
  v_fmac_f32 v16, v20, v20
  v_fmac_f32 v17, v21, v21
  v_mfma_f32_32x32x16_bf16 v[80:95], v[124:127], v[188:191], v[80:95]
  ds_read_b64_tr_b16 v[108:109], v13 offset:53248
  ds_read_b64_tr_b16 v[110:111], v13 offset:53504
  v_and_b32 v22, s60, v189
  v_lshlrev_b32 v23, 16, v189
  v_fmac_f32 v16, v22, v22
  v_fmac_f32 v17, v23, v23
  s_waitcnt lgkmcnt(5)
  v_mfma_f32_32x32x16_bf16 v[64:79], v[96:99], v[192:195], v[64:79]
  ds_read_b128 v[200:203], v10 offset:0
  ds_read_b64_tr_b16 v[112:113], v14 offset:49152
  ds_read_b64_tr_b16 v[114:115], v14 offset:49408
  v_and_b32 v20, s60, v192
  v_lshlrev_b32 v21, 16, v192
  v_fmac_f32 v16, v20, v20
  v_fmac_f32 v17, v21, v21
  v_mfma_f32_32x32x16_bf16 v[80:95], v[100:103], v[192:195], v[80:95]
  ds_read_b64_tr_b16 v[116:117], v14 offset:53248
  ds_read_b64_tr_b16 v[118:119], v14 offset:53504
  v_and_b32 v22, s60, v193
  v_lshlrev_b32 v23, 16, v193
  v_fmac_f32 v16, v22, v22
  v_fmac_f32 v17, v23, v23
  v_mfma_f32_16x16x32_bf16 v[24:27], v[96:99], v[40:43], v[24:27]
  s_add_u32 s58, s93, 7
  s_and_b32 s58, s58, 7
  s_lshl_b32 s57, s58, 7
  s_mul_i32 s58, s58, 196608
  s_add_u32 m0, s61, 32768
s_nop 0
  buffer_load_dwordx4 v4, s[4:7], s57 offen lds
  s_add_u32 m0, s61, 33792
s_nop 0
  buffer_load_dwordx4 v5, s[4:7], s57 offen lds
  v_mfma_f32_16x16x32_bf16 v[28:31], v[100:103], v[40:43], v[28:31]
  ds_read_b128 v[204:207], v11 offset:0
  ds_read_b64_tr_b16 v[120:121], v15 offset:49152
  ds_read_b64_tr_b16 v[122:123], v15 offset:49408
  s_waitcnt lgkmcnt(8)
  v_mfma_f32_32x32x16_bf16 v[64:79], v[104:107], v[196:199], v[64:79]
  ds_read_b64_tr_b16 v[124:125], v15 offset:53248
  ds_read_b64_tr_b16 v[126:127], v15 offset:53504
  v_and_b32 v20, s60, v196
  v_lshlrev_b32 v21, 16, v196
  v_fmac_f32 v16, v20, v20
  v_fmac_f32 v17, v21, v21
  v_mfma_f32_32x32x16_bf16 v[80:95], v[108:111], v[196:199], v[80:95]
  s_add_u32 m0, s62, 32768
s_nop 0
  buffer_load_dwordx4 v6, s[8:11], s58 offen lds
  v_and_b32 v22, s60, v197
  v_lshlrev_b32 v23, 16, v197
  v_fmac_f32 v16, v22, v22
  v_fmac_f32 v17, v23, v23
  s_waitcnt vmcnt(6)
  s_barrier
  v_subrev_u32 v8, 0x10000, v8
  v_subrev_u32 v9, 0x10000, v9
  v_subrev_u32 v10, 0x10000, v10
  v_subrev_u32 v11, 0x10000, v11
  s_waitcnt lgkmcnt(5)
  v_mfma_f32_32x32x16_bf16 v[64:79], v[112:115], v[200:203], v[64:79]
  ds_read_b128 v[208:211], v8 offset:0
  ds_read_b64_tr_b16 v[96:97], v12 offset:0
  ds_read_b64_tr_b16 v[98:99], v12 offset:256
  v_and_b32 v20, s60, v200
  v_lshlrev_b32 v21, 16, v200
  v_fmac_f32 v16, v20, v20
  v_fmac_f32 v17, v21, v21
  v_mfma_f32_32x32x16_bf16 v[80:95], v[116:119], v[200:203], v[80:95]
  ds_read_b64_tr_b16 v[100:101], v12 offset:4096
  ds_read_b64_tr_b16 v[102:103], v12 offset:4352
  v_and_b32 v22, s60, v201
  v_lshlrev_b32 v23, 16, v201
  v_fmac_f32 v16, v22, v22
  v_fmac_f32 v17, v23, v23
  s_waitcnt lgkmcnt(5)
  v_mfma_f32_32x32x16_bf16 v[64:79], v[120:123], v[204:207], v[64:79]
  ds_read_b128 v[212:215], v9 offset:0
  ds_read_b64_tr_b16 v[104:105], v13 offset:0
  ds_read_b64_tr_b16 v[106:107], v13 offset:256
  v_and_b32 v20, s60, v204
  v_lshlrev_b32 v21, 16, v204
  v_fmac_f32 v16, v20, v20
  v_fmac_f32 v17, v21, v21
  v_mfma_f32_32x32x16_bf16 v[80:95], v[124:127], v[204:207], v[80:95]
  ds_read_b64_tr_b16 v[108:109], v13 offset:4096
  ds_read_b64_tr_b16 v[110:111], v13 offset:4352
  v_and_b32 v22, s60, v205
  v_lshlrev_b32 v23, 16, v205
  v_fmac_f32 v16, v22, v22
  v_fmac_f32 v17, v23, v23
  s_waitcnt lgkmcnt(5)
  v_mfma_f32_32x32x16_bf16 v[64:79], v[96:99], v[208:211], v[64:79]
  ds_read_b128 v[216:219], v10 offset:0
  ds_read_b64_tr_b16 v[112:113], v14 offset:0
  ds_read_b64_tr_b16 v[114:115], v14 offset:256
  v_and_b32 v20, s60, v208
  v_lshlrev_b32 v21, 16, v208
  v_fmac_f32 v16, v20, v20
  v_fmac_f32 v17, v21, v21
  v_mfma_f32_32x32x16_bf16 v[80:95], v[100:103], v[208:211], v[80:95]
  ds_read_b64_tr_b16 v[116:117], v14 offset:4096
  ds_read_b64_tr_b16 v[118:119], v14 offset:4352
  v_and_b32 v22, s60, v209
  v_lshlrev_b32 v23, 16, v209
  v_fmac_f32 v16, v22, v22
  v_fmac_f32 v17, v23, v23
  v_mfma_f32_16x16x32_bf16 v[24:27], v[96:99], v[40:43], v[24:27]
  s_add_u32 m0, s63, 49152
  s_add_u32 s54, s98, 0
  s_and_b32 s54, s54, 7
  s_mul_i32 s54, s54, 229376
  buffer_load_dwordx4 v7, s[12:15], s54 offen lds
  v_mfma_f32_16x16x32_bf16 v[28:31], v[100:103], v[40:43], v[28:31]
  ds_read_b128 v[220:223], v11 offset:0
  ds_read_b64_tr_b16 v[120:121], v15 offset:0
  ds_read_b64_tr_b16 v[122:123], v15 offset:256
  s_waitcnt lgkmcnt(8)
  v_mfma_f32_32x32x16_bf16 v[64:79], v[104:107], v[212:215], v[64:79]
  ds_read_b64_tr_b16 v[124:125], v15 offset:4096
  ds_read_b64_tr_b16 v[126:127], v15 offset:4352
  v_and_b32 v20, s60, v212
  v_lshlrev_b32 v21, 16, v212
  v_fmac_f32 v16, v20, v20
  v_fmac_f32 v17, v21, v21
  v_mfma_f32_32x32x16_bf16 v[80:95], v[108:111], v[212:215], v[80:95]
  s_add_u32 m0, s63, 50176
  s_add_u32 s54, s98, 0
  s_and_b32 s54, s54, 7
  s_mul_i32 s54, s54, 229376
  s_add_u32 s54, s54, 57344
  buffer_load_dwordx4 v7, s[12:15], s54 offen lds
  v_and_b32 v22, s60, v213
  v_lshlrev_b32 v23, 16, v213
  v_fmac_f32 v16, v22, v22
  v_fmac_f32 v17, v23, v23
  s_waitcnt vmcnt(5)
  s_barrier
  buffer_load_dword v6, off, s[40:43], 0 sc1
  s_waitcnt lgkmcnt(5)
  v_mfma_f32_32x32x16_bf16 v[64:79], v[112:115], v[216:219], v[64:79]
  ds_read_b128 v[224:227], v8 offset:16384
  ds_read_b64_tr_b16 v[96:97], v12 offset:12288
  ds_read_b64_tr_b16 v[98:99], v12 offset:12544
  v_and_b32 v20, s60, v216
  v_lshlrev_b32 v21, 16, v216
  v_fmac_f32 v16, v20, v20
  v_fmac_f32 v17, v21, v21
  v_mfma_f32_32x32x16_bf16 v[80:95], v[116:119], v[216:219], v[80:95]
  ds_read_b64_tr_b16 v[100:101], v12 offset:16384
  ds_read_b64_tr_b16 v[102:103], v12 offset:16640
  v_and_b32 v22, s60, v217
  v_lshlrev_b32 v23, 16, v217
  v_fmac_f32 v16, v22, v22
  v_fmac_f32 v17, v23, v23
  s_waitcnt lgkmcnt(5)
  v_mfma_f32_32x32x16_bf16 v[64:79], v[120:123], v[220:223], v[64:79]
  ds_read_b128 v[228:231], v9 offset:16384
  ds_read_b64_tr_b16 v[104:105], v13 offset:12288
  ds_read_b64_tr_b16 v[106:107], v13 offset:12544
  v_and_b32 v20, s60, v220
  v_lshlrev_b32 v21, 16, v220
  v_fmac_f32 v16, v20, v20
  v_fmac_f32 v17, v21, v21
  v_mfma_f32_32x32x16_bf16 v[80:95], v[124:127], v[220:223], v[80:95]
  ds_read_b64_tr_b16 v[108:109], v13 offset:16384
  ds_read_b64_tr_b16 v[110:111], v13 offset:16640
  v_and_b32 v22, s60, v221
  v_lshlrev_b32 v23, 16, v221
  v_fmac_f32 v16, v22, v22
  v_fmac_f32 v17, v23, v23
  s_waitcnt lgkmcnt(5)
  v_mfma_f32_32x32x16_bf16 v[64:79], v[96:99], v[224:227], v[64:79]
  ds_read_b128 v[232:235], v10 offset:16384
  ds_read_b64_tr_b16 v[112:113], v14 offset:12288
  ds_read_b64_tr_b16 v[114:115], v14 offset:12544
  v_and_b32 v20, s60, v224
  v_lshlrev_b32 v21, 16, v224
  v_fmac_f32 v16, v20, v20
  v_fmac_f32 v17, v21, v21
  v_mfma_f32_32x32x16_bf16 v[80:95], v[100:103], v[224:227], v[80:95]
  ds_read_b64_tr_b16 v[116:117], v14 offset:16384
  ds_read_b64_tr_b16 v[118:119], v14 offset:16640
  v_and_b32 v22, s60, v225
  v_lshlrev_b32 v23, 16, v225
  v_fmac_f32 v16, v22, v22
  v_fmac_f32 v17, v23, v23
  v_mfma_f32_16x16x32_bf16 v[24:27], v[96:99], v[40:43], v[24:27]
  s_add_u32 m0, s63, 65536
  s_add_u32 s54, s98, 2
  s_and_b32 s54, s54, 7
  s_mul_i32 s54, s54, 229376
  buffer_load_dwordx4 v7, s[12:15], s54 offen lds
  v_mfma_f32_16x16x32_bf16 v[28:31], v[100:103], v[40:43], v[28:31]
  ds_read_b128 v[236:239], v11 offset:16384
  ds_read_b64_tr_b16 v[120:121], v15 offset:12288
  ds_read_b64_tr_b16 v[122:123], v15 offset:12544
  s_waitcnt lgkmcnt(8)
  v_mfma_f32_32x32x16_bf16 v[64:79], v[104:107], v[228:231], v[64:79]
  ds_read_b64_tr_b16 v[124:125], v15 offset:16384
  ds_read_b64_tr_b16 v[126:127], v15 offset:16640
  v_and_b32 v20, s60, v228
  v_lshlrev_b32 v21, 16, v228
  v_fmac_f32 v16, v20, v20
  v_fmac_f32 v17, v21, v21
  v_mfma_f32_32x32x16_bf16 v[80:95], v[108:111], v[228:231], v[80:95]
  s_add_u32 m0, s63, 66560
  s_add_u32 s54, s98, 2
  s_and_b32 s54, s54, 7
  s_mul_i32 s54, s54, 229376
  s_add_u32 s54, s54, 57344
  buffer_load_dwordx4 v7, s[12:15], s54 offen lds
  v_and_b32 v22, s60, v229
  v_lshlrev_b32 v23, 16, v229
  v_fmac_f32 v16, v22, v22
  v_fmac_f32 v17, v23, v23
  s_waitcnt vmcnt(5)
  s_barrier
  s_waitcnt lgkmcnt(5)
  v_mfma_f32_32x32x16_bf16 v[64:79], v[112:115], v[232:235], v[64:79]
  ds_read_b128 v[240:243], v8 offset:32768
  ds_read_b64_tr_b16 v[96:97], v12 offset:24576
  ds_read_b64_tr_b16 v[98:99], v12 offset:24832
  v_and_b32 v20, s60, v232
  v_lshlrev_b32 v21, 16, v232
  v_fmac_f32 v16, v20, v20
  v_fmac_f32 v17, v21, v21
  v_mfma_f32_32x32x16_bf16 v[80:95], v[116:119], v[232:235], v[80:95]
  ds_read_b64_tr_b16 v[100:101], v12 offset:28672
  ds_read_b64_tr_b16 v[102:103], v12 offset:28928
  v_and_b32 v22, s60, v233
  v_lshlrev_b32 v23, 16, v233
  v_fmac_f32 v16, v22, v22
  v_fmac_f32 v17, v23, v23
  s_waitcnt lgkmcnt(5)
  v_mfma_f32_32x32x16_bf16 v[64:79], v[120:123], v[236:239], v[64:79]
  ds_read_b128 v[244:247], v9 offset:32768
  ds_read_b64_tr_b16 v[104:105], v13 offset:24576
  ds_read_b64_tr_b16 v[106:107], v13 offset:24832
  v_and_b32 v20, s60, v236
  v_lshlrev_b32 v21, 16, v236
  v_fmac_f32 v16, v20, v20
  v_fmac_f32 v17, v21, v21
  v_mfma_f32_32x32x16_bf16 v[80:95], v[124:127], v[236:239], v[80:95]
  ds_read_b64_tr_b16 v[108:109], v13 offset:28672
  ds_read_b64_tr_b16 v[110:111], v13 offset:28928
  v_and_b32 v22, s60, v237
  v_lshlrev_b32 v23, 16, v237
  v_fmac_f32 v16, v22, v22
  v_fmac_f32 v17, v23, v23
  s_waitcnt lgkmcnt(5)
  v_mfma_f32_32x32x16_bf16 v[64:79], v[96:99], v[240:243], v[64:79]
  ds_read_b128 v[248:251], v10 offset:32768
  ds_read_b64_tr_b16 v[112:113], v14 offset:24576
  ds_read_b64_tr_b16 v[114:115], v14 offset:24832
  v_and_b32 v20, s60, v240
  v_lshlrev_b32 v21, 16, v240
  v_fmac_f32 v16, v20, v20
  v_fmac_f32 v17, v21, v21
  v_mfma_f32_32x32x16_bf16 v[80:95], v[100:103], v[240:243], v[80:95]
  ds_read_b64_tr_b16 v[116:117], v14 offset:28672
  ds_read_b64_tr_b16 v[118:119], v14 offset:28928
  v_and_b32 v22, s60, v241
  v_lshlrev_b32 v23, 16, v241
  v_fmac_f32 v16, v22, v22
  v_fmac_f32 v17, v23, v23
  v_mfma_f32_16x16x32_bf16 v[24:27], v[96:99], v[40:43], v[24:27]
  s_add_u32 m0, s63, 0
  s_add_u32 s54, s98, 4
  s_and_b32 s54, s54, 7
  s_mul_i32 s54, s54, 229376
  buffer_load_dwordx4 v7, s[12:15], s54 offen lds
  v_mfma_f32_16x16x32_bf16 v[28:31], v[100:103], v[40:43], v[28:31]
  ds_read_b128 v[252:255], v11 offset:32768
  ds_read_b64_tr_b16 v[120:121], v15 offset:24576
  ds_read_b64_tr_b16 v[122:123], v15 offset:24832
  s_waitcnt lgkmcnt(8)
  v_mfma_f32_32x32x16_bf16 v[64:79], v[104:107], v[244:247], v[64:79]
  ds_read_b64_tr_b16 v[124:125], v15 offset:28672
  ds_read_b64_tr_b16 v[126:127], v15 offset:28928
  v_and_b32 v20, s60, v244
  v_lshlrev_b32 v21, 16, v244
  v_fmac_f32 v16, v20, v20
  v_fmac_f32 v17, v21, v21
  v_mfma_f32_32x32x16_bf16 v[80:95], v[108:111], v[244:247], v[80:95]
  s_add_u32 m0, s63, 1024
  s_add_u32 s54, s98, 4
  s_and_b32 s54, s54, 7
  s_mul_i32 s54, s54, 229376
  s_add_u32 s54, s54, 57344
  buffer_load_dwordx4 v7, s[12:15], s54 offen lds
  v_and_b32 v22, s60, v245
  v_lshlrev_b32 v23, 16, v245
  v_fmac_f32 v16, v22, v22
  v_fmac_f32 v17, v23, v23
  s_waitcnt lgkmcnt(5)
  v_mfma_f32_32x32x16_bf16 v[64:79], v[112:115], v[248:251], v[64:79]
  v_and_b32 v20, s60, v248
  v_lshlrev_b32 v21, 16, v248
  v_fmac_f32 v16, v20, v20
  v_fmac_f32 v17, v21, v21
  v_mfma_f32_32x32x16_bf16 v[80:95], v[116:119], v[248:251], v[80:95]
  v_and_b32 v22, s60, v249
  v_lshlrev_b32 v23, 16, v249
  v_fmac_f32 v16, v22, v22
  v_fmac_f32 v17, v23, v23
  s_waitcnt lgkmcnt(0)
  v_mfma_f32_32x32x16_bf16 v[64:79], v[120:123], v[252:255], v[64:79]
  v_and_b32 v20, s60, v252
  v_lshlrev_b32 v21, 16, v252
  v_fmac_f32 v16, v20, v20
  v_fmac_f32 v17, v21, v21
  v_mfma_f32_32x32x16_bf16 v[80:95], v[124:127], v[252:255], v[80:95]
  v_and_b32 v22, s60, v253
  v_lshlrev_b32 v23, 16, v253
  v_fmac_f32 v16, v22, v22
  v_fmac_f32 v17, v23, v23
  v_add_f32 v16, v16, v17
  v_and_b32 v96, 31, v0
  v_lshlrev_b32 v97, 4, v96
  s_lshl_b32 s52, s45, 9
  s_add_u32 s52, s52, 143360
  v_add_u32 v97, s52, v97
  v_lshrrev_b32 v98, 5, v0
  v_lshlrev_b32 v98, 2, v98
  v_add3_u32 v98, v98, v97, 0
  ds_write_b32 v98, v16
  s_mov_b64 exec, s[96:97]
  ds_write_b32 v18, v24 offset:0
  ds_write_b32 v18, v25 offset:16
  ds_write_b32 v18, v26 offset:32
  ds_write_b32 v18, v27 offset:48
  ds_write_b32 v18, v28 offset:512
  ds_write_b32 v18, v29 offset:528
  ds_write_b32 v18, v30 offset:544
  ds_write_b32 v18, v31 offset:560
  s_mov_b64 exec, -1
  v_lshlrev_b32 v98, 2, v96
  s_lshl_b32 s52, s45, 7
  s_add_u32 s52, s52, 145408
  v_add_u32 v98, s52, v98
  v_lshlrev_b32 v99, 4, v96
  v_add_u32 v99, 147456, v99
  v_lshrrev_b32 v96, 5, v0
  v_lshlrev_b32 v96, 9, v96
  v_add_u32 v99, v99, v96
  s_waitcnt lgkmcnt(0)
  s_waitcnt vmcnt(4)
  v_cmp_eq_u32 vcc, 1, v6
s_nop 3
s_cbranch_vccnz ok_3
  s_mov_b32 s11, 20000
spin_4:
  s_sleep 1
  buffer_load_dword v6, off, s[40:43], 0 sc1
  s_waitcnt vmcnt(0)
  v_cmp_eq_u32 vcc, 1, v6
s_nop 3
s_cbranch_vccnz ok_3
  s_sub_u32 s11, s11, 1
  s_cmp_lg_u32 s11, 0
s_cbranch_scc1 spin_4
  v_mov_b32 v6, 1
  buffer_store_dword v6, off, s[40:43], 0 offset:4
s_nop 0
ok_3:
  s_barrier
  ds_read_b128 v[100:103], v97
  ds_read_b32 v108, v98
  ds_read_b128 v[104:107], v99 offset:0
  v_lshrrev_b32 v44, 2, v0
  v_lshlrev_b32 v44, 10, v44
  v_and_b32 v45, 3, v0
  v_lshlrev_b32 v45, 4, v45
  s_and_b32 s52, s2, 1
  s_lshl_b32 s52, s52, 3
  s_add_u32 s52, s52, s44
  s_lshl_b32 s52, s52, 6
  v_add3_u32 v44, v44, v45, s52
  s_lshr_b32 s58, s2, 1
  s_lshl_b32 s53, s44, 10
  s_add_u32 m0, s53, 81920
  s_lshl_b32 s54, s58, 14
  s_cmp_ge_u32 s2, 224
s_cbranch_scc1 prep_wo_5
  buffer_load_dwordx4 v44, s[20:23], s54 offen lds
s_branch prep_j_6
prep_wo_5:
  s_sub_u32 s54, s54, 1835008
  buffer_load_dwordx4 v44, s[24:27], s54 offen lds
prep_j_6:
  s_cmp_ge_u32 s2, 32
  s_cselect_b32 s57, 0x40000000, 0
  s_lshr_b32 s54, s2, 1
  s_add_u32 s54, s54, 16
  s_lshl_b32 s54, s54, 14
  s_add_u32 m0, s53, 90112
  v_add_u32 v44, s57, v44
  buffer_load_dwordx4 v44, s[24:27], s54 offen lds
  v_and_b32 v46, 31, v0
  v_and_b32 v47, 19, v46
  v_bfe_u32 v24, v0, 2, 1
  v_lshlrev_b32 v24, 3, v24
  v_bfe_u32 v25, v0, 3, 1
  v_lshlrev_b32 v25, 2, v25
  v_add3_u32 v47, v47, v24, v25
  v_lshlrev_b32 v47, 1, v47
  s_lshl_b32 s52, s46, 1
  s_add_u32 s52, s52, s51
  s_lshl_b32 s52, s52, 6
  s_add_u32 s53, s52, s64
  buffer_load_ushort v16, v47, s[28:31], s52 offen
  buffer_load_ushort v17, v47, s[28:31], s53 offen
  s_waitcnt lgkmcnt(1)
  v_add_f32 v100, v100, v101
  v_add_f32 v102, v102, v103
  v_mul_f32 v2, 0x3b000000, v108
  v_add_f32 v100, v100, v102
  v_mul_f32 v100, 0x3b000000, v100
  v_fma_f32 v100, -v2, v2, v100
  v_max_f32 v100, 0, v100
  v_add_f32 v101, 0x3727c5ac, v100
  v_rsq_f32 v3, v101
  s_add_u32 m0, s63, 16384
  s_add_u32 s54, s98, 6
  s_and_b32 s54, s54, 7
  s_mul_i32 s54, s54, 229376
  buffer_load_dwordx4 v7, s[12:15], s54 offen lds
  s_waitcnt lgkmcnt(0)
  v_add_f32 v104, v104, v105
  v_add_f32 v106, v106, v107
  v_mul_f32 v101, v3, v3
  v_mul_f32 v101, v101, v100
  v_add_f32 v101, 0x3727c5ac, v101
  v_rsq_f32 v101, v101
  v_add_f32 v104, v104, v106
  s_lshl_b32 s52, s44, 8
  s_add_u32 s52, s52, 151040
  v_lshlrev_b32 v20, 2, v0
  v_add_u32 v20, s52, v20
  v_lshrrev_b32 v21, 5, v0
  v_lshlrev_b32 v21, 4, v21
  v_add_u32 v21, s52, v21
  v_mul_f32 v4, v3, v101
  v_mul_f32 v5, v2, v4
  ds_write_b32 v20, v104
  v_mul_f32 v23, 0x3eb8aa3b, v3
  s_add_u32 m0, s63, 17408
  s_add_u32 s54, s98, 6
  s_and_b32 s54, s54, 7
  s_mul_i32 s54, s54, 229376
  s_add_u32 s54, s54, 57344
  buffer_load_dwordx4 v7, s[12:15], s54 offen lds
  s_lshl_b32 s52, s50, 17
  s_lshl_b32 s53, s65, 10
  s_add_u32 s66, s52, s53
  s_lshl_b32 s52, s50, 18
  s_lshl_b32 s53, s65, 11
  s_add_u32 s67, s52, s53
  s_add_u32 s67, s67, 2097152
  s_lshl_b32 s52, s46, 13
  s_sub_u32 s52, s52, 81920
  v_add_u32 v12, s52, v12
  v_add_u32 v13, s52, v13
  v_add_u32 v14, s52, v14
  v_add_u32 v15, s52, v15
  v_add_u32 v8, 0x10000, v12
  v_add_u32 v9, 0x10000, v13
  v_add_u32 v10, 0x10000, v14
  v_add_u32 v11, 0x10000, v15
  s_add_u32 m0, s63, 32768
  s_add_u32 s54, s98, 0
  s_and_b32 s54, s54, 7
  s_mul_i32 s54, s54, 229376
  s_add_u32 s54, s54, s64
  buffer_load_dwordx4 v7, s[12:15], s54 offen lds
  s_add_u32 m0, s63, 33792
  s_add_u32 s54, s98, 0
  s_and_b32 s54, s54, 7
  s_mul_i32 s54, s54, 229376
  s_add_u32 s54, s54, 57344
  s_add_u32 s54, s54, s64
  buffer_load_dwordx4 v7, s[12:15], s54 offen lds
  s_barrier
  ds_read_b64_tr_b16 v[96:97], v12 offset:49152
  ds_read_b64_tr_b16 v[98:99], v12 offset:49408
  ds_read_b128 v[24:27], v21 offset:0
  ds_read_b128 v[28:31], v21 offset:32
  s_waitcnt lgkmcnt(1)
  v_fma_f32 v64, -v2, v24, v64
  v_fma_f32 v65, -v2, v25, v65
  v_fma_f32 v66, -v2, v26, v66
  v_fma_f32 v67, -v2, v27, v67
  ds_read_b128 v[24:27], v21 offset:64
  v_mul_f32 v64, v23, v64
  v_mul_f32 v65, v23, v65
  ds_read_b64_tr_b16 v[100:101], v12 offset:53248
  ds_read_b64_tr_b16 v[102:103], v12 offset:53504
  v_mul_f32 v66, v23, v66
  v_mul_f32 v67, v23, v67
  v_cvt_pk_bf16_f32 v64, v64, v65
  v_cvt_pk_bf16_f32 v65, v66, v67
  s_waitcnt lgkmcnt(3)
  v_fma_f32 v68, -v2, v28, v68
  v_fma_f32 v69, -v2, v29, v69
  v_fma_f32 v70, -v2, v30, v70
  v_fma_f32 v71, -v2, v31, v71
  ds_read_b128 v[28:31], v21 offset:96
  ds_read_b64_tr_b16 v[104:105], v13 offset:49152
  ds_read_b64_tr_b16 v[106:107], v13 offset:49408
  v_mul_f32 v68, v23, v68
  v_mul_f32 v69, v23, v69
  v_mul_f32 v70, v23, v70
  v_mul_f32 v71, v23, v71
  v_cvt_pk_bf16_f32 v66, v68, v69
  v_cvt_pk_bf16_f32 v67, v70, v71
  buffer_store_dwordx4 v[64:67], v1, s[16:19], s66 offen sc1
  s_waitcnt lgkmcnt(5)
  v_fma_f32 v72, -v2, v24, v72
  v_fma_f32 v73, -v2, v25, v73
  ds_read_b64_tr_b16 v[108:109], v13 offset:53248
  ds_read_b64_tr_b16 v[110:111], v13 offset:53504
  v_fma_f32 v74, -v2, v26, v74
  v_fma_f32 v75, -v2, v27, v75
  ds_read_b128 v[24:27], v21 offset:128
  v_mul_f32 v72, v23, v72
  v_mul_f32 v73, v23, v73
  v_mul_f32 v74, v23, v74
  v_mul_f32 v75, v23, v75
  v_cvt_pk_bf16_f32 v68, v72, v73
  v_cvt_pk_bf16_f32 v69, v74, v75
  s_waitcnt lgkmcnt(5)
  v_mfma_f32_32x32x16_bf16 v[48:63], v[96:99], v[128:131], 0
  ds_read_b64_tr_b16 v[112:113], v14 offset:49152
  ds_read_b64_tr_b16 v[114:115], v14 offset:49408
  v_fma_f32 v76, -v2, v28, v76
  v_fma_f32 v77, -v2, v29, v77
  v_fma_f32 v78, -v2, v30, v78
  v_fma_f32 v79, -v2, v31, v79
  ds_read_b128 v[28:31], v21 offset:160
  v_mfma_f32_16x16x32_bf16 v[32:35], v[96:99], v[40:43], 0
  v_mfma_f32_32x32x16_bf16 v[48:63], v[100:103], v[144:147], v[48:63]
  ds_read_b64_tr_b16 v[116:117], v14 offset:53248
  ds_read_b64_tr_b16 v[118:119], v14 offset:53504
  v_mul_f32 v76, v23, v76
  v_mul_f32 v77, v23, v77
  v_mul_f32 v78, v23, v78
  v_mul_f32 v79, v23, v79
  v_cvt_pk_bf16_f32 v70, v76, v77
  v_mfma_f32_16x16x32_bf16 v[32:35], v[100:103], v[40:43], v[32:35]
  s_waitcnt lgkmcnt(8)
  v_mfma_f32_32x32x16_bf16 v[48:63], v[104:107], v[132:135], v[48:63]
  ds_read_b64_tr_b16 v[120:121], v15 offset:49152
  ds_read_b64_tr_b16 v[122:123], v15 offset:49408
  v_cvt_pk_bf16_f32 v71, v78, v79
  s_add_u32 s54, s66, 65536
  buffer_store_dwordx4 v[68:71], v1, s[16:19], s54 offen sc1
  s_waitcnt lgkmcnt(7)
  v_fma_f32 v80, -v2, v24, v80
  v_fma_f32 v81, -v2, v25, v81
  v_mfma_f32_32x32x16_bf16 v[48:63], v[108:111], v[148:151], v[48:63]
  ds_read_b64_tr_b16 v[124:125], v15 offset:53248
  ds_read_b64_tr_b16 v[126:127], v15 offset:53504
  v_fma_f32 v82, -v2, v26, v82
  v_fma_f32 v83, -v2, v27, v83
  ds_read_b128 v[24:27], v21 offset:192
  v_mul_f32 v80, v3, v80
  v_mul_f32 v81, v3, v81
  s_waitcnt vmcnt(12)
  s_barrier
  s_waitcnt lgkmcnt(8)
  v_mfma_f32_32x32x16_bf16 v[48:63], v[112:115], v[136:139], v[48:63]
  ds_read_b64_tr_b16 v[96:97], v8 offset:0
  ds_read_b64_tr_b16 v[98:99], v8 offset:256
  v_mul_f32 v82, v3, v82
  v_mul_f32 v83, v3, v83
  v_cvt_pk_bf16_f32 v80, v80, v81
  v_cvt_pk_bf16_f32 v81, v82, v83
  s_waitcnt lgkmcnt(9)
  s_waitcnt lgkmcnt(7)
  v_mfma_f32_32x32x16_bf16 v[48:63], v[116:119], v[152:155], v[48:63]
  ds_read_b64_tr_b16 v[100:101], v8 offset:4096
  ds_read_b64_tr_b16 v[102:103], v8 offset:4352
  s_add_u32 m0, s63, 98304
  s_add_u32 s54, s98, 2
  s_and_b32 s54, s54, 7
  s_mul_i32 s54, s54, 229376
  s_add_u32 s54, s54, s64
  buffer_load_dwordx4 v7, s[12:15], s54 offen lds
  v_fma_f32 v84, -v2, v28, v84
  v_fma_f32 v85, -v2, v29, v85
  v_fma_f32 v86, -v2, v30, v86
  v_fma_f32 v87, -v2, v31, v87
  ds_read_b128 v[28:31], v21 offset:224
  s_waitcnt lgkmcnt(8)
  v_mfma_f32_32x32x16_bf16 v[48:63], v[120:123], v[140:143], v[48:63]
  ds_read_b64_tr_b16 v[104:105], v9 offset:0
  ds_read_b64_tr_b16 v[106:107], v9 offset:256
  v_mul_f32 v84, v3, v84
  v_mul_f32 v85, v3, v85
  v_mul_f32 v86, v3, v86
  v_mul_f32 v87, v3, v87
  v_cvt_pk_bf16_f32 v82, v84, v85
  s_waitcnt lgkmcnt(8)
  v_mfma_f32_32x32x16_bf16 v[48:63], v[124:127], v[156:159], v[48:63]
  ds_read_b64_tr_b16 v[108:109], v9 offset:4096
  ds_read_b64_tr_b16 v[110:111], v9 offset:4352
  v_cvt_pk_bf16_f32 v83, v86, v87
  buffer_store_dwordx4 v[80:83], v1, s[16:19], s67 offen sc1
  s_waitcnt lgkmcnt(9)
  v_fma_f32 v88, -v2, v24, v88
  v_fma_f32 v89, -v2, v25, v89
  s_waitcnt lgkmcnt(7)
  v_mfma_f32_32x32x16_bf16 v[48:63], v[96:99], v[160:163], v[48:63]
  ds_read_b64_tr_b16 v[112:113], v10 offset:0
  ds_read_b64_tr_b16 v[114:115], v10 offset:256
  v_fma_f32 v90, -v2, v26, v90
  v_fma_f32 v91, -v2, v27, v91
  v_mul_f32 v88, v3, v88
  v_mul_f32 v89, v3, v89
  v_mul_f32 v90, v3, v90
  v_mfma_f32_16x16x32_bf16 v[32:35], v[96:99], v[40:43], v[32:35]
  s_waitcnt lgkmcnt(7)
  v_mfma_f32_32x32x16_bf16 v[48:63], v[100:103], v[176:179], v[48:63]
  ds_read_b64_tr_b16 v[116:117], v10 offset:4096
  ds_read_b64_tr_b16 v[118:119], v10 offset:4352
  s_add_u32 m0, s63, 99328
  s_add_u32 s54, s98, 2
  s_and_b32 s54, s54, 7
  s_mul_i32 s54, s54, 229376
  s_add_u32 s54, s54, 57344
  s_add_u32 s54, s54, s64
  buffer_load_dwordx4 v7, s[12:15], s54 offen lds
  v_mul_f32 v91, v3, v91
  v_cvt_pk_bf16_f32 v84, v88, v89
  v_cvt_pk_bf16_f32 v85, v90, v91
  s_waitcnt lgkmcnt(8)
  v_fma_f32 v92, -v2, v28, v92
  v_mfma_f32_16x16x32_bf16 v[32:35], v[100:103], v[40:43], v[32:35]
  s_waitcnt lgkmcnt(6)
  v_mfma_f32_32x32x16_bf16 v[48:63], v[104:107], v[164:167], v[48:63]
  ds_read_b64_tr_b16 v[120:121], v11 offset:0
  ds_read_b64_tr_b16 v[122:123], v11 offset:256
  v_fma_f32 v93, -v2, v29, v93
  v_fma_f32 v94, -v2, v30, v94
  v_fma_f32 v95, -v2, v31, v95
  v_mul_f32 v92, v3, v92
  v_mul_f32 v93, v3, v93
  s_waitcnt lgkmcnt(6)
  v_mfma_f32_32x32x16_bf16 v[48:63], v[108:111], v[180:183], v[48:63]
  ds_read_b64_tr_b16 v[124:125], v11 offset:4096
  ds_read_b64_tr_b16 v[126:127], v11 offset:4352
  v_mul_f32 v94, v3, v94
  v_mul_f32 v95, v3, v95
  v_cvt_pk_bf16_f32 v86, v92, v93
  v_cvt_pk_bf16_f32 v87, v94, v95
  s_add_u32 s54, s67, 131072
  buffer_store_dwordx4 v[84:87], v1, s[16:19], s54 offen sc1
  s_waitcnt vmcnt(14)
  s_barrier
  s_waitcnt lgkmcnt(6)
  v_mfma_f32_32x32x16_bf16 v[48:63], v[112:115], v[168:171], v[48:63]
  ds_read_b64_tr_b16 v[96:97], v12 offset:0
  ds_read_b64_tr_b16 v[98:99], v12 offset:256
  s_lshl_b32 s52, s47, 2
  s_lshr_b32 s25, s48, 3
  s_add_u32 s20, s52, s25
  s_and_b32 s53, s48, 7
  s_lshl_b32 s21, s53, 3
  s_add_u32 s21, s21, s44
  s_waitcnt lgkmcnt(6)
  v_mfma_f32_32x32x16_bf16 v[48:63], v[116:119], v[184:187], v[48:63]
  ds_read_b64_tr_b16 v[100:101], v12 offset:4096
  ds_read_b64_tr_b16 v[102:103], v12 offset:4352
  s_add_u32 m0, s63, 114688
  s_add_u32 s54, s98, 4
  s_and_b32 s54, s54, 7
  s_mul_i32 s54, s54, 229376
  s_add_u32 s54, s54, s64
  buffer_load_dwordx4 v7, s[12:15], s54 offen lds
  s_lshl_b32 s23, s44, 10
  s_lshl_b32 s22, s20, 17
  s_add_u32 s22, s22, 2097152
  s_add_u32 s22, s22, s23
  s_lshl_b32 s26, s21, 5
  s_waitcnt lgkmcnt(6)
  v_mfma_f32_32x32x16_bf16 v[48:63], v[120:123], v[172:175], v[48:63]
  ds_read_b64_tr_b16 v[104:105], v13 offset:0
  ds_read_b64_tr_b16 v[106:107], v13 offset:256
  s_add_u32 s26, s26, s20
  s_lshl_b32 s26, s26, 10
  s_add_u32 s26, s26, 16777216
  s_lshl_b32 s52, s47, 3
  s_add_u32 s24, s52, s53
  s_lshl_b32 s27, s24, 3
  s_waitcnt lgkmcnt(6)
  v_mfma_f32_32x32x16_bf16 v[48:63], v[124:127], v[188:191], v[48:63]
  ds_read_b64_tr_b16 v[108:109], v13 offset:4096
  ds_read_b64_tr_b16 v[110:111], v13 offset:4352
  s_add_u32 s27, s27, s44
  s_lshl_b32 s27, s27, 12
  s_add_u32 s27, s27, 16777216
  s_mul_i32 s52, s45, 28
  s_mul_i32 s8, s24, 112
  s_waitcnt lgkmcnt(6)
  v_mfma_f32_32x32x16_bf16 v[48:63], v[96:99], v[192:195], v[48:63]
  ds_read_b64_tr_b16 v[112:113], v14 offset:0
  ds_read_b64_tr_b16 v[114:115], v14 offset:256
  s_add_u32 s8, s8, s52
  s_lshl_b32 s8, s8, 10
  s_add_u32 s8, s8, 6291456
  s_lshl_b32 s9, s52, 4
  s_lshl_b32 s53, s25, 2
  s_add_u32 s9, s9, s53
  v_mfma_f32_16x16x32_bf16 v[32:35], v[96:99], v[40:43], v[32:35]
  s_waitcnt lgkmcnt(6)
  v_mfma_f32_32x32x16_bf16 v[48:63], v[100:103], v[208:211], v[48:63]
  ds_read_b64_tr_b16 v[116:117], v14 offset:4096
  ds_read_b64_tr_b16 v[118:119], v14 offset:4352
  s_add_u32 m0, s63, 115712
  s_add_u32 s54, s98, 4
  s_and_b32 s54, s54, 7
  s_mul_i32 s54, s54, 229376
  s_add_u32 s54, s54, 57344
  s_add_u32 s54, s54, s64
  buffer_load_dwordx4 v7, s[12:15], s54 offen lds
  s_add_u32 s9, s9, s46
  s_add_u32 s9, s9, s46
  s_lshl_b32 s9, s9, 10
  s_add_u32 s9, s9, 13631488
  s_lshl_b32 s10, s46, 4
  v_mfma_f32_16x16x32_bf16 v[32:35], v[100:103], v[40:43], v[32:35]
  s_waitcnt lgkmcnt(6)
  v_mfma_f32_32x32x16_bf16 v[48:63], v[104:107], v[196:199], v[48:63]
  ds_read_b64_tr_b16 v[120:121], v15 offset:0
  ds_read_b64_tr_b16 v[122:123], v15 offset:256
  s_add_u32 s10, s10, 112
  s_lshl_b32 s10, s10, 4
  s_add_u32 s10, s10, s53
  s_add_u32 s10, s10, s45
  s_lshl_b32 s10, s10, 10
  s_add_u32 s10, s10, 13631488
  s_waitcnt lgkmcnt(6)
  v_mfma_f32_32x32x16_bf16 v[48:63], v[108:111], v[212:215], v[48:63]
  ds_read_b64_tr_b16 v[124:125], v15 offset:4096
  ds_read_b64_tr_b16 v[126:127], v15 offset:4352
  v_mov_b32 v24, -1
  v_mov_b32 v25, -1
  v_mov_b32 v26, -1
  v_mov_b32 v27, -1
  buffer_store_dwordx4 v[24:27], v1, s[16:19], s26 offen sc1
  s_waitcnt vmcnt(11)
  s_barrier
  s_waitcnt lgkmcnt(6)
  v_mfma_f32_32x32x16_bf16 v[48:63], v[112:115], v[200:203], v[48:63]
  ds_read_b64_tr_b16 v[96:97], v12 offset:16384
  ds_read_b64_tr_b16 v[98:99], v12 offset:16640
  v_lshrrev_b32 v80, 5, v0
  v_lshlrev_b32 v80, 9, v80
  v_bfe_u32 v81, v0, 2, 2
  v_lshlrev_b32 v81, 6, v81
  v_add_u32 v80, v80, v81
  s_waitcnt lgkmcnt(6)
  v_mfma_f32_32x32x16_bf16 v[48:63], v[116:119], v[216:219], v[48:63]
  ds_read_b64_tr_b16 v[100:101], v12 offset:20480
  ds_read_b64_tr_b16 v[102:103], v12 offset:20736
  v_bfe_u32 v81, v0, 4, 1
  v_lshlrev_b32 v81, 5, v81
  v_add_u32 v80, v80, v81
  v_and_b32 v81, 3, v0
  v_lshlrev_b32 v81, 3, v81
  s_waitcnt lgkmcnt(6)
  v_mfma_f32_32x32x16_bf16 v[48:63], v[120:123], v[204:207], v[48:63]
  ds_read_b64_tr_b16 v[104:105], v13 offset:16384
  ds_read_b64_tr_b16 v[106:107], v13 offset:16640
  s_lshl_b32 s52, s44, 10
  s_add_u32 s52, s52, 81920
  v_add3_u32 v80, v80, v81, s52
  v_add_u32 v82, s57, v1
  s_waitcnt lgkmcnt(6)
  v_mfma_f32_32x32x16_bf16 v[48:63], v[124:127], v[220:223], v[48:63]
  ds_read_b64_tr_b16 v[108:109], v13 offset:20480
  ds_read_b64_tr_b16 v[110:111], v13 offset:20736
  ds_read_b64_tr_b16 v[84:85], v80
  ds_read_b64_tr_b16 v[86:87], v80 offset:256
  ds_read_b64_tr_b16 v[88:89], v80 offset:8192
  ds_read_b64_tr_b16 v[90:91], v80 offset:8448
  s_waitcnt lgkmcnt(10)
  v_mfma_f32_32x32x16_bf16 v[48:63], v[96:99], v[224:227], v[48:63]
  ds_read_b64_tr_b16 v[112:113], v14 offset:16384
  ds_read_b64_tr_b16 v[114:115], v14 offset:16640
  v_mfma_f32_16x16x32_bf16 v[32:35], v[96:99], v[40:43], v[32:35]
  s_waitcnt lgkmcnt(10)
  v_mfma_f32_32x32x16_bf16 v[48:63], v[100:103], v[240:243], v[48:63]
  ds_read_b64_tr_b16 v[116:117], v14 offset:20480
  ds_read_b64_tr_b16 v[118:119], v14 offset:20736
  v_mfma_f32_16x16x32_bf16 v[32:35], v[100:103], v[40:43], v[32:35]
  s_waitcnt lgkmcnt(10)
  v_mfma_f32_32x32x16_bf16 v[48:63], v[104:107], v[228:231], v[48:63]
  ds_read_b64_tr_b16 v[120:121], v15 offset:16384
  ds_read_b64_tr_b16 v[122:123], v15 offset:16640
  s_lshl_b32 s58, s2, 3
  s_add_u32 s58, s58, s44
  s_lshl_b32 s58, s58, 10
  s_add_u32 s58, s58, 13631488
  s_waitcnt lgkmcnt(6)
  buffer_store_dwordx4 v[84:87], v1, s[16:19], s58 offen sc1
  s_add_u32 s58, s58, 2097152
  buffer_store_dwordx4 v[88:91], v82, s[16:19], s58 offen sc1
  v_mfma_f32_32x32x16_bf16 v[48:63], v[108:111], v[244:247], v[48:63]
  ds_read_b64_tr_b16 v[124:125], v15 offset:20480
  ds_read_b64_tr_b16 v[126:127], v15 offset:20736
  s_mov_b64 exec, s[96:97]
  ds_write_b32 v18, v32 offset:1536
  ds_write_b32 v18, v33 offset:1552
  ds_write_b32 v18, v34 offset:1568
  ds_write_b32 v18, v35 offset:1584
  s_mov_b64 exec, -1
  s_waitcnt lgkmcnt(0)
  s_waitcnt vmcnt(11)
  s_waitcnt vmcnt(5)
  s_barrier
  v_mfma_f32_32x32x16_bf16 v[48:63], v[112:115], v[232:235], v[48:63]
  ds_read_b64_tr_b16 v[96:97], v12 offset:32768
  ds_read_b64_tr_b16 v[98:99], v12 offset:33024
  s_lshl_b32 s52, s50, 8
  s_lshl_b32 s53, s49, 2
  s_add_u32 s52, s52, s53
  s_add_u32 s52, s52, 18874368
  s_cmp_eq_u32 s44, 0
  s_cselect_b64 exec, 1, 0
  v_mov_b32 v6, 1
  buffer_store_dword v6, off, s[16:19], s52 sc1
  s_mov_b64 exec, -1
  v_and_b32 v28, 31, v0
  v_lshlrev_b32 v28, 4, v28
  v_add_u32 v28, 147456, v28
  ds_read_b128 v[24:27], v28 offset:1536
  v_mfma_f32_32x32x16_bf16 v[48:63], v[116:119], v[248:251], v[48:63]
  ds_read_b64_tr_b16 v[100:101], v12 offset:36864
  ds_read_b64_tr_b16 v[102:103], v12 offset:37120
  s_add_u32 m0, s63, 49152
  s_add_u32 s54, s98, 6
  s_and_b32 s54, s54, 7
  s_mul_i32 s54, s54, 229376
  s_add_u32 s54, s54, s64
  buffer_load_dwordx4 v7, s[12:15], s54 offen lds
  v_lshlrev_b32 v28, 16, v16
  v_cmp_gt_u32 vcc, 32, v0
  s_waitcnt lgkmcnt(2)
  v_add_f32 v24, v24, v25
  v_mfma_f32_32x32x16_bf16 v[48:63], v[120:123], v[236:239], v[48:63]
  ds_read_b64_tr_b16 v[104:105], v13 offset:32768
  ds_read_b64_tr_b16 v[106:107], v13 offset:33024
  v_add_f32 v26, v26, v27
  v_add_f32 v24, v24, v26
  v_cndmask_b32 v24, v28, v24, vcc
  ds_write_b32 v20, v24
  v_mfma_f32_32x32x16_bf16 v[48:63], v[124:127], v[252:255], v[48:63]
  ds_read_b64_tr_b16 v[108:109], v13 offset:36864
  ds_read_b64_tr_b16 v[110:111], v13 offset:37120
  s_mov_b32 s59, 0xbdd2d3e8
  v_mov_b32 v46, 0xc0135761
  ds_read_b128 v[80:83], v21 offset:0
  ds_read_b128 v[84:87], v21 offset:128
  v_mfma_f32_32x32x16_bf16 v[64:79], v[96:99], v[128:131], 0
  ds_read_b64_tr_b16 v[112:113], v14 offset:32768
  ds_read_b64_tr_b16 v[114:115], v14 offset:33024
  v_mfma_f32_16x16x32_bf16 v[36:39], v[96:99], v[40:43], 0
  s_waitcnt lgkmcnt(9)
  v_mfma_f32_32x32x16_bf16 v[64:79], v[100:103], v[144:147], v[64:79]
  ds_read_b64_tr_b16 v[116:117], v14 offset:36864
  ds_read_b64_tr_b16 v[118:119], v14 offset:37120
  s_add_u32 m0, s63, 50176
  s_add_u32 s54, s98, 6
  s_and_b32 s54, s54, 7
  s_mul_i32 s54, s54, 229376
  s_add_u32 s54, s54, 57344
  s_add_u32 s54, s54, s64
  buffer_load_dwordx4 v7, s[12:15], s54 offen lds
  s_waitcnt lgkmcnt(4)
  v_fma_f32 v84, -v5, v80, v84
  v_fma_f32 v85, -v5, v81, v85
  v_fma_f32 v86, -v5, v82, v86
  v_fma_f32 v87, -v5, v83, v87
  v_fma_f32 v48, v4, v48, v84
  v_mfma_f32_16x16x32_bf16 v[36:39], v[100:103], v[40:43], v[36:39]
  v_mfma_f32_32x32x16_bf16 v[64:79], v[104:107], v[132:135], v[64:79]
  ds_read_b64_tr_b16 v[120:121], v15 offset:32768
  ds_read_b64_tr_b16 v[122:123], v15 offset:33024
  v_fma_f32 v49, v4, v49, v85
  v_fma_f32 v50, v4, v50, v86
  v_fma_f32 v51, v4, v51, v87
  ds_read_b128 v[80:83], v21 offset:32
  ds_read_b128 v[84:87], v21 offset:160
  v_mul_f32 v88, v48, v48
  v_mfma_f32_32x32x16_bf16 v[64:79], v[108:111], v[148:151], v[64:79]
  ds_read_b64_tr_b16 v[124:125], v15 offset:36864
  ds_read_b64_tr_b16 v[126:127], v15 offset:37120
  v_mul_f32 v89, v49, v49
  v_mul_f32 v90, v50, v50
  v_mul_f32 v91, v51, v51
  v_fma_f32 v88, v88, s59, v46
  v_fma_f32 v89, v89, s59, v46
  s_barrier
  s_waitcnt lgkmcnt(8)
  v_mfma_f32_32x32x16_bf16 v[64:79], v[112:115], v[136:139], v[64:79]
  ds_read_b64_tr_b16 v[96:97], v8 offset:32768
  ds_read_b64_tr_b16 v[98:99], v8 offset:33024
  v_fma_f32 v90, v90, s59, v46
  v_fma_f32 v91, v91, s59, v46
  v_mul_f32 v88, v88, v48
  v_mul_f32 v89, v89, v49
  v_mul_f32 v90, v90, v50
  v_mul_f32 v91, v91, v51
  s_waitcnt lgkmcnt(8)
  v_mfma_f32_32x32x16_bf16 v[64:79], v[116:119], v[152:155], v[64:79]
  ds_read_b64_tr_b16 v[100:101], v8 offset:36864
  ds_read_b64_tr_b16 v[102:103], v8 offset:37120
  v_exp_f32 v92, v88
  v_exp_f32 v93, v89
  v_exp_f32 v94, v90
  v_exp_f32 v95, v91
  v_add_f32 v92, 1.0, v92
  s_waitcnt lgkmcnt(8)
  v_mfma_f32_32x32x16_bf16 v[64:79], v[120:123], v[140:143], v[64:79]
  ds_read_b64_tr_b16 v[104:105], v9 offset:32768
  ds_read_b64_tr_b16 v[106:107], v9 offset:33024
  v_add_f32 v93, 1.0, v93
  v_add_f32 v94, 1.0, v94
  v_add_f32 v95, 1.0, v95
  v_rcp_f32 v92, v92
  v_rcp_f32 v93, v93
  v_rcp_f32 v94, v94
  s_waitcnt lgkmcnt(6)
  v_mfma_f32_32x32x16_bf16 v[64:79], v[124:127], v[156:159], v[64:79]
  ds_read_b64_tr_b16 v[108:109], v9 offset:36864
  ds_read_b64_tr_b16 v[110:111], v9 offset:37120
  v_rcp_f32 v95, v95
  v_mul_f32 v48, v48, v92
  v_mul_f32 v49, v49, v93
  v_mul_f32 v50, v50, v94
  v_mul_f32 v51, v51, v95
  v_cvt_pk_bf16_f32 v48, v48, v49
  s_waitcnt lgkmcnt(6)
  v_mfma_f32_32x32x16_bf16 v[64:79], v[96:99], v[160:163], v[64:79]
  ds_read_b64_tr_b16 v[112:113], v10 offset:32768
  ds_read_b64_tr_b16 v[114:115], v10 offset:33024
  v_cvt_pk_bf16_f32 v49, v50, v51
  v_fma_f32 v84, -v5, v80, v84
  v_fma_f32 v85, -v5, v81, v85
  v_fma_f32 v86, -v5, v82, v86
  v_mfma_f32_16x16x32_bf16 v[36:39], v[96:99], v[40:43], v[36:39]
  s_waitcnt lgkmcnt(6)
  v_mfma_f32_32x32x16_bf16 v[64:79], v[100:103], v[176:179], v[64:79]
  ds_read_b64_tr_b16 v[116:117], v10 offset:36864
  ds_read_b64_tr_b16 v[118:119], v10 offset:37120
  v_fma_f32 v87, -v5, v83, v87
  v_fma_f32 v52, v4, v52, v84
  v_fma_f32 v53, v4, v53, v85
  v_fma_f32 v54, v4, v54, v86
  v_fma_f32 v55, v4, v55, v87
  ds_read_b128 v[80:83], v21 offset:64
  v_mfma_f32_16x16x32_bf16 v[36:39], v[100:103], v[40:43], v[36:39]
  s_waitcnt lgkmcnt(7)
  v_mfma_f32_32x32x16_bf16 v[64:79], v[104:107], v[164:167], v[64:79]
  ds_read_b64_tr_b16 v[120:121], v11 offset:32768
  ds_read_b64_tr_b16 v[122:123], v11 offset:33024
  ds_read_b128 v[84:87], v21 offset:192
  v_mul_f32 v88, v52, v52
  v_mul_f32 v89, v53, v53
  v_mul_f32 v90, v54, v54
  v_mul_f32 v91, v55, v55
  s_waitcnt lgkmcnt(8)
  v_mfma_f32_32x32x16_bf16 v[64:79], v[108:111], v[180:183], v[64:79]
  ds_read_b64_tr_b16 v[124:125], v11 offset:36864
  ds_read_b64_tr_b16 v[126:127], v11 offset:37120
  v_fma_f32 v88, v88, s59, v46
  v_fma_f32 v89, v89, s59, v46
  v_fma_f32 v90, v90, s59, v46
  v_fma_f32 v91, v91, s59, v46
  v_mul_f32 v88, v88, v52
  v_mul_f32 v89, v89, v53
  s_waitcnt vmcnt(5)
  s_waitcnt vmcnt(2)
  s_barrier
  s_waitcnt lgkmcnt(8)
  v_mfma_f32_32x32x16_bf16 v[64:79], v[112:115], v[168:171], v[64:79]
  ds_read_b64_tr_b16 v[96:97], v8 offset:49152
  ds_read_b64_tr_b16 v[98:99], v8 offset:49408
  s_lshr_b32 s52, s2, 4
  s_lshl_b32 s52, s52, 8
  s_and_b32 s53, s2, 15
  s_lshl_b32 s53, s53, 2
  s_add_u32 s52, s52, s53
  s_add_u32 s52, s52, 18878464
  s_cmp_eq_u32 s44, 0
  s_cselect_b64 exec, 1, 0
  v_mov_b32 v6, 1
  buffer_store_dword v6, off, s[16:19], s52 sc1
  s_mov_b64 exec, -1
  v_mul_f32 v90, v90, v54
  v_mul_f32 v91, v91, v55
  v_exp_f32 v92, v88
  v_exp_f32 v93, v89
  v_exp_f32 v94, v90
  v_exp_f32 v95, v91
  s_waitcnt lgkmcnt(8)
  v_mfma_f32_32x32x16_bf16 v[64:79], v[116:119], v[184:187], v[64:79]
  ds_read_b64_tr_b16 v[100:101], v8 offset:53248
  ds_read_b64_tr_b16 v[102:103], v8 offset:53504
  v_add_f32 v92, 1.0, v92
  v_add_f32 v93, 1.0, v93
  v_add_f32 v94, 1.0, v94
  v_add_f32 v95, 1.0, v95
  v_rcp_f32 v92, v92
  s_waitcnt lgkmcnt(7)
  v_mfma_f32_32x32x16_bf16 v[64:79], v[120:123], v[172:175], v[64:79]
  ds_read_b64_tr_b16 v[104:105], v9 offset:49152
  ds_read_b64_tr_b16 v[106:107], v9 offset:49408
  v_rcp_f32 v93, v93
  v_rcp_f32 v94, v94
  v_rcp_f32 v95, v95
  v_mul_f32 v52, v52, v92
  v_mul_f32 v53, v53, v93
  v_mul_f32 v54, v54, v94
  s_waitcnt lgkmcnt(6)
  v_mfma_f32_32x32x16_bf16 v[64:79], v[124:127], v[188:191], v[64:79]
  ds_read_b64_tr_b16 v[108:109], v9 offset:53248
  ds_read_b64_tr_b16 v[110:111], v9 offset:53504
  v_mul_f32 v55, v55, v95
  v_cvt_pk_bf16_f32 v50, v52, v53
  v_cvt_pk_bf16_f32 v51, v54, v55
  v_fma_f32 v84, -v5, v80, v84
  s_waitcnt lgkmcnt(6)
  v_mfma_f32_32x32x16_bf16 v[64:79], v[96:99], v[192:195], v[64:79]
  ds_read_b64_tr_b16 v[112:113], v10 offset:49152
  ds_read_b64_tr_b16 v[114:115], v10 offset:49408
  v_fma_f32 v85, -v5, v81, v85
  v_fma_f32 v86, -v5, v82, v86
  v_fma_f32 v87, -v5, v83, v87
  v_fma_f32 v56, v4, v56, v84
  v_fma_f32 v57, v4, v57, v85
  v_fma_f32 v58, v4, v58, v86
  v_mfma_f32_16x16x32_bf16 v[36:39], v[96:99], v[40:43], v[36:39]
  s_waitcnt lgkmcnt(6)
  v_mfma_f32_32x32x16_bf16 v[64:79], v[100:103], v[208:211], v[64:79]
  ds_read_b64_tr_b16 v[116:117], v10 offset:53248
  ds_read_b64_tr_b16 v[118:119], v10 offset:53504
  v_fma_f32 v59, v4, v59, v87
  ds_read_b128 v[80:83], v21 offset:96
  ds_read_b128 v[84:87], v21 offset:224
  v_mul_f32 v88, v56, v56
  v_mul_f32 v89, v57, v57
  v_mfma_f32_16x16x32_bf16 v[36:39], v[100:103], v[40:43], v[36:39]
  s_waitcnt lgkmcnt(8)
  v_mfma_f32_32x32x16_bf16 v[64:79], v[104:107], v[196:199], v[64:79]
  ds_read_b64_tr_b16 v[120:121], v11 offset:49152
  ds_read_b64_tr_b16 v[122:123], v11 offset:49408
  v_mul_f32 v90, v58, v58
  v_mul_f32 v91, v59, v59
  v_fma_f32 v88, v88, s59, v46
  v_fma_f32 v89, v89, s59, v46
  v_fma_f32 v90, v90, s59, v46
  v_fma_f32 v91, v91, s59, v46
  s_waitcnt lgkmcnt(8)
  v_mfma_f32_32x32x16_bf16 v[64:79], v[108:111], v[212:215], v[64:79]
  ds_read_b64_tr_b16 v[124:125], v11 offset:53248
  ds_read_b64_tr_b16 v[126:127], v11 offset:53504
  v_mul_f32 v88, v88, v56
  v_mul_f32 v89, v89, v57
  v_mul_f32 v90, v90, v58
  v_mul_f32 v91, v91, v59
  v_exp_f32 v92, v88
  v_exp_f32 v93, v89
  s_waitcnt vmcnt(0)
  s_barrier
  s_waitcnt lgkmcnt(8)
  v_mfma_f32_32x32x16_bf16 v[64:79], v[112:115], v[200:203], v[64:79]
  ds_read_b64_tr_b16 v[96:97], v12 offset:49152
  ds_read_b64_tr_b16 v[98:99], v12 offset:49408
  v_and_b32 v22, 15, v0
  v_lshlrev_b32 v22, 2, v22
  s_lshr_b32 s53, s20, 1
  s_lshl_b32 s53, s53, 8
  s_add_u32 s53, s53, 18874368
  buffer_load_dword v23, v22, s[16:19], s53 offen sc1
  v_exp_f32 v94, v90
  v_exp_f32 v95, v91
  v_add_f32 v92, 1.0, v92
  v_add_f32 v93, 1.0, v93
  v_add_f32 v94, 1.0, v94
  s_waitcnt lgkmcnt(8)
  v_mfma_f32_32x32x16_bf16 v[64:79], v[116:119], v[216:219], v[64:79]
  ds_read_b64_tr_b16 v[100:101], v12 offset:53248
  ds_read_b64_tr_b16 v[102:103], v12 offset:53504
  v_add_f32 v95, 1.0, v95
  v_rcp_f32 v92, v92
  v_rcp_f32 v93, v93
  v_rcp_f32 v94, v94
  v_rcp_f32 v95, v95
  v_mul_f32 v56, v56, v92
  s_waitcnt lgkmcnt(6)
  v_mfma_f32_32x32x16_bf16 v[64:79], v[120:123], v[204:207], v[64:79]
  ds_read_b64_tr_b16 v[104:105], v13 offset:49152
  ds_read_b64_tr_b16 v[106:107], v13 offset:49408
  v_mul_f32 v57, v57, v93
  v_mul_f32 v58, v58, v94
  v_mul_f32 v59, v59, v95
  v_cvt_pk_bf16_f32 v52, v56, v57
  v_cvt_pk_bf16_f32 v53, v58, v59
  s_waitcnt lgkmcnt(6)
  v_mfma_f32_32x32x16_bf16 v[64:79], v[124:127], v[220:223], v[64:79]
  ds_read_b64_tr_b16 v[108:109], v13 offset:53248
  ds_read_b64_tr_b16 v[110:111], v13 offset:53504
  v_fma_f32 v84, -v5, v80, v84
  v_fma_f32 v85, -v5, v81, v85
  v_fma_f32 v86, -v5, v82, v86
  v_fma_f32 v87, -v5, v83, v87
  v_fma_f32 v60, v4, v60, v84
  s_waitcnt lgkmcnt(6)
  v_mfma_f32_32x32x16_bf16 v[64:79], v[96:99], v[224:227], v[64:79]
  ds_read_b64_tr_b16 v[112:113], v14 offset:49152
  ds_read_b64_tr_b16 v[114:115], v14 offset:49408
  v_fma_f32 v61, v4, v61, v85
  v_fma_f32 v62, v4, v62, v86
  v_fma_f32 v63, v4, v63, v87
  v_mul_f32 v88, v60, v60
  v_mul_f32 v89, v61, v61
  v_mul_f32 v90, v62, v62
  v_mfma_f32_16x16x32_bf16 v[36:39], v[96:99], v[40:43], v[36:39]
  s_waitcnt lgkmcnt(6)
  v_mfma_f32_32x32x16_bf16 v[64:79], v[100:103], v[240:243], v[64:79]
  ds_read_b64_tr_b16 v[116:117], v14 offset:53248
  ds_read_b64_tr_b16 v[118:119], v14 offset:53504
  v_mul_f32 v91, v63, v63
  v_fma_f32 v88, v88, s59, v46
  v_fma_f32 v89, v89, s59, v46
  v_fma_f32 v90, v90, s59, v46
  v_fma_f32 v91, v91, s59, v46
  v_mfma_f32_16x16x32_bf16 v[36:39], v[100:103], v[40:43], v[36:39]
  s_waitcnt lgkmcnt(6)
  v_mfma_f32_32x32x16_bf16 v[64:79], v[104:107], v[228:231], v[64:79]
  ds_read_b64_tr_b16 v[120:121], v15 offset:49152
  ds_read_b64_tr_b16 v[122:123], v15 offset:49408
  v_mul_f32 v88, v88, v60
  v_mul_f32 v89, v89, v61
  v_mul_f32 v90, v90, v62
  v_mul_f32 v91, v91, v63
  v_exp_f32 v92, v88
  v_exp_f32 v93, v89
  s_waitcnt lgkmcnt(6)
  v_mfma_f32_32x32x16_bf16 v[64:79], v[108:111], v[244:247], v[64:79]
  ds_read_b64_tr_b16 v[124:125], v15 offset:53248
  ds_read_b64_tr_b16 v[126:127], v15 offset:53504
  v_exp_f32 v94, v90
  v_exp_f32 v95, v91
  v_add_f32 v92, 1.0, v92
  v_add_f32 v93, 1.0, v93
  v_add_f32 v94, 1.0, v94
  s_waitcnt lgkmcnt(6)
  v_mfma_f32_32x32x16_bf16 v[64:79], v[112:115], v[232:235], v[64:79]
  v_add_f32 v95, 1.0, v95
  v_rcp_f32 v92, v92
  v_rcp_f32 v93, v93
  v_rcp_f32 v94, v94
  v_rcp_f32 v95, v95
  v_mul_f32 v60, v60, v92
  s_waitcnt lgkmcnt(4)
  v_mfma_f32_32x32x16_bf16 v[64:79], v[116:119], v[248:251], v[64:79]
  v_mul_f32 v61, v61, v93
  v_mul_f32 v62, v62, v94
  v_mul_f32 v63, v63, v95
  v_cvt_pk_bf16_f32 v54, v60, v61
  v_cvt_pk_bf16_f32 v55, v62, v63
  s_waitcnt lgkmcnt(2)
  v_mfma_f32_32x32x16_bf16 v[64:79], v[120:123], v[236:239], v[64:79]
  s_waitcnt lgkmcnt(0)
  v_mfma_f32_32x32x16_bf16 v[64:79], v[124:127], v[252:255], v[64:79]
  s_mov_b64 exec, s[96:97]
  ds_write_b32 v18, v36 offset:2048
  ds_write_b32 v18, v37 offset:2064
  ds_write_b32 v18, v38 offset:2080
  ds_write_b32 v18, v39 offset:2096
  s_mov_b64 exec, -1
  s_waitcnt lgkmcnt(0)
  s_waitcnt vmcnt(0)
  s_barrier
  v_cmp_ne_u32 vcc, 1, v23
s_nop 3
s_cbranch_vccz ok_7
  s_mov_b32 s11, 20000
spin_8:
  s_sleep 1
  s_lshr_b32 s53, s20, 1
  s_lshl_b32 s53, s53, 8
  s_add_u32 s53, s53, 18874368
  buffer_load_dword v23, v22, s[16:19], s53 offen sc1
  s_waitcnt vmcnt(0)
  v_cmp_ne_u32 vcc, 1, v23
s_nop 3
s_cbranch_vccz ok_7
  s_sub_u32 s11, s11, 1
  s_cmp_lg_u32 s11, 0
s_cbranch_scc1 spin_8
  v_mov_b32 v6, 2
  buffer_store_dword v6, off, s[40:43], 0 offset:8
s_nop 0
ok_7:
  v_and_b32 v28, 31, v0
  v_lshlrev_b32 v28, 4, v28
  v_add_u32 v28, 147456, v28
  ds_read_b128 v[24:27], v28 offset:2048
  s_lshl_b32 s54, s20, 6
  s_add_u32 s54, s54, s21
  s_lshl_b32 s54, s54, 10
  buffer_load_dwordx4 v[12:15], v1, s[16:19], s54 offen sc1
  v_lshlrev_b32 v28, 16, v17
  v_cmp_gt_u32 vcc, 32, v0
  s_add_u32 m0, s23, 0
  s_add_u32 s54, s22, 0
  buffer_load_dwordx4 v1, s[16:19], s54 offen sc1 lds
  s_waitcnt lgkmcnt(0)
  v_add_f32 v24, v24, v25
  v_add_f32 v26, v26, v27
  v_add_f32 v24, v24, v26
  v_cndmask_b32 v24, v28, v24, vcc
  ds_write_b32 v20, v24
  ds_read_b128 v[80:83], v21 offset:0
  ds_read_b128 v[84:87], v21 offset:128
  s_add_u32 m0, s23, 8192
  s_add_u32 s54, s22, 8192
  buffer_load_dwordx4 v1, s[16:19], s54 offen sc1 lds
  s_add_u32 m0, s23, 16384
  s_add_u32 s54, s22, 16384
  buffer_load_dwordx4 v1, s[16:19], s54 offen sc1 lds
  s_waitcnt lgkmcnt(0)
  v_fma_f32 v84, -v5, v80, v84
  v_fma_f32 v85, -v5, v81, v85
  v_fma_f32 v86, -v5, v82, v86
  v_fma_f32 v87, -v5, v83, v87
  v_fma_f32 v64, v4, v64, v84
  v_fma_f32 v65, v4, v65, v85
  v_fma_f32 v66, v4, v66, v86
  v_fma_f32 v67, v4, v67, v87
  ds_read_b128 v[80:83], v21 offset:32
  ds_read_b128 v[84:87], v21 offset:160
  v_mul_f32 v88, v64, v64
  v_mul_f32 v89, v65, v65
  v_mul_f32 v90, v66, v66
  v_mul_f32 v91, v67, v67
  v_fma_f32 v88, v88, s59, v46
  v_fma_f32 v89, v89, s59, v46
  s_add_u32 m0, s23, 24576
  s_add_u32 s54, s22, 24576
  buffer_load_dwordx4 v1, s[16:19], s54 offen sc1 lds
  v_fma_f32 v90, v90, s59, v46
  v_fma_f32 v91, v91, s59, v46
  v_mul_f32 v88, v88, v64
  v_mul_f32 v89, v89, v65
  v_mul_f32 v90, v90, v66
  v_mul_f32 v91, v91, v67
  v_exp_f32 v92, v88
  v_exp_f32 v93, v89
  v_exp_f32 v94, v90
  v_exp_f32 v95, v91
  v_add_f32 v92, 1.0, v92
  v_add_f32 v93, 1.0, v93
  v_add_f32 v94, 1.0, v94
  v_add_f32 v95, 1.0, v95
  v_rcp_f32 v92, v92
  v_rcp_f32 v93, v93
  s_add_u32 m0, s23, 32768
  s_add_u32 s54, s22, 32768
  buffer_load_dwordx4 v1, s[16:19], s54 offen sc1 lds
  v_rcp_f32 v94, v94
  v_rcp_f32 v95, v95
  v_mul_f32 v64, v64, v92
  v_mul_f32 v65, v65, v93
  v_mul_f32 v66, v66, v94
  v_mul_f32 v67, v67, v95
  v_cvt_pk_bf16_f32 v64, v64, v65
  v_cvt_pk_bf16_f32 v65, v66, v67
  s_waitcnt lgkmcnt(0)
  v_fma_f32 v84, -v5, v80, v84
  v_fma_f32 v85, -v5, v81, v85
  v_fma_f32 v86, -v5, v82, v86
  v_fma_f32 v87, -v5, v83, v87
  v_fma_f32 v68, v4, v68, v84
  v_fma_f32 v69, v4, v69, v85
  v_fma_f32 v70, v4, v70, v86
  s_add_u32 m0, s23, 40960
  s_add_u32 s54, s22, 40960
  buffer_load_dwordx4 v1, s[16:19], s54 offen sc1 lds
  v_fma_f32 v71, v4, v71, v87
  ds_read_b128 v[80:83], v21 offset:64
  ds_read_b128 v[84:87], v21 offset:192
  v_mul_f32 v88, v68, v68
  v_mul_f32 v89, v69, v69
  v_mul_f32 v90, v70, v70
  v_mul_f32 v91, v71, v71
  v_fma_f32 v88, v88, s59, v46
  v_fma_f32 v89, v89, s59, v46
  v_fma_f32 v90, v90, s59, v46
  v_fma_f32 v91, v91, s59, v46
  v_mul_f32 v88, v88, v68
  v_mul_f32 v89, v89, v69
  v_mul_f32 v90, v90, v70
  v_mul_f32 v91, v91, v71
  v_exp_f32 v92, v88
  s_add_u32 m0, s23, 49152
  s_add_u32 s54, s22, 49152
  buffer_load_dwordx4 v1, s[16:19], s54 offen sc1 lds
  v_exp_f32 v93, v89
  v_exp_f32 v94, v90
  v_exp_f32 v95, v91
  v_add_f32 v92, 1.0, v92
  v_add_f32 v93, 1.0, v93
  v_add_f32 v94, 1.0, v94
  v_add_f32 v95, 1.0, v95
  v_rcp_f32 v92, v92
  v_rcp_f32 v93, v93
  v_rcp_f32 v94, v94
  v_rcp_f32 v95, v95
  v_mul_f32 v68, v68, v92
  v_mul_f32 v69, v69, v93
  v_mul_f32 v70, v70, v94
  v_mul_f32 v71, v71, v95
  v_cvt_pk_bf16_f32 v66, v68, v69
  s_add_u32 m0, s23, 57344
  s_add_u32 s54, s22, 57344
  buffer_load_dwordx4 v1, s[16:19], s54 offen sc1 lds
  v_cvt_pk_bf16_f32 v67, v70, v71
  s_waitcnt lgkmcnt(0)
  v_fma_f32 v84, -v5, v80, v84
  v_fma_f32 v85, -v5, v81, v85
  v_fma_f32 v86, -v5, v82, v86
  v_fma_f32 v87, -v5, v83, v87
  v_fma_f32 v72, v4, v72, v84
  v_fma_f32 v73, v4, v73, v85
  v_fma_f32 v74, v4, v74, v86
  v_fma_f32 v75, v4, v75, v87
  ds_read_b128 v[80:83], v21 offset:96
  ds_read_b128 v[84:87], v21 offset:224
  v_mul_f32 v88, v72, v72
  v_mul_f32 v89, v73, v73
  v_mul_f32 v90, v74, v74
  v_mul_f32 v91, v75, v75
  v_fma_f32 v88, v88, s59, v46
  v_fma_f32 v89, v89, s59, v46
  v_fma_f32 v90, v90, s59, v46
  v_fma_f32 v91, v91, s59, v46
  v_mul_f32 v88, v88, v72
  v_mul_f32 v89, v89, v73
  v_mul_f32 v90, v90, v74
  v_mul_f32 v91, v91, v75
  v_exp_f32 v92, v88
  v_exp_f32 v93, v89
  v_exp_f32 v94, v90
  v_exp_f32 v95, v91
  v_add_f32 v92, 1.0, v92
  v_add_f32 v93, 1.0, v93
  v_add_f32 v94, 1.0, v94
  v_add_f32 v95, 1.0, v95
  v_rcp_f32 v92, v92
  v_rcp_f32 v93, v93
  v_rcp_f32 v94, v94
  v_rcp_f32 v95, v95
  v_mul_f32 v72, v72, v92
  v_mul_f32 v73, v73, v93
  v_mul_f32 v74, v74, v94
  v_mul_f32 v75, v75, v95
  v_cvt_pk_bf16_f32 v68, v72, v73
  v_cvt_pk_bf16_f32 v69, v74, v75
  s_waitcnt lgkmcnt(0)
  v_fma_f32 v84, -v5, v80, v84
  v_fma_f32 v85, -v5, v81, v85
  v_fma_f32 v86, -v5, v82, v86
  v_fma_f32 v87, -v5, v83, v87
  v_fma_f32 v76, v4, v76, v84
  v_fma_f32 v77, v4, v77, v85
  v_fma_f32 v78, v4, v78, v86
  v_fma_f32 v79, v4, v79, v87
  v_mul_f32 v88, v76, v76
  v_mul_f32 v89, v77, v77
  v_mul_f32 v90, v78, v78
  v_mul_f32 v91, v79, v79
  v_fma_f32 v88, v88, s59, v46
  v_fma_f32 v89, v89, s59, v46
  v_fma_f32 v90, v90, s59, v46
  v_fma_f32 v91, v91, s59, v46
  v_mul_f32 v88, v88, v76
  v_mul_f32 v89, v89, v77
  v_mul_f32 v90, v90, v78
  v_mul_f32 v91, v91, v79
  v_exp_f32 v92, v88
  v_exp_f32 v93, v89
  v_exp_f32 v94, v90
  v_exp_f32 v95, v91
  v_add_f32 v92, 1.0, v92
  v_add_f32 v93, 1.0, v93
  v_add_f32 v94, 1.0, v94
  v_add_f32 v95, 1.0, v95
  v_rcp_f32 v92, v92
  v_rcp_f32 v93, v93
  v_rcp_f32 v94, v94
  v_rcp_f32 v95, v95
  v_mul_f32 v76, v76, v92
  v_mul_f32 v77, v77, v93
  v_mul_f32 v78, v78, v94
  v_mul_f32 v79, v79, v95
  v_cvt_pk_bf16_f32 v70, v76, v77
  v_cvt_pk_bf16_f32 v71, v78, v79
  s_mul_i32 s56, s65, 112
  s_lshl_b32 s52, s46, 1
  s_add_u32 s52, s52, s51
  s_add_u32 s52, s52, 0
  s_lshl_b32 s52, s52, 1
  s_add_u32 s56, s56, s52
  s_lshl_b32 s56, s56, 10
  s_add_u32 s56, s56, 6291456
  buffer_store_dwordx4 v[48:51], v1, s[16:19], s56 offen sc1
  buffer_store_dwordx4 v[52:55], v1, s[16:19], s56 offen offset:1024 sc1
  s_mul_i32 s56, s65, 112
  s_lshl_b32 s52, s46, 1
  s_add_u32 s52, s52, s51
  s_add_u32 s52, s52, 1
  s_lshl_b32 s52, s52, 1
  s_add_u32 s56, s56, s52
  s_lshl_b32 s56, s56, 10
  s_add_u32 s56, s56, 6291456
  buffer_store_dwordx4 v[64:67], v1, s[16:19], s56 offen sc1
  buffer_store_dwordx4 v[68:71], v1, s[16:19], s56 offen offset:1024 sc1
  s_waitcnt lgkmcnt(0)
  v_mov_b32 v2, v1
  v_add_u32 v3, 0x10000, v1
  v_and_b32 v6, 15, v0
  v_lshrrev_b32 v7, 5, v0
  v_lshlrev_b32 v7, 4, v7
  v_add_u32 v6, v6, v7
  v_lshlrev_b32 v6, 4, v6
  v_add_u32 v4, 0x400, v6
  v_add_u32 v5, 0x10400, v6
  s_mov_b32 s94, 0xffff
  s_mov_b32 s95, 0xffff
  v_and_b32 v6, 27, v0
  v_cmp_eq_u32 vcc, 16, v6
  v_mov_b32 v6, 0x3f803f80
s_nop 0
  v_cndmask_b32 v20, 0, v6, vcc
  v_cndmask_b32 v24, 0, v6, vcc
  v_cndmask_b32 v21, 0, v6, vcc
  v_cndmask_b32 v25, 0, v6, vcc
  v_cndmask_b32 v22, 0, v6, vcc
  v_cndmask_b32 v26, 0, v6, vcc
  v_cndmask_b32 v23, 0, v6, vcc
  v_cndmask_b32 v27, 0, v6, vcc
  s_waitcnt vmcnt(4)
  s_barrier
  ds_read_b128 v[16:19], v2 offset:0
  s_mov_b64 exec, s[94:95]
  ds_read_b128 v[20:23], v4 offset:0
  s_mov_b64 exec, -1
  s_waitcnt lgkmcnt(1)
  v_mfma_f32_32x32x16_bf16 v[52:67], v[16:19], v[12:15], 0
s_nop 11
  v_max3_f32 v6, v52, v53, v54
  v_max3_f32 v7, v55, v56, v57
  v_max3_f32 v6, v6, v58, v59
  v_max3_f32 v7, v7, v60, v61
  v_max3_f32 v6, v6, v62, v63
  v_max3_f32 v7, v7, v64, v65
  v_max3_f32 v6, v6, v66, v67
  v_max_f32 v6, v6, v7
  v_mov_b32 v7, v6
s_nop 1
  v_permlane32_swap_b32 v6, v7
  v_max_f32 v6, v6, v7
  v_sub_f32 v36, 0, v6
  v_sub_f32 v37, 0, v6
  v_sub_f32 v38, 0, v6
  v_sub_f32 v39, 0, v6
  v_sub_f32 v40, 0, v6
  v_sub_f32 v41, 0, v6
  v_sub_f32 v42, 0, v6
  v_sub_f32 v43, 0, v6
  v_sub_f32 v44, 0, v6
  v_sub_f32 v45, 0, v6
  v_sub_f32 v46, 0, v6
  v_sub_f32 v47, 0, v6
  v_sub_f32 v48, 0, v6
  v_sub_f32 v49, 0, v6
  v_sub_f32 v50, 0, v6
  v_sub_f32 v51, 0, v6
s_nop 1
  v_mfma_f32_32x32x16_bf16 v[52:67], v[16:19], v[12:15], v[36:51]
  ds_read_b128 v[16:19], v2 offset:2048
  s_setprio 2
  s_waitcnt lgkmcnt(0)
  v_mfma_f32_32x32x16_bf16 v[68:83], v[16:19], v[12:15], v[36:51]
  ds_read_b128 v[16:19], v2 offset:4096
  s_add_u32 m0, s23, 65536
  s_add_u32 s54, s22, 65536
  buffer_load_dwordx4 v1, s[16:19], s54 offen sc1 lds
s_nop 3
  v_exp_f32 v52, v52
  v_exp_f32 v53, v53
  v_exp_f32 v54, v54
  v_exp_f32 v55, v55
  v_cvt_pk_bf16_f32 v28, v52, v53
  v_exp_f32 v56, v56
  v_exp_f32 v57, v57
  v_cvt_pk_bf16_f32 v29, v54, v55
  v_exp_f32 v58, v58
  v_exp_f32 v59, v59
  v_cvt_pk_bf16_f32 v30, v56, v57
  v_exp_f32 v60, v60
  v_exp_f32 v61, v61
  v_cvt_pk_bf16_f32 v31, v58, v59
  v_exp_f32 v62, v62
  v_exp_f32 v63, v63
  v_mfma_f32_32x32x16_bf16 v[84:99], v[20:23], v[28:31], 0
  s_mov_b64 exec, s[94:95]
  ds_read_b128 v[24:27], v4 offset:512
  ds_read_b128 v[20:23], v4 offset:2048
  s_mov_b64 exec, -1
  v_cvt_pk_bf16_f32 v32, v60, v61
  v_exp_f32 v64, v64
  v_exp_f32 v65, v65
  v_cvt_pk_bf16_f32 v33, v62, v63
  v_exp_f32 v66, v66
  v_exp_f32 v67, v67
  v_cvt_pk_bf16_f32 v34, v64, v65
  v_cvt_pk_bf16_f32 v35, v66, v67
  s_waitcnt lgkmcnt(2)
  v_mfma_f32_32x32x16_bf16 v[52:67], v[16:19], v[12:15], v[36:51]
  ds_read_b128 v[16:19], v2 offset:6144
  s_add_u32 m0, s23, 73728
  s_add_u32 s54, s22, 73728
  buffer_load_dwordx4 v1, s[16:19], s54 offen sc1 lds
  v_exp_f32 v68, v68
  v_exp_f32 v69, v69
  v_exp_f32 v70, v70
  v_exp_f32 v71, v71
  v_cvt_pk_bf16_f32 v28, v68, v69
  v_exp_f32 v72, v72
  v_exp_f32 v73, v73
  v_cvt_pk_bf16_f32 v29, v70, v71
  s_waitcnt lgkmcnt(2)
  v_mfma_f32_32x32x16_bf16 v[84:99], v[24:27], v[32:35], v[84:99]
  v_exp_f32 v74, v74
  v_exp_f32 v75, v75
  v_cvt_pk_bf16_f32 v30, v72, v73
  v_exp_f32 v76, v76
  v_exp_f32 v77, v77
  v_cvt_pk_bf16_f32 v31, v74, v75
  v_exp_f32 v78, v78
  v_exp_f32 v79, v79
  s_waitcnt lgkmcnt(1)
  v_mfma_f32_32x32x16_bf16 v[84:99], v[20:23], v[28:31], v[84:99]
  s_mov_b64 exec, s[94:95]
  ds_read_b128 v[24:27], v4 offset:2560
  ds_read_b128 v[20:23], v4 offset:4096
  s_mov_b64 exec, -1
  v_cvt_pk_bf16_f32 v32, v76, v77
  v_exp_f32 v80, v80
  v_exp_f32 v81, v81
  v_cvt_pk_bf16_f32 v33, v78, v79
  v_exp_f32 v82, v82
  v_exp_f32 v83, v83
  v_cvt_pk_bf16_f32 v34, v80, v81
  v_cvt_pk_bf16_f32 v35, v82, v83
  s_waitcnt vmcnt(2)
  v_mov_b32 v6, 163824
  v_mov_b32 v7, 1
  s_mov_b64 exec, 1
  ds_add_rtn_u32 v7, v6, v7
  s_mov_b64 exec, -1
  s_waitcnt lgkmcnt(3)
  v_mfma_f32_32x32x16_bf16 v[68:83], v[16:19], v[12:15], v[36:51]
  ds_read_b128 v[16:19], v2 offset:8192
  s_add_u32 m0, s23, 81920
  s_add_u32 s54, s22, 81920
  buffer_load_dwordx4 v1, s[16:19], s54 offen sc1 lds
  v_exp_f32 v52, v52
  v_exp_f32 v53, v53
  v_exp_f32 v54, v54
  v_exp_f32 v55, v55
  v_cvt_pk_bf16_f32 v28, v52, v53
  v_exp_f32 v56, v56
  v_exp_f32 v57, v57
  v_cvt_pk_bf16_f32 v29, v54, v55
  s_waitcnt lgkmcnt(3)
  v_mfma_f32_32x32x16_bf16 v[84:99], v[24:27], v[32:35], v[84:99]
  v_exp_f32 v58, v58
  v_exp_f32 v59, v59
  v_cvt_pk_bf16_f32 v30, v56, v57
  v_exp_f32 v60, v60
  v_exp_f32 v61, v61
  v_cvt_pk_bf16_f32 v31, v58, v59
  v_exp_f32 v62, v62
  v_exp_f32 v63, v63
  s_waitcnt lgkmcnt(2)
  v_mfma_f32_32x32x16_bf16 v[84:99], v[20:23], v[28:31], v[84:99]
  s_mov_b64 exec, s[94:95]
  ds_read_b128 v[24:27], v4 offset:4608
  ds_read_b128 v[20:23], v4 offset:6144
  s_mov_b64 exec, -1
  v_cvt_pk_bf16_f32 v32, v60, v61
  v_exp_f32 v64, v64
  v_exp_f32 v65, v65
  v_cvt_pk_bf16_f32 v33, v62, v63
  v_exp_f32 v66, v66
  v_exp_f32 v67, v67
  v_cvt_pk_bf16_f32 v34, v64, v65
  v_cvt_pk_bf16_f32 v35, v66, v67
  s_setprio 0
  s_waitcnt lgkmcnt(3)
  v_readfirstlane_b32 s52, v7
s_nop 3
  s_cmp_lg_u32 s52, 7
s_cbranch_scc1 nofb_9
  s_lshl_b32 s52, s49, 8
  s_lshl_b32 s53, s50, 2
  s_add_u32 s52, s52, s53
  s_add_u32 s52, s52, 18882560
  s_mov_b64 exec, 1
  v_mov_b32 v7, 1
  buffer_store_dword v7, off, s[16:19], s52 sc1
  s_mov_b64 exec, -1
nofb_9:
  s_waitcnt lgkmcnt(2)
  v_mfma_f32_32x32x16_bf16 v[52:67], v[16:19], v[12:15], v[36:51]
  ds_read_b128 v[16:19], v2 offset:10240
  s_add_u32 m0, s23, 90112
  s_add_u32 s54, s22, 90112
  buffer_load_dwordx4 v1, s[16:19], s54 offen sc1 lds
  v_exp_f32 v68, v68
  v_exp_f32 v69, v69
  v_exp_f32 v70, v70
  v_exp_f32 v71, v71
  v_cvt_pk_bf16_f32 v28, v68, v69
  v_exp_f32 v72, v72
  v_exp_f32 v73, v73
  v_cvt_pk_bf16_f32 v29, v70, v71
  s_waitcnt lgkmcnt(2)
  v_mfma_f32_32x32x16_bf16 v[84:99], v[24:27], v[32:35], v[84:99]
  v_exp_f32 v74, v74
  v_exp_f32 v75, v75
  v_cvt_pk_bf16_f32 v30, v72, v73
  v_exp_f32 v76, v76
  v_exp_f32 v77, v77
  v_cvt_pk_bf16_f32 v31, v74, v75
  v_exp_f32 v78, v78
  v_exp_f32 v79, v79
  s_waitcnt lgkmcnt(1)
  v_mfma_f32_32x32x16_bf16 v[84:99], v[20:23], v[28:31], v[84:99]
  s_mov_b64 exec, s[94:95]
  ds_read_b128 v[24:27], v4 offset:6656
  ds_read_b128 v[20:23], v4 offset:8192
  s_mov_b64 exec, -1
  v_cvt_pk_bf16_f32 v32, v76, v77
  v_exp_f32 v80, v80
  v_exp_f32 v81, v81
  v_cvt_pk_bf16_f32 v33, v78, v79
  v_exp_f32 v82, v82
  v_exp_f32 v83, v83
  v_cvt_pk_bf16_f32 v34, v80, v81
  v_cvt_pk_bf16_f32 v35, v82, v83
  s_setprio 2
  s_waitcnt lgkmcnt(2)
  v_mfma_f32_32x32x16_bf16 v[68:83], v[16:19], v[12:15], v[36:51]
  ds_read_b128 v[16:19], v2 offset:12288
  s_add_u32 m0, s23, 98304
  s_add_u32 s54, s22, 98304
  buffer_load_dwordx4 v1, s[16:19], s54 offen sc1 lds
  v_exp_f32 v52, v52
  v_exp_f32 v53, v53
  v_exp_f32 v54, v54
  v_exp_f32 v55, v55
  v_cvt_pk_bf16_f32 v28, v52, v53
  v_exp_f32 v56, v56
  v_exp_f32 v57, v57
  v_cvt_pk_bf16_f32 v29, v54, v55
  s_waitcnt lgkmcnt(2)
  v_mfma_f32_32x32x16_bf16 v[84:99], v[24:27], v[32:35], v[84:99]
  v_exp_f32 v58, v58
  v_exp_f32 v59, v59
  v_cvt_pk_bf16_f32 v30, v56, v57
  v_exp_f32 v60, v60
  v_exp_f32 v61, v61
  v_cvt_pk_bf16_f32 v31, v58, v59
  v_exp_f32 v62, v62
  v_exp_f32 v63, v63
  s_waitcnt lgkmcnt(1)
  v_mfma_f32_32x32x16_bf16 v[84:99], v[20:23], v[28:31], v[84:99]
  s_mov_b64 exec, s[94:95]
  ds_read_b128 v[24:27], v4 offset:8704
  ds_read_b128 v[20:23], v4 offset:10240
  s_mov_b64 exec, -1
  v_cvt_pk_bf16_f32 v32, v60, v61
  v_exp_f32 v64, v64
  v_exp_f32 v65, v65
  v_cvt_pk_bf16_f32 v33, v62, v63
  v_exp_f32 v66, v66
  v_exp_f32 v67, v67
  v_cvt_pk_bf16_f32 v34, v64, v65
  v_cvt_pk_bf16_f32 v35, v66, v67
  s_waitcnt lgkmcnt(2)
  v_mfma_f32_32x32x16_bf16 v[52:67], v[16:19], v[12:15], v[36:51]
  ds_read_b128 v[16:19], v2 offset:14336
  s_add_u32 m0, s23, 106496
  s_add_u32 s54, s22, 106496
  buffer_load_dwordx4 v1, s[16:19], s54 offen sc1 lds
  v_exp_f32 v68, v68
  v_exp_f32 v69, v69
  v_exp_f32 v70, v70
  v_exp_f32 v71, v71
  v_cvt_pk_bf16_f32 v28, v68, v69
  v_exp_f32 v72, v72
  v_exp_f32 v73, v73
  v_cvt_pk_bf16_f32 v29, v70, v71
  s_waitcnt lgkmcnt(2)
  v_mfma_f32_32x32x16_bf16 v[84:99], v[24:27], v[32:35], v[84:99]
  v_exp_f32 v74, v74
  v_exp_f32 v75, v75
  v_cvt_pk_bf16_f32 v30, v72, v73
  v_exp_f32 v76, v76
  v_exp_f32 v77, v77
  v_cvt_pk_bf16_f32 v31, v74, v75
  v_exp_f32 v78, v78
  v_exp_f32 v79, v79
  s_waitcnt lgkmcnt(1)
  v_mfma_f32_32x32x16_bf16 v[84:99], v[20:23], v[28:31], v[84:99]
  s_mov_b64 exec, s[94:95]
  ds_read_b128 v[24:27], v4 offset:10752
  ds_read_b128 v[20:23], v4 offset:12288
  s_mov_b64 exec, -1
  v_cvt_pk_bf16_f32 v32, v76, v77
  v_exp_f32 v80, v80
  v_exp_f32 v81, v81
  v_cvt_pk_bf16_f32 v33, v78, v79
  v_exp_f32 v82, v82
  v_exp_f32 v83, v83
  v_cvt_pk_bf16_f32 v34, v80, v81
  v_cvt_pk_bf16_f32 v35, v82, v83
  s_waitcnt lgkmcnt(2)
  v_mfma_f32_32x32x16_bf16 v[68:83], v[16:19], v[12:15], v[36:51]
  ds_read_b128 v[16:19], v2 offset:16384
  s_add_u32 m0, s23, 114688
  s_add_u32 s54, s22, 114688
  buffer_load_dwordx4 v1, s[16:19], s54 offen sc1 lds
  v_exp_f32 v52, v52
  v_exp_f32 v53, v53
  v_exp_f32 v54, v54
  v_exp_f32 v55, v55
  v_cvt_pk_bf16_f32 v28, v52, v53
  v_exp_f32 v56, v56
  v_exp_f32 v57, v57
  v_cvt_pk_bf16_f32 v29, v54, v55
  s_waitcnt lgkmcnt(2)
  v_mfma_f32_32x32x16_bf16 v[84:99], v[24:27], v[32:35], v[84:99]
  v_exp_f32 v58, v58
  v_exp_f32 v59, v59
  v_cvt_pk_bf16_f32 v30, v56, v57
  v_exp_f32 v60, v60
  v_exp_f32 v61, v61
  v_cvt_pk_bf16_f32 v31, v58, v59
  v_exp_f32 v62, v62
  v_exp_f32 v63, v63
  s_waitcnt lgkmcnt(1)
  v_mfma_f32_32x32x16_bf16 v[84:99], v[20:23], v[28:31], v[84:99]
  s_mov_b64 exec, s[94:95]
  ds_read_b128 v[24:27], v4 offset:12800
  ds_read_b128 v[20:23], v4 offset:14336
  s_mov_b64 exec, -1
  v_cvt_pk_bf16_f32 v32, v60, v61
  v_exp_f32 v64, v64
  v_exp_f32 v65, v65
  v_cvt_pk_bf16_f32 v33, v62, v63
  v_exp_f32 v66, v66
  v_exp_f32 v67, v67
  v_cvt_pk_bf16_f32 v34, v64, v65
  v_cvt_pk_bf16_f32 v35, v66, v67
  s_setprio 0
  s_waitcnt lgkmcnt(2)
  v_mfma_f32_32x32x16_bf16 v[52:67], v[16:19], v[12:15], v[36:51]
  ds_read_b128 v[16:19], v2 offset:18432
  s_add_u32 m0, s23, 122880
  s_add_u32 s54, s22, 122880
  buffer_load_dwordx4 v1, s[16:19], s54 offen sc1 lds
  v_exp_f32 v68, v68
  v_exp_f32 v69, v69
  v_exp_f32 v70, v70
  v_exp_f32 v71, v71
  v_cvt_pk_bf16_f32 v28, v68, v69
  v_exp_f32 v72, v72
  v_exp_f32 v73, v73
  v_cvt_pk_bf16_f32 v29, v70, v71
  s_waitcnt lgkmcnt(2)
  v_mfma_f32_32x32x16_bf16 v[84:99], v[24:27], v[32:35], v[84:99]
  v_exp_f32 v74, v74
  v_exp_f32 v75, v75
  v_cvt_pk_bf16_f32 v30, v72, v73
  v_exp_f32 v76, v76
  v_exp_f32 v77, v77
  v_cvt_pk_bf16_f32 v31, v74, v75
  v_exp_f32 v78, v78
  v_exp_f32 v79, v79
  s_waitcnt lgkmcnt(1)
  v_mfma_f32_32x32x16_bf16 v[84:99], v[20:23], v[28:31], v[84:99]
  s_mov_b64 exec, s[94:95]
  ds_read_b128 v[24:27], v4 offset:14848
  ds_read_b128 v[20:23], v4 offset:16384
  s_mov_b64 exec, -1
  v_cvt_pk_bf16_f32 v32, v76, v77
  v_exp_f32 v80, v80
  v_exp_f32 v81, v81
  v_cvt_pk_bf16_f32 v33, v78, v79
  v_exp_f32 v82, v82
  v_exp_f32 v83, v83
  v_cvt_pk_bf16_f32 v34, v80, v81
  v_cvt_pk_bf16_f32 v35, v82, v83
  s_setprio 2
  s_waitcnt lgkmcnt(2)
  v_mfma_f32_32x32x16_bf16 v[68:83], v[16:19], v[12:15], v[36:51]
  ds_read_b128 v[16:19], v2 offset:20480
  v_exp_f32 v52, v52
  v_exp_f32 v53, v53
  v_exp_f32 v54, v54
  v_exp_f32 v55, v55
  v_cvt_pk_bf16_f32 v28, v52, v53
  v_exp_f32 v56, v56
  v_exp_f32 v57, v57
  v_cvt_pk_bf16_f32 v29, v54, v55
  s_waitcnt lgkmcnt(2)
  v_mfma_f32_32x32x16_bf16 v[84:99], v[24:27], v[32:35], v[84:99]
  v_exp_f32 v58, v58
  v_exp_f32 v59, v59
  v_cvt_pk_bf16_f32 v30, v56, v57
  v_exp_f32 v60, v60
  v_exp_f32 v61, v61
  v_cvt_pk_bf16_f32 v31, v58, v59
  v_exp_f32 v62, v62
  v_exp_f32 v63, v63
  s_waitcnt lgkmcnt(1)
  v_mfma_f32_32x32x16_bf16 v[84:99], v[20:23], v[28:31], v[84:99]
  s_mov_b64 exec, s[94:95]
  ds_read_b128 v[24:27], v4 offset:16896
  ds_read_b128 v[20:23], v4 offset:18432
  s_mov_b64 exec, -1
  v_cvt_pk_bf16_f32 v32, v60, v61
  v_exp_f32 v64, v64
  v_exp_f32 v65, v65
  v_cvt_pk_bf16_f32 v33, v62, v63
  v_exp_f32 v66, v66
  v_exp_f32 v67, v67
  v_cvt_pk_bf16_f32 v34, v64, v65
  v_cvt_pk_bf16_f32 v35, v66, v67
  s_waitcnt lgkmcnt(2)
  v_mfma_f32_32x32x16_bf16 v[52:67], v[16:19], v[12:15], v[36:51]
  ds_read_b128 v[16:19], v2 offset:22528
  v_exp_f32 v68, v68
  v_exp_f32 v69, v69
  v_exp_f32 v70, v70
  v_exp_f32 v71, v71
  v_cvt_pk_bf16_f32 v28, v68, v69
  v_exp_f32 v72, v72
  v_exp_f32 v73, v73
  v_cvt_pk_bf16_f32 v29, v70, v71
  s_waitcnt lgkmcnt(2)
  v_mfma_f32_32x32x16_bf16 v[84:99], v[24:27], v[32:35], v[84:99]
  v_exp_f32 v74, v74
  v_exp_f32 v75, v75
  v_cvt_pk_bf16_f32 v30, v72, v73
  v_exp_f32 v76, v76
  v_exp_f32 v77, v77
  v_cvt_pk_bf16_f32 v31, v74, v75
  v_exp_f32 v78, v78
  v_exp_f32 v79, v79
  s_waitcnt lgkmcnt(1)
  v_mfma_f32_32x32x16_bf16 v[84:99], v[20:23], v[28:31], v[84:99]
  s_mov_b64 exec, s[94:95]
  ds_read_b128 v[24:27], v4 offset:18944
  ds_read_b128 v[20:23], v4 offset:20480
  s_mov_b64 exec, -1
  v_cvt_pk_bf16_f32 v32, v76, v77
  v_exp_f32 v80, v80
  v_exp_f32 v81, v81
  v_cvt_pk_bf16_f32 v33, v78, v79
  v_exp_f32 v82, v82
  v_exp_f32 v83, v83
  v_cvt_pk_bf16_f32 v34, v80, v81
  v_cvt_pk_bf16_f32 v35, v82, v83
  s_waitcnt lgkmcnt(2)
  v_mfma_f32_32x32x16_bf16 v[68:83], v[16:19], v[12:15], v[36:51]
  ds_read_b128 v[16:19], v2 offset:24576
  v_exp_f32 v52, v52
  v_exp_f32 v53, v53
  v_exp_f32 v54, v54
  v_exp_f32 v55, v55
  v_cvt_pk_bf16_f32 v28, v52, v53
  v_exp_f32 v56, v56
  v_exp_f32 v57, v57
  v_cvt_pk_bf16_f32 v29, v54, v55
  s_waitcnt lgkmcnt(2)
  v_mfma_f32_32x32x16_bf16 v[84:99], v[24:27], v[32:35], v[84:99]
  v_exp_f32 v58, v58
  v_exp_f32 v59, v59
  v_cvt_pk_bf16_f32 v30, v56, v57
  v_exp_f32 v60, v60
  v_exp_f32 v61, v61
  v_cvt_pk_bf16_f32 v31, v58, v59
  v_exp_f32 v62, v62
  v_exp_f32 v63, v63
  s_waitcnt lgkmcnt(1)
  v_mfma_f32_32x32x16_bf16 v[84:99], v[20:23], v[28:31], v[84:99]
  s_mov_b64 exec, s[94:95]
  ds_read_b128 v[24:27], v4 offset:20992
  ds_read_b128 v[20:23], v4 offset:22528
  s_mov_b64 exec, -1
  v_cvt_pk_bf16_f32 v32, v60, v61
  v_exp_f32 v64, v64
  v_exp_f32 v65, v65
  v_cvt_pk_bf16_f32 v33, v62, v63
  v_exp_f32 v66, v66
  v_exp_f32 v67, v67
  v_cvt_pk_bf16_f32 v34, v64, v65
  v_cvt_pk_bf16_f32 v35, v66, v67
  s_setprio 0
  s_waitcnt lgkmcnt(2)
  v_mfma_f32_32x32x16_bf16 v[52:67], v[16:19], v[12:15], v[36:51]
  ds_read_b128 v[16:19], v2 offset:26624
  v_exp_f32 v68, v68
  v_exp_f32 v69, v69
  v_exp_f32 v70, v70
  v_exp_f32 v71, v71
  v_cvt_pk_bf16_f32 v28, v68, v69
  v_exp_f32 v72, v72
  v_exp_f32 v73, v73
  v_cvt_pk_bf16_f32 v29, v70, v71
  s_waitcnt lgkmcnt(2)
  v_mfma_f32_32x32x16_bf16 v[84:99], v[24:27], v[32:35], v[84:99]
  v_exp_f32 v74, v74
  v_exp_f32 v75, v75
  v_cvt_pk_bf16_f32 v30, v72, v73
  v_exp_f32 v76, v76
  v_exp_f32 v77, v77
  v_cvt_pk_bf16_f32 v31, v74, v75
  v_exp_f32 v78, v78
  v_exp_f32 v79, v79
  s_waitcnt lgkmcnt(1)
  v_mfma_f32_32x32x16_bf16 v[84:99], v[20:23], v[28:31], v[84:99]
  s_mov_b64 exec, s[94:95]
  ds_read_b128 v[24:27], v4 offset:23040
  ds_read_b128 v[20:23], v4 offset:24576
  s_mov_b64 exec, -1
  v_cvt_pk_bf16_f32 v32, v76, v77
  v_exp_f32 v80, v80
  v_exp_f32 v81, v81
  v_cvt_pk_bf16_f32 v33, v78, v79
  v_exp_f32 v82, v82
  v_exp_f32 v83, v83
  v_cvt_pk_bf16_f32 v34, v80, v81
  v_cvt_pk_bf16_f32 v35, v82, v83
  s_setprio 2
  s_waitcnt lgkmcnt(2)
  v_mfma_f32_32x32x16_bf16 v[68:83], v[16:19], v[12:15], v[36:51]
  ds_read_b128 v[16:19], v2 offset:28672
  v_exp_f32 v52, v52
  v_exp_f32 v53, v53
  v_exp_f32 v54, v54
  v_exp_f32 v55, v55
  v_cvt_pk_bf16_f32 v28, v52, v53
  v_exp_f32 v56, v56
  v_exp_f32 v57, v57
  v_cvt_pk_bf16_f32 v29, v54, v55
  s_waitcnt lgkmcnt(2)
  v_mfma_f32_32x32x16_bf16 v[84:99], v[24:27], v[32:35], v[84:99]
  v_exp_f32 v58, v58
  v_exp_f32 v59, v59
  v_cvt_pk_bf16_f32 v30, v56, v57
  v_exp_f32 v60, v60
  v_exp_f32 v61, v61
  v_cvt_pk_bf16_f32 v31, v58, v59
  v_exp_f32 v62, v62
  v_exp_f32 v63, v63
  s_waitcnt lgkmcnt(1)
  v_mfma_f32_32x32x16_bf16 v[84:99], v[20:23], v[28:31], v[84:99]
  s_mov_b64 exec, s[94:95]
  ds_read_b128 v[24:27], v4 offset:25088
  ds_read_b128 v[20:23], v4 offset:26624
  s_mov_b64 exec, -1
  v_cvt_pk_bf16_f32 v32, v60, v61
  v_exp_f32 v64, v64
  v_exp_f32 v65, v65
  v_cvt_pk_bf16_f32 v33, v62, v63
  v_exp_f32 v66, v66
  v_exp_f32 v67, v67
  v_cvt_pk_bf16_f32 v34, v64, v65
  v_cvt_pk_bf16_f32 v35, v66, v67
  s_waitcnt lgkmcnt(2)
  v_mfma_f32_32x32x16_bf16 v[52:67], v[16:19], v[12:15], v[36:51]
  ds_read_b128 v[16:19], v2 offset:30720
  v_exp_f32 v68, v68
  v_exp_f32 v69, v69
  v_exp_f32 v70, v70
  v_exp_f32 v71, v71
  v_cvt_pk_bf16_f32 v28, v68, v69
  v_exp_f32 v72, v72
  v_exp_f32 v73, v73
  v_cvt_pk_bf16_f32 v29, v70, v71
  s_waitcnt lgkmcnt(2)
  v_mfma_f32_32x32x16_bf16 v[84:99], v[24:27], v[32:35], v[84:99]
  v_exp_f32 v74, v74
  v_exp_f32 v75, v75
  v_cvt_pk_bf16_f32 v30, v72, v73
  v_exp_f32 v76, v76
  v_exp_f32 v77, v77
  v_cvt_pk_bf16_f32 v31, v74, v75
  v_exp_f32 v78, v78
  v_exp_f32 v79, v79
  s_waitcnt lgkmcnt(1)
  v_mfma_f32_32x32x16_bf16 v[84:99], v[20:23], v[28:31], v[84:99]
  s_mov_b64 exec, s[94:95]
  ds_read_b128 v[24:27], v4 offset:27136
  ds_read_b128 v[20:23], v4 offset:28672
  s_mov_b64 exec, -1
  v_lshrrev_b32 v6, 2, v0
  v_lshlrev_b32 v6, 8, v6
  v_and_b32 v7, 3, v0
  v_lshlrev_b32 v7, 4, v7
  v_add_u32 v6, v6, v7
  v_and_b32 v7, 15, v0
  v_lshlrev_b32 v7, 2, v7
  s_mov_b32 s53, 18878464
  s_lshr_b32 s52, s24, 2
  s_lshl_b32 s52, s52, 8
  s_add_u32 s52, s52, 18882560
  buffer_load_dwordx4 v[8:11], v6, s[16:19], s53 offen sc1
  buffer_load_dword v228, v7, s[16:19], s52 offen sc1
  v_cvt_pk_bf16_f32 v32, v76, v77
  v_exp_f32 v80, v80
  v_exp_f32 v81, v81
  v_cvt_pk_bf16_f32 v33, v78, v79
  v_exp_f32 v82, v82
  v_exp_f32 v83, v83
  v_cvt_pk_bf16_f32 v34, v80, v81
  v_cvt_pk_bf16_f32 v35, v82, v83
  s_waitcnt lgkmcnt(2)
  v_mfma_f32_32x32x16_bf16 v[68:83], v[16:19], v[12:15], v[36:51]
  ds_read_b128 v[16:19], v2 offset:32768
  v_exp_f32 v52, v52
  v_exp_f32 v53, v53
  v_exp_f32 v54, v54
  v_exp_f32 v55, v55
  v_cvt_pk_bf16_f32 v28, v52, v53
  v_exp_f32 v56, v56
  v_exp_f32 v57, v57
  v_cvt_pk_bf16_f32 v29, v54, v55
  s_waitcnt lgkmcnt(2)
  v_mfma_f32_32x32x16_bf16 v[84:99], v[24:27], v[32:35], v[84:99]
  v_exp_f32 v58, v58
  v_exp_f32 v59, v59
  v_cvt_pk_bf16_f32 v30, v56, v57
  v_exp_f32 v60, v60
  v_exp_f32 v61, v61
  v_cvt_pk_bf16_f32 v31, v58, v59
  v_exp_f32 v62, v62
  v_exp_f32 v63, v63
  s_waitcnt lgkmcnt(1)
  v_mfma_f32_32x32x16_bf16 v[84:99], v[20:23], v[28:31], v[84:99]
  s_mov_b64 exec, s[94:95]
  ds_read_b128 v[24:27], v4 offset:29184
  ds_read_b128 v[20:23], v4 offset:30720
  s_mov_b64 exec, -1
  v_cvt_pk_bf16_f32 v32, v60, v61
  v_exp_f32 v64, v64
  v_exp_f32 v65, v65
  v_cvt_pk_bf16_f32 v33, v62, v63
  v_exp_f32 v66, v66
  v_exp_f32 v67, v67
  v_cvt_pk_bf16_f32 v34, v64, v65
  v_cvt_pk_bf16_f32 v35, v66, v67
  s_setprio 0
  s_waitcnt lgkmcnt(2)
  v_mfma_f32_32x32x16_bf16 v[52:67], v[16:19], v[12:15], v[36:51]
  ds_read_b128 v[16:19], v2 offset:34816
  v_exp_f32 v68, v68
  v_exp_f32 v69, v69
  v_exp_f32 v70, v70
  v_exp_f32 v71, v71
  v_cvt_pk_bf16_f32 v28, v68, v69
  v_exp_f32 v72, v72
  v_exp_f32 v73, v73
  v_cvt_pk_bf16_f32 v29, v70, v71
  s_waitcnt lgkmcnt(2)
  v_mfma_f32_32x32x16_bf16 v[84:99], v[24:27], v[32:35], v[84:99]
  v_exp_f32 v74, v74
  v_exp_f32 v75, v75
  v_cvt_pk_bf16_f32 v30, v72, v73
  v_exp_f32 v76, v76
  v_exp_f32 v77, v77
  v_cvt_pk_bf16_f32 v31, v74, v75
  v_exp_f32 v78, v78
  v_exp_f32 v79, v79
  s_waitcnt lgkmcnt(1)
  v_mfma_f32_32x32x16_bf16 v[84:99], v[20:23], v[28:31], v[84:99]
  s_mov_b64 exec, s[94:95]
  ds_read_b128 v[24:27], v4 offset:31232
  ds_read_b128 v[20:23], v4 offset:32768
  s_mov_b64 exec, -1
  v_cvt_pk_bf16_f32 v32, v76, v77
  v_exp_f32 v80, v80
  v_exp_f32 v81, v81
  v_cvt_pk_bf16_f32 v33, v78, v79
  v_exp_f32 v82, v82
  v_exp_f32 v83, v83
  v_cvt_pk_bf16_f32 v34, v80, v81
  v_cvt_pk_bf16_f32 v35, v82, v83
  s_setprio 2
  s_waitcnt vmcnt(0)
  v_and_b32 v8, v8, v9
  v_and_b32 v10, v10, v11
  v_and_b32 v8, v8, v10
  v_and_b32 v8, v8, v228
  v_cmp_ne_u32 vcc, 1, v8
s_nop 3
s_cbranch_vccz ok_10
  s_mov_b32 s11, 20000
spin_11:
  s_sleep 1
  s_mov_b32 s53, 18878464
  s_lshr_b32 s52, s24, 2
  s_lshl_b32 s52, s52, 8
  s_add_u32 s52, s52, 18882560
  buffer_load_dwordx4 v[8:11], v6, s[16:19], s53 offen sc1
  buffer_load_dword v228, v7, s[16:19], s52 offen sc1
  s_waitcnt vmcnt(0)
  v_and_b32 v8, v8, v9
  v_and_b32 v10, v10, v11
  v_and_b32 v8, v8, v10
  v_and_b32 v8, v8, v228
  v_cmp_ne_u32 vcc, 1, v8
s_nop 3
s_cbranch_vccz ok_10
  s_sub_u32 s11, s11, 1
  s_cmp_lg_u32 s11, 0
s_cbranch_scc1 spin_11
  v_mov_b32 v6, 3
  buffer_store_dword v6, off, s[40:43], 0 offset:12
s_nop 0
ok_10:
  s_waitcnt lgkmcnt(2)
  v_mfma_f32_32x32x16_bf16 v[68:83], v[16:19], v[12:15], v[36:51]
  ds_read_b128 v[16:19], v2 offset:36864
  s_add_u32 s54, s8, 0
  buffer_load_dwordx4 v[164:167], v1, s[16:19], s54 offen sc1
  s_add_u32 s55, s9, 0
  buffer_load_dwordx4 v[168:171], v1, s[16:19], s55 offen offset:0 sc1
  v_exp_f32 v52, v52
  v_exp_f32 v53, v53
  v_exp_f32 v54, v54
  v_exp_f32 v55, v55
  v_cvt_pk_bf16_f32 v28, v52, v53
  v_exp_f32 v56, v56
  v_exp_f32 v57, v57
  v_cvt_pk_bf16_f32 v29, v54, v55
  s_waitcnt lgkmcnt(2)
  v_mfma_f32_32x32x16_bf16 v[84:99], v[24:27], v[32:35], v[84:99]
  v_exp_f32 v58, v58
  v_exp_f32 v59, v59
  v_cvt_pk_bf16_f32 v30, v56, v57
  v_exp_f32 v60, v60
  v_exp_f32 v61, v61
  v_cvt_pk_bf16_f32 v31, v58, v59
  v_exp_f32 v62, v62
  v_exp_f32 v63, v63
  s_waitcnt lgkmcnt(1)
  v_mfma_f32_32x32x16_bf16 v[84:99], v[20:23], v[28:31], v[84:99]
  s_mov_b64 exec, s[94:95]
  ds_read_b128 v[24:27], v4 offset:33280
  ds_read_b128 v[20:23], v4 offset:34816
  s_mov_b64 exec, -1
  buffer_load_dwordx4 v[172:175], v1, s[16:19], s55 offen offset:1024 sc1
  v_cvt_pk_bf16_f32 v32, v60, v61
  v_exp_f32 v64, v64
  v_exp_f32 v65, v65
  v_cvt_pk_bf16_f32 v33, v62, v63
  v_exp_f32 v66, v66
  v_exp_f32 v67, v67
  v_cvt_pk_bf16_f32 v34, v64, v65
  v_cvt_pk_bf16_f32 v35, v66, v67
  s_waitcnt lgkmcnt(2)
  v_mfma_f32_32x32x16_bf16 v[52:67], v[16:19], v[12:15], v[36:51]
  ds_read_b128 v[16:19], v2 offset:38912
  s_add_u32 s54, s8, 1024
  buffer_load_dwordx4 v[176:179], v1, s[16:19], s54 offen sc1
  v_exp_f32 v68, v68
  v_exp_f32 v69, v69
  v_exp_f32 v70, v70
  v_exp_f32 v71, v71
  v_cvt_pk_bf16_f32 v28, v68, v69
  v_exp_f32 v72, v72
  v_exp_f32 v73, v73
  v_cvt_pk_bf16_f32 v29, v70, v71
  s_waitcnt lgkmcnt(2)
  v_mfma_f32_32x32x16_bf16 v[84:99], v[24:27], v[32:35], v[84:99]
  v_exp_f32 v74, v74
  v_exp_f32 v75, v75
  v_cvt_pk_bf16_f32 v30, v72, v73
  v_exp_f32 v76, v76
  v_exp_f32 v77, v77
  v_cvt_pk_bf16_f32 v31, v74, v75
  v_exp_f32 v78, v78
  v_exp_f32 v79, v79
  s_waitcnt lgkmcnt(1)
  v_mfma_f32_32x32x16_bf16 v[84:99], v[20:23], v[28:31], v[84:99]
  s_mov_b64 exec, s[94:95]
  ds_read_b128 v[24:27], v4 offset:35328
  ds_read_b128 v[20:23], v4 offset:36864
  s_mov_b64 exec, -1
  s_add_u32 s55, s9, 16384
  buffer_load_dwordx4 v[180:183], v1, s[16:19], s55 offen offset:0 sc1
  v_cvt_pk_bf16_f32 v32, v76, v77
  v_exp_f32 v80, v80
  v_exp_f32 v81, v81
  v_cvt_pk_bf16_f32 v33, v78, v79
  v_exp_f32 v82, v82
  v_exp_f32 v83, v83
  v_cvt_pk_bf16_f32 v34, v80, v81
  v_cvt_pk_bf16_f32 v35, v82, v83
  s_waitcnt lgkmcnt(2)
  v_mfma_f32_32x32x16_bf16 v[68:83], v[16:19], v[12:15], v[36:51]
  ds_read_b128 v[16:19], v2 offset:40960
  buffer_load_dwordx4 v[184:187], v1, s[16:19], s55 offen offset:1024 sc1
  v_exp_f32 v52, v52
  v_exp_f32 v53, v53
  v_exp_f32 v54, v54
  v_exp_f32 v55, v55
  v_cvt_pk_bf16_f32 v28, v52, v53
  v_exp_f32 v56, v56
  v_exp_f32 v57, v57
  v_cvt_pk_bf16_f32 v29, v54, v55
  s_waitcnt lgkmcnt(2)
  v_mfma_f32_32x32x16_bf16 v[84:99], v[24:27], v[32:35], v[84:99]
  v_exp_f32 v58, v58
  v_exp_f32 v59, v59
  v_cvt_pk_bf16_f32 v30, v56, v57
  v_exp_f32 v60, v60
  v_exp_f32 v61, v61
  v_cvt_pk_bf16_f32 v31, v58, v59
  v_exp_f32 v62, v62
  v_exp_f32 v63, v63
  s_waitcnt lgkmcnt(1)
  v_mfma_f32_32x32x16_bf16 v[84:99], v[20:23], v[28:31], v[84:99]
  s_mov_b64 exec, s[94:95]
  ds_read_b128 v[24:27], v4 offset:37376
  ds_read_b128 v[20:23], v4 offset:38912
  s_mov_b64 exec, -1
  s_add_u32 s54, s8, 2048
  buffer_load_dwordx4 v[188:191], v1, s[16:19], s54 offen sc1
  v_cvt_pk_bf16_f32 v32, v60, v61
  v_exp_f32 v64, v64
  v_exp_f32 v65, v65
  v_cvt_pk_bf16_f32 v33, v62, v63
  v_exp_f32 v66, v66
  v_exp_f32 v67, v67
  v_cvt_pk_bf16_f32 v34, v64, v65
  v_cvt_pk_bf16_f32 v35, v66, v67
  s_setprio 0
  s_waitcnt lgkmcnt(2)
  v_mfma_f32_32x32x16_bf16 v[52:67], v[16:19], v[12:15], v[36:51]
  ds_read_b128 v[16:19], v2 offset:43008
  s_add_u32 s55, s9, 32768
  buffer_load_dwordx4 v[192:195], v1, s[16:19], s55 offen offset:0 sc1
  v_exp_f32 v68, v68
  v_exp_f32 v69, v69
  v_exp_f32 v70, v70
  v_exp_f32 v71, v71
  v_cvt_pk_bf16_f32 v28, v68, v69
  v_exp_f32 v72, v72
  v_exp_f32 v73, v73
  v_cvt_pk_bf16_f32 v29, v70, v71
  s_waitcnt lgkmcnt(2)
  v_mfma_f32_32x32x16_bf16 v[84:99], v[24:27], v[32:35], v[84:99]
  v_exp_f32 v74, v74
  v_exp_f32 v75, v75
  v_cvt_pk_bf16_f32 v30, v72, v73
  v_exp_f32 v76, v76
  v_exp_f32 v77, v77
  v_cvt_pk_bf16_f32 v31, v74, v75
  v_exp_f32 v78, v78
  v_exp_f32 v79, v79
  s_waitcnt lgkmcnt(1)
  v_mfma_f32_32x32x16_bf16 v[84:99], v[20:23], v[28:31], v[84:99]
  s_mov_b64 exec, s[94:95]
  ds_read_b128 v[24:27], v4 offset:39424
  ds_read_b128 v[20:23], v4 offset:40960
  s_mov_b64 exec, -1
  buffer_load_dwordx4 v[196:199], v1, s[16:19], s55 offen offset:1024 sc1
  v_cvt_pk_bf16_f32 v32, v76, v77
  v_exp_f32 v80, v80
  v_exp_f32 v81, v81
  v_cvt_pk_bf16_f32 v33, v78, v79
  v_exp_f32 v82, v82
  v_exp_f32 v83, v83
  v_cvt_pk_bf16_f32 v34, v80, v81
  v_cvt_pk_bf16_f32 v35, v82, v83
  s_setprio 2
  s_waitcnt lgkmcnt(2)
  v_mfma_f32_32x32x16_bf16 v[68:83], v[16:19], v[12:15], v[36:51]
  ds_read_b128 v[16:19], v2 offset:45056
  s_add_u32 s54, s8, 3072
  buffer_load_dwordx4 v[200:203], v1, s[16:19], s54 offen sc1
  v_exp_f32 v52, v52
  v_exp_f32 v53, v53
  v_exp_f32 v54, v54
  v_exp_f32 v55, v55
  v_cvt_pk_bf16_f32 v28, v52, v53
  v_exp_f32 v56, v56
  v_exp_f32 v57, v57
  v_cvt_pk_bf16_f32 v29, v54, v55
  s_waitcnt lgkmcnt(2)
  v_mfma_f32_32x32x16_bf16 v[84:99], v[24:27], v[32:35], v[84:99]
  v_exp_f32 v58, v58
  v_exp_f32 v59, v59
  v_cvt_pk_bf16_f32 v30, v56, v57
  v_exp_f32 v60, v60
  v_exp_f32 v61, v61
  v_cvt_pk_bf16_f32 v31, v58, v59
  v_exp_f32 v62, v62
  v_exp_f32 v63, v63
  s_waitcnt lgkmcnt(1)
  v_mfma_f32_32x32x16_bf16 v[84:99], v[20:23], v[28:31], v[84:99]
  s_mov_b64 exec, s[94:95]
  ds_read_b128 v[24:27], v4 offset:41472
  ds_read_b128 v[20:23], v4 offset:43008
  s_mov_b64 exec, -1
  s_add_u32 s55, s9, 49152
  buffer_load_dwordx4 v[204:207], v1, s[16:19], s55 offen offset:0 sc1
  buffer_load_dwordx4 v[208:211], v1, s[16:19], s55 offen offset:1024 sc1
  v_cvt_pk_bf16_f32 v32, v60, v61
  v_exp_f32 v64, v64
  v_exp_f32 v65, v65
  v_cvt_pk_bf16_f32 v33, v62, v63
  v_exp_f32 v66, v66
  v_exp_f32 v67, v67
  v_cvt_pk_bf16_f32 v34, v64, v65
  v_cvt_pk_bf16_f32 v35, v66, v67
  s_waitcnt lgkmcnt(2)
  v_mfma_f32_32x32x16_bf16 v[52:67], v[16:19], v[12:15], v[36:51]
  ds_read_b128 v[16:19], v2 offset:47104
  s_add_u32 s54, s8, 4096
  buffer_load_dwordx4 v[212:215], v1, s[16:19], s54 offen sc1
  v_exp_f32 v68, v68
  v_exp_f32 v69, v69
  v_exp_f32 v70, v70
  v_exp_f32 v71, v71
  v_cvt_pk_bf16_f32 v28, v68, v69
  v_exp_f32 v72, v72
  v_exp_f32 v73, v73
  v_cvt_pk_bf16_f32 v29, v70, v71
  s_waitcnt lgkmcnt(2)
  v_mfma_f32_32x32x16_bf16 v[84:99], v[24:27], v[32:35], v[84:99]
  v_exp_f32 v74, v74
  v_exp_f32 v75, v75
  v_cvt_pk_bf16_f32 v30, v72, v73
  v_exp_f32 v76, v76
  v_exp_f32 v77, v77
  v_cvt_pk_bf16_f32 v31, v74, v75
  v_exp_f32 v78, v78
  v_exp_f32 v79, v79
  s_waitcnt lgkmcnt(1)
  v_mfma_f32_32x32x16_bf16 v[84:99], v[20:23], v[28:31], v[84:99]
  s_mov_b64 exec, s[94:95]
  ds_read_b128 v[24:27], v4 offset:43520
  ds_read_b128 v[20:23], v4 offset:45056
  s_mov_b64 exec, -1
  s_add_u32 s55, s9, 65536
  buffer_load_dwordx4 v[216:219], v1, s[16:19], s55 offen offset:0 sc1
  v_cvt_pk_bf16_f32 v32, v76, v77
  v_exp_f32 v80, v80
  v_exp_f32 v81, v81
  v_cvt_pk_bf16_f32 v33, v78, v79
  s_waitcnt vmcnt(12)
  v_mfma_f32_32x32x16_bf16 v[100:115], v[168:171], v[164:167], 0
  v_exp_f32 v82, v82
  v_exp_f32 v83, v83
  v_cvt_pk_bf16_f32 v34, v80, v81
  v_cvt_pk_bf16_f32 v35, v82, v83
  s_waitcnt lgkmcnt(2)
  v_mfma_f32_32x32x16_bf16 v[68:83], v[16:19], v[12:15], v[36:51]
  ds_read_b128 v[16:19], v2 offset:49152
  buffer_load_dwordx4 v[220:223], v1, s[16:19], s55 offen offset:1024 sc1
  v_exp_f32 v52, v52
  v_exp_f32 v53, v53
  v_exp_f32 v54, v54
  v_exp_f32 v55, v55
  s_waitcnt vmcnt(12)
  v_mfma_f32_32x32x16_bf16 v[116:131], v[172:175], v[164:167], 0
  v_cvt_pk_bf16_f32 v28, v52, v53
  v_exp_f32 v56, v56
  v_exp_f32 v57, v57
  v_cvt_pk_bf16_f32 v29, v54, v55
  s_waitcnt lgkmcnt(2)
  v_mfma_f32_32x32x16_bf16 v[84:99], v[24:27], v[32:35], v[84:99]
  v_exp_f32 v58, v58
  v_exp_f32 v59, v59
  v_cvt_pk_bf16_f32 v30, v56, v57
  v_exp_f32 v60, v60
  v_exp_f32 v61, v61
  v_cvt_pk_bf16_f32 v31, v58, v59
  v_exp_f32 v62, v62
  v_exp_f32 v63, v63
  s_waitcnt lgkmcnt(1)
  v_mfma_f32_32x32x16_bf16 v[84:99], v[20:23], v[28:31], v[84:99]
  s_mov_b64 exec, s[94:95]
  ds_read_b128 v[24:27], v4 offset:45568
  ds_read_b128 v[20:23], v4 offset:47104
  s_mov_b64 exec, -1
  s_add_u32 s54, s8, 5120
  buffer_load_dwordx4 v[224:227], v1, s[16:19], s54 offen sc1
  v_cvt_pk_bf16_f32 v32, v60, v61
  v_exp_f32 v64, v64
  v_exp_f32 v65, v65
  v_cvt_pk_bf16_f32 v33, v62, v63
  v_exp_f32 v66, v66
  v_exp_f32 v67, v67
  v_cvt_pk_bf16_f32 v34, v64, v65
  v_cvt_pk_bf16_f32 v35, v66, v67
  s_setprio 0
  s_waitcnt lgkmcnt(2)
  v_mfma_f32_32x32x16_bf16 v[52:67], v[16:19], v[12:15], v[36:51]
  ds_read_b128 v[16:19], v2 offset:51200
  s_add_u32 s55, s9, 81920
  buffer_load_dwordx4 v[164:167], v1, s[16:19], s55 offen offset:0 sc1
  v_exp_f32 v68, v68
  v_exp_f32 v69, v69
  v_exp_f32 v70, v70
  v_exp_f32 v71, v71
  s_waitcnt vmcnt(12)
  v_mfma_f32_32x32x16_bf16 v[100:115], v[180:183], v[176:179], v[100:115]
  v_cvt_pk_bf16_f32 v28, v68, v69
  v_exp_f32 v72, v72
  v_exp_f32 v73, v73
  v_cvt_pk_bf16_f32 v29, v70, v71
  s_waitcnt lgkmcnt(2)
  v_mfma_f32_32x32x16_bf16 v[84:99], v[24:27], v[32:35], v[84:99]
  v_exp_f32 v74, v74
  v_exp_f32 v75, v75
  v_cvt_pk_bf16_f32 v30, v72, v73
  v_exp_f32 v76, v76
  v_exp_f32 v77, v77
  v_cvt_pk_bf16_f32 v31, v74, v75
  v_exp_f32 v78, v78
  v_exp_f32 v79, v79
  s_waitcnt lgkmcnt(1)
  v_mfma_f32_32x32x16_bf16 v[84:99], v[20:23], v[28:31], v[84:99]
  s_mov_b64 exec, s[94:95]
  ds_read_b128 v[24:27], v4 offset:47616
  ds_read_b128 v[20:23], v4 offset:49152
  s_mov_b64 exec, -1
  buffer_load_dwordx4 v[168:171], v1, s[16:19], s55 offen offset:1024 sc1
  v_cvt_pk_bf16_f32 v32, v76, v77
  v_exp_f32 v80, v80
  v_exp_f32 v81, v81
  v_cvt_pk_bf16_f32 v33, v78, v79
  s_waitcnt vmcnt(12)
  v_mfma_f32_32x32x16_bf16 v[116:131], v[184:187], v[176:179], v[116:131]
  v_exp_f32 v82, v82
  v_exp_f32 v83, v83
  v_cvt_pk_bf16_f32 v34, v80, v81
  v_cvt_pk_bf16_f32 v35, v82, v83
  s_setprio 2
  s_barrier
  s_waitcnt lgkmcnt(2)
  v_mfma_f32_32x32x16_bf16 v[68:83], v[16:19], v[12:15], v[36:51]
  ds_read_b128 v[16:19], v2 offset:53248
  s_add_u32 s54, s8, 6144
  buffer_load_dwordx4 v[172:175], v1, s[16:19], s54 offen sc1
  v_exp_f32 v52, v52
  v_exp_f32 v53, v53
  v_exp_f32 v54, v54
  v_exp_f32 v55, v55
  v_cvt_pk_bf16_f32 v28, v52, v53
  v_exp_f32 v56, v56
  v_exp_f32 v57, v57
  v_cvt_pk_bf16_f32 v29, v54, v55
  s_waitcnt lgkmcnt(2)
  v_mfma_f32_32x32x16_bf16 v[84:99], v[24:27], v[32:35], v[84:99]
  v_exp_f32 v58, v58
  v_exp_f32 v59, v59
  v_cvt_pk_bf16_f32 v30, v56, v57
  v_exp_f32 v60, v60
  v_exp_f32 v61, v61
  v_cvt_pk_bf16_f32 v31, v58, v59
  v_exp_f32 v62, v62
  v_exp_f32 v63, v63
  s_waitcnt lgkmcnt(1)
  v_mfma_f32_32x32x16_bf16 v[84:99], v[20:23], v[28:31], v[84:99]
  s_mov_b64 exec, s[94:95]
  ds_read_b128 v[24:27], v4 offset:49664
  ds_read_b128 v[20:23], v4 offset:51200
  s_mov_b64 exec, -1
  s_add_u32 s55, s9, 98304
  buffer_load_dwordx4 v[176:179], v1, s[16:19], s55 offen offset:0 sc1
  v_cvt_pk_bf16_f32 v32, v60, v61
  v_exp_f32 v64, v64
  v_exp_f32 v65, v65
  v_cvt_pk_bf16_f32 v33, v62, v63
  s_waitcnt vmcnt(12)
  v_mfma_f32_32x32x16_bf16 v[100:115], v[192:195], v[188:191], v[100:115]
  v_exp_f32 v66, v66
  v_exp_f32 v67, v67
  v_cvt_pk_bf16_f32 v34, v64, v65
  v_cvt_pk_bf16_f32 v35, v66, v67
  s_waitcnt lgkmcnt(2)
  v_mfma_f32_32x32x16_bf16 v[52:67], v[16:19], v[12:15], v[36:51]
  ds_read_b128 v[16:19], v2 offset:55296
  buffer_load_dwordx4 v[180:183], v1, s[16:19], s55 offen offset:1024 sc1
  s_add_u32 s54, s8, 7168
  buffer_load_dwordx4 v[184:187], v1, s[16:19], s54 offen sc1
  v_exp_f32 v68, v68
  v_exp_f32 v69, v69
  v_exp_f32 v70, v70
  v_exp_f32 v71, v71
  s_waitcnt vmcnt(13)
  v_mfma_f32_32x32x16_bf16 v[116:131], v[196:199], v[188:191], v[116:131]
  v_cvt_pk_bf16_f32 v28, v68, v69
  v_exp_f32 v72, v72
  v_exp_f32 v73, v73
  v_cvt_pk_bf16_f32 v29, v70, v71
  s_waitcnt lgkmcnt(2)
  v_mfma_f32_32x32x16_bf16 v[84:99], v[24:27], v[32:35], v[84:99]
  v_exp_f32 v74, v74
  v_exp_f32 v75, v75
  v_cvt_pk_bf16_f32 v30, v72, v73
  v_exp_f32 v76, v76
  v_exp_f32 v77, v77
  v_cvt_pk_bf16_f32 v31, v74, v75
  v_exp_f32 v78, v78
  v_exp_f32 v79, v79
  s_waitcnt lgkmcnt(1)
  v_mfma_f32_32x32x16_bf16 v[84:99], v[20:23], v[28:31], v[84:99]
  s_mov_b64 exec, s[94:95]
  ds_read_b128 v[24:27], v4 offset:51712
  ds_read_b128 v[20:23], v4 offset:53248
  s_mov_b64 exec, -1
  s_add_u32 s55, s9, 114688
  buffer_load_dwordx4 v[188:191], v1, s[16:19], s55 offen offset:0 sc1
  v_cvt_pk_bf16_f32 v32, v76, v77
  v_exp_f32 v80, v80
  v_exp_f32 v81, v81
  v_cvt_pk_bf16_f32 v33, v78, v79
  v_exp_f32 v82, v82
  v_exp_f32 v83, v83
  v_cvt_pk_bf16_f32 v34, v80, v81
  v_cvt_pk_bf16_f32 v35, v82, v83
  s_waitcnt lgkmcnt(2)
  v_mfma_f32_32x32x16_bf16 v[68:83], v[16:19], v[12:15], v[36:51]
  ds_read_b128 v[16:19], v2 offset:57344
  buffer_load_dwordx4 v[192:195], v1, s[16:19], s55 offen offset:1024 sc1
  v_exp_f32 v52, v52
  v_exp_f32 v53, v53
  v_exp_f32 v54, v54
  v_exp_f32 v55, v55
  s_waitcnt vmcnt(13)
  v_mfma_f32_32x32x16_bf16 v[100:115], v[204:207], v[200:203], v[100:115]
  s_waitcnt vmcnt(12)
  v_mfma_f32_32x32x16_bf16 v[116:131], v[208:211], v[200:203], v[116:131]
  v_cvt_pk_bf16_f32 v28, v52, v53
  v_exp_f32 v56, v56
  v_exp_f32 v57, v57
  v_cvt_pk_bf16_f32 v29, v54, v55
  s_waitcnt lgkmcnt(2)
  v_mfma_f32_32x32x16_bf16 v[84:99], v[24:27], v[32:35], v[84:99]
  v_exp_f32 v58, v58
  v_exp_f32 v59, v59
  v_cvt_pk_bf16_f32 v30, v56, v57
  v_exp_f32 v60, v60
  v_exp_f32 v61, v61
  v_cvt_pk_bf16_f32 v31, v58, v59
  v_exp_f32 v62, v62
  v_exp_f32 v63, v63
  s_waitcnt lgkmcnt(1)
  v_mfma_f32_32x32x16_bf16 v[84:99], v[20:23], v[28:31], v[84:99]
  s_mov_b64 exec, s[94:95]
  ds_read_b128 v[24:27], v4 offset:53760
  ds_read_b128 v[20:23], v4 offset:55296
  s_mov_b64 exec, -1
  s_add_u32 s54, s8, 8192
  buffer_load_dwordx4 v[196:199], v1, s[16:19], s54 offen sc1
  v_cvt_pk_bf16_f32 v32, v60, v61
  v_exp_f32 v64, v64
  v_exp_f32 v65, v65
  v_cvt_pk_bf16_f32 v33, v62, v63
  v_exp_f32 v66, v66
  v_exp_f32 v67, v67
  v_cvt_pk_bf16_f32 v34, v64, v65
  v_cvt_pk_bf16_f32 v35, v66, v67
  s_setprio 0
  s_waitcnt lgkmcnt(2)
  v_mfma_f32_32x32x16_bf16 v[52:67], v[16:19], v[12:15], v[36:51]
  ds_read_b128 v[16:19], v2 offset:59392
  s_add_u32 s55, s9, 131072
  buffer_load_dwordx4 v[200:203], v1, s[16:19], s55 offen offset:0 sc1
  v_exp_f32 v68, v68
  v_exp_f32 v69, v69
  v_exp_f32 v70, v70
  v_exp_f32 v71, v71
  s_waitcnt vmcnt(12)
  v_mfma_f32_32x32x16_bf16 v[100:115], v[216:219], v[212:215], v[100:115]
  v_cvt_pk_bf16_f32 v28, v68, v69
  v_exp_f32 v72, v72
  v_exp_f32 v73, v73
  v_cvt_pk_bf16_f32 v29, v70, v71
  s_waitcnt lgkmcnt(2)
  v_mfma_f32_32x32x16_bf16 v[84:99], v[24:27], v[32:35], v[84:99]
  v_exp_f32 v74, v74
  v_exp_f32 v75, v75
  v_cvt_pk_bf16_f32 v30, v72, v73
  v_exp_f32 v76, v76
  v_exp_f32 v77, v77
  v_cvt_pk_bf16_f32 v31, v74, v75
  v_exp_f32 v78, v78
  v_exp_f32 v79, v79
  s_waitcnt lgkmcnt(1)
  v_mfma_f32_32x32x16_bf16 v[84:99], v[20:23], v[28:31], v[84:99]
  s_mov_b64 exec, s[94:95]
  ds_read_b128 v[24:27], v4 offset:55808
  ds_read_b128 v[20:23], v4 offset:57344
  s_mov_b64 exec, -1
  buffer_load_dwordx4 v[204:207], v1, s[16:19], s55 offen offset:1024 sc1
  v_cvt_pk_bf16_f32 v32, v76, v77
  v_exp_f32 v80, v80
  v_exp_f32 v81, v81
  v_cvt_pk_bf16_f32 v33, v78, v79
  s_waitcnt vmcnt(12)
  v_mfma_f32_32x32x16_bf16 v[116:131], v[220:223], v[212:215], v[116:131]
  v_exp_f32 v82, v82
  v_exp_f32 v83, v83
  v_cvt_pk_bf16_f32 v34, v80, v81
  v_cvt_pk_bf16_f32 v35, v82, v83
  s_setprio 2
  s_waitcnt lgkmcnt(2)
  v_mfma_f32_32x32x16_bf16 v[68:83], v[16:19], v[12:15], v[36:51]
  ds_read_b128 v[16:19], v2 offset:61440
  s_add_u32 s54, s8, 9216
  buffer_load_dwordx4 v[208:211], v1, s[16:19], s54 offen sc1
  v_exp_f32 v52, v52
  v_exp_f32 v53, v53
  v_exp_f32 v54, v54
  v_exp_f32 v55, v55
  v_cvt_pk_bf16_f32 v28, v52, v53
  v_exp_f32 v56, v56
  v_exp_f32 v57, v57
  v_cvt_pk_bf16_f32 v29, v54, v55
  s_waitcnt lgkmcnt(2)
  v_mfma_f32_32x32x16_bf16 v[84:99], v[24:27], v[32:35], v[84:99]
  v_exp_f32 v58, v58
  v_exp_f32 v59, v59
  v_cvt_pk_bf16_f32 v30, v56, v57
  v_exp_f32 v60, v60
  v_exp_f32 v61, v61
  v_cvt_pk_bf16_f32 v31, v58, v59
  v_exp_f32 v62, v62
  v_exp_f32 v63, v63
  s_waitcnt lgkmcnt(1)
  v_mfma_f32_32x32x16_bf16 v[84:99], v[20:23], v[28:31], v[84:99]
  s_mov_b64 exec, s[94:95]
  ds_read_b128 v[24:27], v4 offset:57856
  ds_read_b128 v[20:23], v4 offset:59392
  s_mov_b64 exec, -1
  s_add_u32 s55, s9, 147456
  buffer_load_dwordx4 v[212:215], v1, s[16:19], s55 offen offset:0 sc1
  v_cvt_pk_bf16_f32 v32, v60, v61
  v_exp_f32 v64, v64
  v_exp_f32 v65, v65
  v_cvt_pk_bf16_f32 v33, v62, v63
  s_waitcnt vmcnt(12)
  v_mfma_f32_32x32x16_bf16 v[100:115], v[164:167], v[224:227], v[100:115]
  v_exp_f32 v66, v66
  v_exp_f32 v67, v67
  v_cvt_pk_bf16_f32 v34, v64, v65
  v_cvt_pk_bf16_f32 v35, v66, v67
  s_waitcnt lgkmcnt(2)
  v_mfma_f32_32x32x16_bf16 v[52:67], v[16:19], v[12:15], v[36:51]
  ds_read_b128 v[16:19], v2 offset:63488
  buffer_load_dwordx4 v[216:219], v1, s[16:19], s55 offen offset:1024 sc1
  v_exp_f32 v68, v68
  v_exp_f32 v69, v69
  v_exp_f32 v70, v70
  v_exp_f32 v71, v71
  s_waitcnt vmcnt(12)
  v_mfma_f32_32x32x16_bf16 v[116:131], v[168:171], v[224:227], v[116:131]
  v_cvt_pk_bf16_f32 v28, v68, v69
  v_exp_f32 v72, v72
  v_exp_f32 v73, v73
  v_cvt_pk_bf16_f32 v29, v70, v71
  s_waitcnt lgkmcnt(2)
  v_mfma_f32_32x32x16_bf16 v[84:99], v[24:27], v[32:35], v[84:99]
  v_exp_f32 v74, v74
  v_exp_f32 v75, v75
  v_cvt_pk_bf16_f32 v30, v72, v73
  v_exp_f32 v76, v76
  v_exp_f32 v77, v77
  v_cvt_pk_bf16_f32 v31, v74, v75
  v_exp_f32 v78, v78
  v_exp_f32 v79, v79
  s_waitcnt lgkmcnt(1)
  v_mfma_f32_32x32x16_bf16 v[84:99], v[20:23], v[28:31], v[84:99]
  s_mov_b64 exec, s[94:95]
  ds_read_b128 v[24:27], v4 offset:59904
  ds_read_b128 v[20:23], v4 offset:61440
  s_mov_b64 exec, -1
  s_add_u32 s54, s8, 10240
  buffer_load_dwordx4 v[220:223], v1, s[16:19], s54 offen sc1
  s_add_u32 s55, s9, 163840
  buffer_load_dwordx4 v[224:227], v1, s[16:19], s55 offen offset:0 sc1
  v_cvt_pk_bf16_f32 v32, v76, v77
  v_exp_f32 v80, v80
  v_exp_f32 v81, v81
  v_cvt_pk_bf16_f32 v33, v78, v79
  v_exp_f32 v82, v82
  v_exp_f32 v83, v83
  v_cvt_pk_bf16_f32 v34, v80, v81
  v_cvt_pk_bf16_f32 v35, v82, v83
  s_waitcnt lgkmcnt(2)
  v_mfma_f32_32x32x16_bf16 v[68:83], v[16:19], v[12:15], v[36:51]
  ds_read_b128 v[16:19], v3 offset:0
  buffer_load_dwordx4 v[164:167], v1, s[16:19], s55 offen offset:1024 sc1
  v_exp_f32 v52, v52
  v_exp_f32 v53, v53
  v_exp_f32 v54, v54
  v_exp_f32 v55, v55
  s_waitcnt vmcnt(13)
  v_mfma_f32_32x32x16_bf16 v[100:115], v[176:179], v[172:175], v[100:115]
  v_cvt_pk_bf16_f32 v28, v52, v53
  v_exp_f32 v56, v56
  v_exp_f32 v57, v57
  v_cvt_pk_bf16_f32 v29, v54, v55
  s_waitcnt lgkmcnt(2)
  v_mfma_f32_32x32x16_bf16 v[84:99], v[24:27], v[32:35], v[84:99]
  v_exp_f32 v58, v58
  v_exp_f32 v59, v59
  v_cvt_pk_bf16_f32 v30, v56, v57
  v_exp_f32 v60, v60
  v_exp_f32 v61, v61
  v_cvt_pk_bf16_f32 v31, v58, v59
  v_exp_f32 v62, v62
  v_exp_f32 v63, v63
  s_waitcnt lgkmcnt(1)
  v_mfma_f32_32x32x16_bf16 v[84:99], v[20:23], v[28:31], v[84:99]
  s_mov_b64 exec, s[94:95]
  ds_read_b128 v[24:27], v4 offset:61952
  ds_read_b128 v[20:23], v4 offset:63488
  s_mov_b64 exec, -1
  s_add_u32 s54, s8, 11264
  buffer_load_dwordx4 v[168:171], v1, s[16:19], s54 offen sc1
  v_cvt_pk_bf16_f32 v32, v60, v61
  v_exp_f32 v64, v64
  v_exp_f32 v65, v65
  v_cvt_pk_bf16_f32 v33, v62, v63
  s_waitcnt vmcnt(13)
  v_mfma_f32_32x32x16_bf16 v[116:131], v[180:183], v[172:175], v[116:131]
  v_exp_f32 v66, v66
  v_exp_f32 v67, v67
  v_cvt_pk_bf16_f32 v34, v64, v65
  v_cvt_pk_bf16_f32 v35, v66, v67
  s_setprio 0
  s_waitcnt lgkmcnt(2)
  v_mfma_f32_32x32x16_bf16 v[52:67], v[16:19], v[12:15], v[36:51]
  ds_read_b128 v[16:19], v3 offset:2048
  s_add_u32 s55, s9, 180224
  buffer_load_dwordx4 v[172:175], v1, s[16:19], s55 offen offset:0 sc1
  v_exp_f32 v68, v68
  v_exp_f32 v69, v69
  v_exp_f32 v70, v70
  v_exp_f32 v71, v71
  s_waitcnt vmcnt(12)
  v_mfma_f32_32x32x16_bf16 v[100:115], v[188:191], v[184:187], v[100:115]
  v_cvt_pk_bf16_f32 v28, v68, v69
  v_exp_f32 v72, v72
  v_exp_f32 v73, v73
  v_cvt_pk_bf16_f32 v29, v70, v71
  s_waitcnt lgkmcnt(2)
  v_mfma_f32_32x32x16_bf16 v[84:99], v[24:27], v[32:35], v[84:99]
  v_exp_f32 v74, v74
  v_exp_f32 v75, v75
  v_cvt_pk_bf16_f32 v30, v72, v73
  v_exp_f32 v76, v76
  v_exp_f32 v77, v77
  v_cvt_pk_bf16_f32 v31, v74, v75
  v_exp_f32 v78, v78
  v_exp_f32 v79, v79
  s_waitcnt lgkmcnt(1)
  v_mfma_f32_32x32x16_bf16 v[84:99], v[20:23], v[28:31], v[84:99]
  s_mov_b64 exec, s[94:95]
  ds_read_b128 v[24:27], v4 offset:64000
  ds_read_b128 v[20:23], v5 offset:0
  s_mov_b64 exec, -1
  buffer_load_dwordx4 v[176:179], v1, s[16:19], s55 offen offset:1024 sc1
  v_cvt_pk_bf16_f32 v32, v76, v77
  v_exp_f32 v80, v80
  v_exp_f32 v81, v81
  v_cvt_pk_bf16_f32 v33, v78, v79
  s_waitcnt vmcnt(12)
  v_mfma_f32_32x32x16_bf16 v[116:131], v[192:195], v[184:187], v[116:131]
  v_exp_f32 v82, v82
  v_exp_f32 v83, v83
  v_cvt_pk_bf16_f32 v34, v80, v81
  v_cvt_pk_bf16_f32 v35, v82, v83
  s_setprio 2
  s_waitcnt lgkmcnt(2)
  v_mfma_f32_32x32x16_bf16 v[68:83], v[16:19], v[12:15], v[36:51]
  ds_read_b128 v[16:19], v3 offset:4096
  s_add_u32 s54, s8, 12288
  buffer_load_dwordx4 v[180:183], v1, s[16:19], s54 offen sc1
  v_exp_f32 v52, v52
  v_exp_f32 v53, v53
  v_exp_f32 v54, v54
  v_exp_f32 v55, v55
  v_cvt_pk_bf16_f32 v28, v52, v53
  v_exp_f32 v56, v56
  v_exp_f32 v57, v57
  v_cvt_pk_bf16_f32 v29, v54, v55
  s_waitcnt lgkmcnt(2)
  v_mfma_f32_32x32x16_bf16 v[84:99], v[24:27], v[32:35], v[84:99]
  v_exp_f32 v58, v58
  v_exp_f32 v59, v59
  v_cvt_pk_bf16_f32 v30, v56, v57
  v_exp_f32 v60, v60
  v_exp_f32 v61, v61
  v_cvt_pk_bf16_f32 v31, v58, v59
  v_exp_f32 v62, v62
  v_exp_f32 v63, v63
  s_waitcnt lgkmcnt(1)
  v_mfma_f32_32x32x16_bf16 v[84:99], v[20:23], v[28:31], v[84:99]
  s_mov_b64 exec, s[94:95]
  ds_read_b128 v[24:27], v5 offset:512
  ds_read_b128 v[20:23], v5 offset:2048
  s_mov_b64 exec, -1
  s_add_u32 s55, s9, 196608
  buffer_load_dwordx4 v[184:187], v1, s[16:19], s55 offen offset:0 sc1
  v_cvt_pk_bf16_f32 v32, v60, v61
  v_exp_f32 v64, v64
  v_exp_f32 v65, v65
  v_cvt_pk_bf16_f32 v33, v62, v63
  s_waitcnt vmcnt(12)
  v_mfma_f32_32x32x16_bf16 v[100:115], v[200:203], v[196:199], v[100:115]
  v_exp_f32 v66, v66
  v_exp_f32 v67, v67
  v_cvt_pk_bf16_f32 v34, v64, v65
  v_cvt_pk_bf16_f32 v35, v66, v67
  s_waitcnt lgkmcnt(2)
  v_mfma_f32_32x32x16_bf16 v[52:67], v[16:19], v[12:15], v[36:51]
  ds_read_b128 v[16:19], v3 offset:6144
  buffer_load_dwordx4 v[188:191], v1, s[16:19], s55 offen offset:1024 sc1
  v_exp_f32 v68, v68
  v_exp_f32 v69, v69
  v_exp_f32 v70, v70
  v_exp_f32 v71, v71
  s_waitcnt vmcnt(12)
  v_mfma_f32_32x32x16_bf16 v[116:131], v[204:207], v[196:199], v[116:131]
  v_cvt_pk_bf16_f32 v28, v68, v69
  v_exp_f32 v72, v72
  v_exp_f32 v73, v73
  v_cvt_pk_bf16_f32 v29, v70, v71
  s_waitcnt lgkmcnt(2)
  v_mfma_f32_32x32x16_bf16 v[84:99], v[24:27], v[32:35], v[84:99]
  v_exp_f32 v74, v74
  v_exp_f32 v75, v75
  v_cvt_pk_bf16_f32 v30, v72, v73
  v_exp_f32 v76, v76
  v_exp_f32 v77, v77
  v_cvt_pk_bf16_f32 v31, v74, v75
  v_exp_f32 v78, v78
  v_exp_f32 v79, v79
  s_waitcnt lgkmcnt(1)
  v_mfma_f32_32x32x16_bf16 v[84:99], v[20:23], v[28:31], v[84:99]
  s_mov_b64 exec, s[94:95]
  ds_read_b128 v[24:27], v5 offset:2560
  ds_read_b128 v[20:23], v5 offset:4096
  s_mov_b64 exec, -1
  s_add_u32 s54, s8, 13312
  buffer_load_dwordx4 v[192:195], v1, s[16:19], s54 offen sc1
  v_cvt_pk_bf16_f32 v32, v76, v77
  v_exp_f32 v80, v80
  v_exp_f32 v81, v81
  v_cvt_pk_bf16_f32 v33, v78, v79
  v_exp_f32 v82, v82
  v_exp_f32 v83, v83
  v_cvt_pk_bf16_f32 v34, v80, v81
  v_cvt_pk_bf16_f32 v35, v82, v83
  s_waitcnt lgkmcnt(2)
  v_mfma_f32_32x32x16_bf16 v[68:83], v[16:19], v[12:15], v[36:51]
  ds_read_b128 v[16:19], v3 offset:8192
  s_add_u32 s55, s9, 212992
  buffer_load_dwordx4 v[196:199], v1, s[16:19], s55 offen offset:0 sc1
  buffer_load_dwordx4 v[200:203], v1, s[16:19], s55 offen offset:1024 sc1
  v_exp_f32 v52, v52
  v_exp_f32 v53, v53
  v_exp_f32 v54, v54
  v_exp_f32 v55, v55
  s_waitcnt vmcnt(13)
  v_mfma_f32_32x32x16_bf16 v[100:115], v[212:215], v[208:211], v[100:115]
  v_cvt_pk_bf16_f32 v28, v52, v53
  v_exp_f32 v56, v56
  v_exp_f32 v57, v57
  v_cvt_pk_bf16_f32 v29, v54, v55
  s_waitcnt lgkmcnt(2)
  v_mfma_f32_32x32x16_bf16 v[84:99], v[24:27], v[32:35], v[84:99]
  v_exp_f32 v58, v58
  v_exp_f32 v59, v59
  v_cvt_pk_bf16_f32 v30, v56, v57
  v_exp_f32 v60, v60
  v_exp_f32 v61, v61
  v_cvt_pk_bf16_f32 v31, v58, v59
  v_exp_f32 v62, v62
  v_exp_f32 v63, v63
  s_waitcnt lgkmcnt(1)
  v_mfma_f32_32x32x16_bf16 v[84:99], v[20:23], v[28:31], v[84:99]
  s_mov_b64 exec, s[94:95]
  ds_read_b128 v[24:27], v5 offset:4608
  ds_read_b128 v[20:23], v5 offset:6144
  s_mov_b64 exec, -1
  s_add_u32 s54, s8, 14336
  buffer_load_dwordx4 v[204:207], v1, s[16:19], s54 offen sc1
  v_cvt_pk_bf16_f32 v32, v60, v61
  v_exp_f32 v64, v64
  v_exp_f32 v65, v65
  v_cvt_pk_bf16_f32 v33, v62, v63
  s_waitcnt vmcnt(13)
  v_mfma_f32_32x32x16_bf16 v[116:131], v[216:219], v[208:211], v[116:131]
  v_exp_f32 v66, v66
  v_exp_f32 v67, v67
  v_cvt_pk_bf16_f32 v34, v64, v65
  v_cvt_pk_bf16_f32 v35, v66, v67
  s_setprio 0
  s_waitcnt lgkmcnt(2)
  v_mfma_f32_32x32x16_bf16 v[52:67], v[16:19], v[12:15], v[36:51]
  ds_read_b128 v[16:19], v3 offset:10240
  s_add_u32 s55, s9, 229376
  buffer_load_dwordx4 v[208:211], v1, s[16:19], s55 offen offset:0 sc1
  v_exp_f32 v68, v68
  v_exp_f32 v69, v69
  v_exp_f32 v70, v70
  v_exp_f32 v71, v71
  s_waitcnt vmcnt(12)
  v_mfma_f32_32x32x16_bf16 v[100:115], v[224:227], v[220:223], v[100:115]
  v_cvt_pk_bf16_f32 v28, v68, v69
  v_exp_f32 v72, v72
  v_exp_f32 v73, v73
  v_cvt_pk_bf16_f32 v29, v70, v71
  s_waitcnt lgkmcnt(2)
  v_mfma_f32_32x32x16_bf16 v[84:99], v[24:27], v[32:35], v[84:99]
  v_exp_f32 v74, v74
  v_exp_f32 v75, v75
  v_cvt_pk_bf16_f32 v30, v72, v73
  v_exp_f32 v76, v76
  v_exp_f32 v77, v77
  v_cvt_pk_bf16_f32 v31, v74, v75
  v_exp_f32 v78, v78
  v_exp_f32 v79, v79
  s_waitcnt lgkmcnt(1)
  v_mfma_f32_32x32x16_bf16 v[84:99], v[20:23], v[28:31], v[84:99]
  s_mov_b64 exec, s[94:95]
  ds_read_b128 v[24:27], v5 offset:6656
  ds_read_b128 v[20:23], v5 offset:8192
  s_mov_b64 exec, -1
  buffer_load_dwordx4 v[212:215], v1, s[16:19], s55 offen offset:1024 sc1
  v_cvt_pk_bf16_f32 v32, v76, v77
  v_exp_f32 v80, v80
  v_exp_f32 v81, v81
  v_cvt_pk_bf16_f32 v33, v78, v79
  s_waitcnt vmcnt(12)
  v_mfma_f32_32x32x16_bf16 v[116:131], v[164:167], v[220:223], v[116:131]
  v_exp_f32 v82, v82
  v_exp_f32 v83, v83
  v_cvt_pk_bf16_f32 v34, v80, v81
  v_cvt_pk_bf16_f32 v35, v82, v83
  s_setprio 2
  s_waitcnt lgkmcnt(2)
  v_mfma_f32_32x32x16_bf16 v[68:83], v[16:19], v[12:15], v[36:51]
  ds_read_b128 v[16:19], v3 offset:12288
  s_add_u32 s54, s8, 15360
  buffer_load_dwordx4 v[216:219], v1, s[16:19], s54 offen sc1
  v_exp_f32 v52, v52
  v_exp_f32 v53, v53
  v_exp_f32 v54, v54
  v_exp_f32 v55, v55
  v_cvt_pk_bf16_f32 v28, v52, v53
  v_exp_f32 v56, v56
  v_exp_f32 v57, v57
  v_cvt_pk_bf16_f32 v29, v54, v55
  s_waitcnt lgkmcnt(2)
  v_mfma_f32_32x32x16_bf16 v[84:99], v[24:27], v[32:35], v[84:99]
  v_exp_f32 v58, v58
  v_exp_f32 v59, v59
  v_cvt_pk_bf16_f32 v30, v56, v57
  v_exp_f32 v60, v60
  v_exp_f32 v61, v61
  v_cvt_pk_bf16_f32 v31, v58, v59
  v_exp_f32 v62, v62
  v_exp_f32 v63, v63
  s_waitcnt lgkmcnt(1)
  v_mfma_f32_32x32x16_bf16 v[84:99], v[20:23], v[28:31], v[84:99]
  s_mov_b64 exec, s[94:95]
  ds_read_b128 v[24:27], v5 offset:8704
  ds_read_b128 v[20:23], v5 offset:10240
  s_mov_b64 exec, -1
  s_add_u32 s55, s9, 245760
  buffer_load_dwordx4 v[220:223], v1, s[16:19], s55 offen offset:0 sc1
  v_cvt_pk_bf16_f32 v32, v60, v61
  v_exp_f32 v64, v64
  v_exp_f32 v65, v65
  v_cvt_pk_bf16_f32 v33, v62, v63
  s_waitcnt vmcnt(12)
  v_mfma_f32_32x32x16_bf16 v[100:115], v[172:175], v[168:171], v[100:115]
  v_exp_f32 v66, v66
  v_exp_f32 v67, v67
  v_cvt_pk_bf16_f32 v34, v64, v65
  v_cvt_pk_bf16_f32 v35, v66, v67
  s_waitcnt lgkmcnt(2)
  v_mfma_f32_32x32x16_bf16 v[52:67], v[16:19], v[12:15], v[36:51]
  ds_read_b128 v[16:19], v3 offset:14336
  buffer_load_dwordx4 v[224:227], v1, s[16:19], s55 offen offset:1024 sc1
  v_exp_f32 v68, v68
  v_exp_f32 v69, v69
  v_exp_f32 v70, v70
  v_exp_f32 v71, v71
  s_waitcnt vmcnt(12)
  v_mfma_f32_32x32x16_bf16 v[116:131], v[176:179], v[168:171], v[116:131]
  v_cvt_pk_bf16_f32 v28, v68, v69
  v_exp_f32 v72, v72
  v_exp_f32 v73, v73
  v_cvt_pk_bf16_f32 v29, v70, v71
  s_waitcnt lgkmcnt(2)
  v_mfma_f32_32x32x16_bf16 v[84:99], v[24:27], v[32:35], v[84:99]
  v_exp_f32 v74, v74
  v_exp_f32 v75, v75
  v_cvt_pk_bf16_f32 v30, v72, v73
  v_exp_f32 v76, v76
  v_exp_f32 v77, v77
  v_cvt_pk_bf16_f32 v31, v74, v75
  v_exp_f32 v78, v78
  v_exp_f32 v79, v79
  s_waitcnt lgkmcnt(1)
  v_mfma_f32_32x32x16_bf16 v[84:99], v[20:23], v[28:31], v[84:99]
  s_mov_b64 exec, s[94:95]
  ds_read_b128 v[24:27], v5 offset:10752
  ds_read_b128 v[20:23], v5 offset:12288
  s_mov_b64 exec, -1
  s_add_u32 s54, s8, 16384
  buffer_load_dwordx4 v[164:167], v1, s[16:19], s54 offen sc1
  v_cvt_pk_bf16_f32 v32, v76, v77
  v_exp_f32 v80, v80
  v_exp_f32 v81, v81
  v_cvt_pk_bf16_f32 v33, v78, v79
  v_exp_f32 v82, v82
  v_exp_f32 v83, v83
  v_cvt_pk_bf16_f32 v34, v80, v81
  v_cvt_pk_bf16_f32 v35, v82, v83
  s_waitcnt lgkmcnt(2)
  v_mfma_f32_32x32x16_bf16 v[68:83], v[16:19], v[12:15], v[36:51]
  ds_read_b128 v[16:19], v3 offset:16384
  s_add_u32 s55, s9, 262144
  buffer_load_dwordx4 v[168:171], v1, s[16:19], s55 offen offset:0 sc1
  v_exp_f32 v52, v52
  v_exp_f32 v53, v53
  v_exp_f32 v54, v54
  v_exp_f32 v55, v55
  s_waitcnt vmcnt(12)
  v_mfma_f32_32x32x16_bf16 v[100:115], v[184:187], v[180:183], v[100:115]
  v_cvt_pk_bf16_f32 v28, v52, v53
  v_exp_f32 v56, v56
  v_exp_f32 v57, v57
  v_cvt_pk_bf16_f32 v29, v54, v55
  s_waitcnt lgkmcnt(2)
  v_mfma_f32_32x32x16_bf16 v[84:99], v[24:27], v[32:35], v[84:99]
  v_exp_f32 v58, v58
  v_exp_f32 v59, v59
  v_cvt_pk_bf16_f32 v30, v56, v57
  v_exp_f32 v60, v60
  v_exp_f32 v61, v61
  v_cvt_pk_bf16_f32 v31, v58, v59
  v_exp_f32 v62, v62
  v_exp_f32 v63, v63
  s_waitcnt lgkmcnt(1)
  v_mfma_f32_32x32x16_bf16 v[84:99], v[20:23], v[28:31], v[84:99]
  s_mov_b64 exec, s[94:95]
  ds_read_b128 v[24:27], v5 offset:12800
  ds_read_b128 v[20:23], v5 offset:14336
  s_mov_b64 exec, -1
  buffer_load_dwordx4 v[172:175], v1, s[16:19], s55 offen offset:1024 sc1
  s_add_u32 s54, s8, 17408
  buffer_load_dwordx4 v[176:179], v1, s[16:19], s54 offen sc1
  v_cvt_pk_bf16_f32 v32, v60, v61
  v_exp_f32 v64, v64
  v_exp_f32 v65, v65
  v_cvt_pk_bf16_f32 v33, v62, v63
  s_waitcnt vmcnt(13)
  v_mfma_f32_32x32x16_bf16 v[116:131], v[188:191], v[180:183], v[116:131]
  v_exp_f32 v66, v66
  v_exp_f32 v67, v67
  v_cvt_pk_bf16_f32 v34, v64, v65
  v_cvt_pk_bf16_f32 v35, v66, v67
  s_setprio 0
  s_waitcnt lgkmcnt(2)
  v_mfma_f32_32x32x16_bf16 v[52:67], v[16:19], v[12:15], v[36:51]
  ds_read_b128 v[16:19], v3 offset:18432
  s_add_u32 s55, s9, 278528
  buffer_load_dwordx4 v[180:183], v1, s[16:19], s55 offen offset:0 sc1
  v_exp_f32 v68, v68
  v_exp_f32 v69, v69
  v_exp_f32 v70, v70
  v_exp_f32 v71, v71
  v_cvt_pk_bf16_f32 v28, v68, v69
  v_exp_f32 v72, v72
  v_exp_f32 v73, v73
  v_cvt_pk_bf16_f32 v29, v70, v71
  s_waitcnt lgkmcnt(2)
  v_mfma_f32_32x32x16_bf16 v[84:99], v[24:27], v[32:35], v[84:99]
  v_exp_f32 v74, v74
  v_exp_f32 v75, v75
  v_cvt_pk_bf16_f32 v30, v72, v73
  v_exp_f32 v76, v76
  v_exp_f32 v77, v77
  v_cvt_pk_bf16_f32 v31, v74, v75
  v_exp_f32 v78, v78
  v_exp_f32 v79, v79
  s_waitcnt lgkmcnt(1)
  v_mfma_f32_32x32x16_bf16 v[84:99], v[20:23], v[28:31], v[84:99]
  s_mov_b64 exec, s[94:95]
  ds_read_b128 v[24:27], v5 offset:14848
  ds_read_b128 v[20:23], v5 offset:16384
  s_mov_b64 exec, -1
  buffer_load_dwordx4 v[184:187], v1, s[16:19], s55 offen offset:1024 sc1
  v_cvt_pk_bf16_f32 v32, v76, v77
  v_exp_f32 v80, v80
  v_exp_f32 v81, v81
  v_cvt_pk_bf16_f32 v33, v78, v79
  s_waitcnt vmcnt(13)
  v_mfma_f32_32x32x16_bf16 v[100:115], v[196:199], v[192:195], v[100:115]
  s_waitcnt vmcnt(12)
  v_mfma_f32_32x32x16_bf16 v[116:131], v[200:203], v[192:195], v[116:131]
  v_exp_f32 v82, v82
  v_exp_f32 v83, v83
  v_cvt_pk_bf16_f32 v34, v80, v81
  v_cvt_pk_bf16_f32 v35, v82, v83
  s_setprio 2
  s_waitcnt lgkmcnt(2)
  v_mfma_f32_32x32x16_bf16 v[68:83], v[16:19], v[12:15], v[36:51]
  ds_read_b128 v[16:19], v3 offset:20480
  s_add_u32 s54, s8, 18432
  buffer_load_dwordx4 v[188:191], v1, s[16:19], s54 offen sc1
  v_exp_f32 v52, v52
  v_exp_f32 v53, v53
  v_exp_f32 v54, v54
  v_exp_f32 v55, v55
  v_cvt_pk_bf16_f32 v28, v52, v53
  v_exp_f32 v56, v56
  v_exp_f32 v57, v57
  v_cvt_pk_bf16_f32 v29, v54, v55
  s_waitcnt lgkmcnt(2)
  v_mfma_f32_32x32x16_bf16 v[84:99], v[24:27], v[32:35], v[84:99]
  v_exp_f32 v58, v58
  v_exp_f32 v59, v59
  v_cvt_pk_bf16_f32 v30, v56, v57
  v_exp_f32 v60, v60
  v_exp_f32 v61, v61
  v_cvt_pk_bf16_f32 v31, v58, v59
  v_exp_f32 v62, v62
  v_exp_f32 v63, v63
  s_waitcnt lgkmcnt(1)
  v_mfma_f32_32x32x16_bf16 v[84:99], v[20:23], v[28:31], v[84:99]
  s_mov_b64 exec, s[94:95]
  ds_read_b128 v[24:27], v5 offset:16896
  ds_read_b128 v[20:23], v5 offset:18432
  s_mov_b64 exec, -1
  s_add_u32 s55, s9, 294912
  buffer_load_dwordx4 v[192:195], v1, s[16:19], s55 offen offset:0 sc1
  v_cvt_pk_bf16_f32 v32, v60, v61
  v_exp_f32 v64, v64
  v_exp_f32 v65, v65
  v_cvt_pk_bf16_f32 v33, v62, v63
  s_waitcnt vmcnt(12)
  v_mfma_f32_32x32x16_bf16 v[100:115], v[208:211], v[204:207], v[100:115]
  v_exp_f32 v66, v66
  v_exp_f32 v67, v67
  v_cvt_pk_bf16_f32 v34, v64, v65
  v_cvt_pk_bf16_f32 v35, v66, v67
  s_waitcnt lgkmcnt(2)
  v_mfma_f32_32x32x16_bf16 v[52:67], v[16:19], v[12:15], v[36:51]
  ds_read_b128 v[16:19], v3 offset:22528
  buffer_load_dwordx4 v[196:199], v1, s[16:19], s55 offen offset:1024 sc1
  v_exp_f32 v68, v68
  v_exp_f32 v69, v69
  v_exp_f32 v70, v70
  v_exp_f32 v71, v71
  s_waitcnt vmcnt(12)
  v_mfma_f32_32x32x16_bf16 v[116:131], v[212:215], v[204:207], v[116:131]
  v_cvt_pk_bf16_f32 v28, v68, v69
  v_exp_f32 v72, v72
  v_exp_f32 v73, v73
  v_cvt_pk_bf16_f32 v29, v70, v71
  s_waitcnt lgkmcnt(2)
  v_mfma_f32_32x32x16_bf16 v[84:99], v[24:27], v[32:35], v[84:99]
  v_exp_f32 v74, v74
  v_exp_f32 v75, v75
  v_cvt_pk_bf16_f32 v30, v72, v73
  v_exp_f32 v76, v76
  v_exp_f32 v77, v77
  v_cvt_pk_bf16_f32 v31, v74, v75
  v_exp_f32 v78, v78
  v_exp_f32 v79, v79
  s_waitcnt lgkmcnt(1)
  v_mfma_f32_32x32x16_bf16 v[84:99], v[20:23], v[28:31], v[84:99]
  s_mov_b64 exec, s[94:95]
  ds_read_b128 v[24:27], v5 offset:18944
  ds_read_b128 v[20:23], v5 offset:20480
  s_mov_b64 exec, -1
  s_add_u32 s54, s8, 19456
  buffer_load_dwordx4 v[200:203], v1, s[16:19], s54 offen sc1
  v_cvt_pk_bf16_f32 v32, v76, v77
  v_exp_f32 v80, v80
  v_exp_f32 v81, v81
  v_cvt_pk_bf16_f32 v33, v78, v79
  v_exp_f32 v82, v82
  v_exp_f32 v83, v83
  v_cvt_pk_bf16_f32 v34, v80, v81
  v_cvt_pk_bf16_f32 v35, v82, v83
  s_waitcnt lgkmcnt(2)
  v_mfma_f32_32x32x16_bf16 v[68:83], v[16:19], v[12:15], v[36:51]
  ds_read_b128 v[16:19], v3 offset:24576
  s_add_u32 s55, s9, 311296
  buffer_load_dwordx4 v[204:207], v1, s[16:19], s55 offen offset:0 sc1
  v_exp_f32 v52, v52
  v_exp_f32 v53, v53
  v_exp_f32 v54, v54
  v_exp_f32 v55, v55
  s_waitcnt vmcnt(12)
  v_mfma_f32_32x32x16_bf16 v[100:115], v[220:223], v[216:219], v[100:115]
  v_cvt_pk_bf16_f32 v28, v52, v53
  v_exp_f32 v56, v56
  v_exp_f32 v57, v57
  v_cvt_pk_bf16_f32 v29, v54, v55
  s_waitcnt lgkmcnt(2)
  v_mfma_f32_32x32x16_bf16 v[84:99], v[24:27], v[32:35], v[84:99]
  v_exp_f32 v58, v58
  v_exp_f32 v59, v59
  v_cvt_pk_bf16_f32 v30, v56, v57
  v_exp_f32 v60, v60
  v_exp_f32 v61, v61
  v_cvt_pk_bf16_f32 v31, v58, v59
  v_exp_f32 v62, v62
  v_exp_f32 v63, v63
  s_waitcnt lgkmcnt(1)
  v_mfma_f32_32x32x16_bf16 v[84:99], v[20:23], v[28:31], v[84:99]
  s_mov_b64 exec, s[94:95]
  ds_read_b128 v[24:27], v5 offset:20992
  ds_read_b128 v[20:23], v5 offset:22528
  s_mov_b64 exec, -1
  buffer_load_dwordx4 v[208:211], v1, s[16:19], s55 offen offset:1024 sc1
  v_cvt_pk_bf16_f32 v32, v60, v61
  v_exp_f32 v64, v64
  v_exp_f32 v65, v65
  v_cvt_pk_bf16_f32 v33, v62, v63
  s_waitcnt vmcnt(12)
  v_mfma_f32_32x32x16_bf16 v[116:131], v[224:227], v[216:219], v[116:131]
  v_exp_f32 v66, v66
  v_exp_f32 v67, v67
  v_cvt_pk_bf16_f32 v34, v64, v65
  v_cvt_pk_bf16_f32 v35, v66, v67
  s_setprio 0
  s_waitcnt lgkmcnt(2)
  v_mfma_f32_32x32x16_bf16 v[52:67], v[16:19], v[12:15], v[36:51]
  ds_read_b128 v[16:19], v3 offset:26624
  s_add_u32 s54, s8, 20480
  buffer_load_dwordx4 v[212:215], v1, s[16:19], s54 offen sc1
  s_add_u32 s55, s9, 327680
  buffer_load_dwordx4 v[216:219], v1, s[16:19], s55 offen offset:0 sc1
  v_exp_f32 v68, v68
  v_exp_f32 v69, v69
  v_exp_f32 v70, v70
  v_exp_f32 v71, v71
  v_cvt_pk_bf16_f32 v28, v68, v69
  v_exp_f32 v72, v72
  v_exp_f32 v73, v73
  v_cvt_pk_bf16_f32 v29, v70, v71
  s_waitcnt lgkmcnt(2)
  v_mfma_f32_32x32x16_bf16 v[84:99], v[24:27], v[32:35], v[84:99]
  v_exp_f32 v74, v74
  v_exp_f32 v75, v75
  v_cvt_pk_bf16_f32 v30, v72, v73
  v_exp_f32 v76, v76
  v_exp_f32 v77, v77
  v_cvt_pk_bf16_f32 v31, v74, v75
  v_exp_f32 v78, v78
  v_exp_f32 v79, v79
  s_waitcnt lgkmcnt(1)
  v_mfma_f32_32x32x16_bf16 v[84:99], v[20:23], v[28:31], v[84:99]
  s_mov_b64 exec, s[94:95]
  ds_read_b128 v[24:27], v5 offset:23040
  ds_read_b128 v[20:23], v5 offset:24576
  s_mov_b64 exec, -1
  buffer_load_dwordx4 v[220:223], v1, s[16:19], s55 offen offset:1024 sc1
  v_cvt_pk_bf16_f32 v32, v76, v77
  v_exp_f32 v80, v80
  v_exp_f32 v81, v81
  v_cvt_pk_bf16_f32 v33, v78, v79
  s_waitcnt vmcnt(13)
  v_mfma_f32_32x32x16_bf16 v[100:115], v[168:171], v[164:167], v[100:115]
  v_exp_f32 v82, v82
  v_exp_f32 v83, v83
  v_cvt_pk_bf16_f32 v34, v80, v81
  v_cvt_pk_bf16_f32 v35, v82, v83
  s_setprio 2
  s_waitcnt lgkmcnt(2)
  v_mfma_f32_32x32x16_bf16 v[68:83], v[16:19], v[12:15], v[36:51]
  ds_read_b128 v[16:19], v3 offset:28672
  s_add_u32 s54, s8, 21504
  buffer_load_dwordx4 v[224:227], v1, s[16:19], s54 offen sc1
  v_exp_f32 v52, v52
  v_exp_f32 v53, v53
  v_exp_f32 v54, v54
  v_exp_f32 v55, v55
  s_waitcnt vmcnt(13)
  v_mfma_f32_32x32x16_bf16 v[116:131], v[172:175], v[164:167], v[116:131]
  v_cvt_pk_bf16_f32 v28, v52, v53
  v_exp_f32 v56, v56
  v_exp_f32 v57, v57
  v_cvt_pk_bf16_f32 v29, v54, v55
  s_waitcnt lgkmcnt(2)
  v_mfma_f32_32x32x16_bf16 v[84:99], v[24:27], v[32:35], v[84:99]
  v_exp_f32 v58, v58
  v_exp_f32 v59, v59
  v_cvt_pk_bf16_f32 v30, v56, v57
  v_exp_f32 v60, v60
  v_exp_f32 v61, v61
  v_cvt_pk_bf16_f32 v31, v58, v59
  v_exp_f32 v62, v62
  v_exp_f32 v63, v63
  s_waitcnt lgkmcnt(1)
  v_mfma_f32_32x32x16_bf16 v[84:99], v[20:23], v[28:31], v[84:99]
  s_mov_b64 exec, s[94:95]
  ds_read_b128 v[24:27], v5 offset:25088
  ds_read_b128 v[20:23], v5 offset:26624
  s_mov_b64 exec, -1
  s_add_u32 s55, s9, 344064
  buffer_load_dwordx4 v[164:167], v1, s[16:19], s55 offen offset:0 sc1
  v_cvt_pk_bf16_f32 v32, v60, v61
  v_exp_f32 v64, v64
  v_exp_f32 v65, v65
  v_cvt_pk_bf16_f32 v33, v62, v63
  s_waitcnt vmcnt(12)
  v_mfma_f32_32x32x16_bf16 v[100:115], v[180:183], v[176:179], v[100:115]
  v_exp_f32 v66, v66
  v_exp_f32 v67, v67
  v_cvt_pk_bf16_f32 v34, v64, v65
  v_cvt_pk_bf16_f32 v35, v66, v67
  s_waitcnt lgkmcnt(2)
  v_mfma_f32_32x32x16_bf16 v[52:67], v[16:19], v[12:15], v[36:51]
  ds_read_b128 v[16:19], v3 offset:30720
  buffer_load_dwordx4 v[168:171], v1, s[16:19], s55 offen offset:1024 sc1
  v_exp_f32 v68, v68
  v_exp_f32 v69, v69
  v_exp_f32 v70, v70
  v_exp_f32 v71, v71
  s_waitcnt vmcnt(12)
  v_mfma_f32_32x32x16_bf16 v[116:131], v[184:187], v[176:179], v[116:131]
  v_cvt_pk_bf16_f32 v28, v68, v69
  v_exp_f32 v72, v72
  v_exp_f32 v73, v73
  v_cvt_pk_bf16_f32 v29, v70, v71
  s_waitcnt lgkmcnt(2)
  v_mfma_f32_32x32x16_bf16 v[84:99], v[24:27], v[32:35], v[84:99]
  v_exp_f32 v74, v74
  v_exp_f32 v75, v75
  v_cvt_pk_bf16_f32 v30, v72, v73
  v_exp_f32 v76, v76
  v_exp_f32 v77, v77
  v_cvt_pk_bf16_f32 v31, v74, v75
  v_exp_f32 v78, v78
  v_exp_f32 v79, v79
  s_waitcnt lgkmcnt(1)
  v_mfma_f32_32x32x16_bf16 v[84:99], v[20:23], v[28:31], v[84:99]
  s_mov_b64 exec, s[94:95]
  ds_read_b128 v[24:27], v5 offset:27136
  ds_read_b128 v[20:23], v5 offset:28672
  s_mov_b64 exec, -1
  s_add_u32 s54, s8, 22528
  buffer_load_dwordx4 v[172:175], v1, s[16:19], s54 offen sc1
  v_cvt_pk_bf16_f32 v32, v76, v77
  v_exp_f32 v80, v80
  v_exp_f32 v81, v81
  v_cvt_pk_bf16_f32 v33, v78, v79
  v_exp_f32 v82, v82
  v_exp_f32 v83, v83
  v_cvt_pk_bf16_f32 v34, v80, v81
  v_cvt_pk_bf16_f32 v35, v82, v83
  s_waitcnt lgkmcnt(2)
  v_mfma_f32_32x32x16_bf16 v[68:83], v[16:19], v[12:15], v[36:51]
  ds_read_b128 v[16:19], v3 offset:32768
  s_add_u32 s55, s9, 360448
  buffer_load_dwordx4 v[176:179], v1, s[16:19], s55 offen offset:0 sc1
  v_exp_f32 v52, v52
  v_exp_f32 v53, v53
  v_exp_f32 v54, v54
  v_exp_f32 v55, v55
  s_waitcnt vmcnt(12)
  v_mfma_f32_32x32x16_bf16 v[100:115], v[192:195], v[188:191], v[100:115]
  v_cvt_pk_bf16_f32 v28, v52, v53
  v_exp_f32 v56, v56
  v_exp_f32 v57, v57
  v_cvt_pk_bf16_f32 v29, v54, v55
  s_waitcnt lgkmcnt(2)
  v_mfma_f32_32x32x16_bf16 v[84:99], v[24:27], v[32:35], v[84:99]
  v_exp_f32 v58, v58
  v_exp_f32 v59, v59
  v_cvt_pk_bf16_f32 v30, v56, v57
  v_exp_f32 v60, v60
  v_exp_f32 v61, v61
  v_cvt_pk_bf16_f32 v31, v58, v59
  v_exp_f32 v62, v62
  v_exp_f32 v63, v63
  s_waitcnt lgkmcnt(1)
  v_mfma_f32_32x32x16_bf16 v[84:99], v[20:23], v[28:31], v[84:99]
  s_mov_b64 exec, s[94:95]
  ds_read_b128 v[24:27], v5 offset:29184
  ds_read_b128 v[20:23], v5 offset:30720
  s_mov_b64 exec, -1
  buffer_load_dwordx4 v[180:183], v1, s[16:19], s55 offen offset:1024 sc1
  v_cvt_pk_bf16_f32 v32, v60, v61
  v_exp_f32 v64, v64
  v_exp_f32 v65, v65
  v_cvt_pk_bf16_f32 v33, v62, v63
  s_waitcnt vmcnt(12)
  v_mfma_f32_32x32x16_bf16 v[116:131], v[196:199], v[188:191], v[116:131]
  v_exp_f32 v66, v66
  v_exp_f32 v67, v67
  v_cvt_pk_bf16_f32 v34, v64, v65
  v_cvt_pk_bf16_f32 v35, v66, v67
  s_setprio 0
  s_waitcnt lgkmcnt(2)
  v_mfma_f32_32x32x16_bf16 v[52:67], v[16:19], v[12:15], v[36:51]
  ds_read_b128 v[16:19], v3 offset:34816
  s_add_u32 s54, s8, 23552
  buffer_load_dwordx4 v[184:187], v1, s[16:19], s54 offen sc1
  v_exp_f32 v68, v68
  v_exp_f32 v69, v69
  v_exp_f32 v70, v70
  v_exp_f32 v71, v71
  v_cvt_pk_bf16_f32 v28, v68, v69
  v_exp_f32 v72, v72
  v_exp_f32 v73, v73
  v_cvt_pk_bf16_f32 v29, v70, v71
  s_waitcnt lgkmcnt(2)
  v_mfma_f32_32x32x16_bf16 v[84:99], v[24:27], v[32:35], v[84:99]
  v_exp_f32 v74, v74
  v_exp_f32 v75, v75
  v_cvt_pk_bf16_f32 v30, v72, v73
  v_exp_f32 v76, v76
  v_exp_f32 v77, v77
  v_cvt_pk_bf16_f32 v31, v74, v75
  v_exp_f32 v78, v78
  v_exp_f32 v79, v79
  s_waitcnt lgkmcnt(1)
  v_mfma_f32_32x32x16_bf16 v[84:99], v[20:23], v[28:31], v[84:99]
  s_mov_b64 exec, s[94:95]
  ds_read_b128 v[24:27], v5 offset:31232
  ds_read_b128 v[20:23], v5 offset:32768
  s_mov_b64 exec, -1
  s_add_u32 s55, s9, 376832
  buffer_load_dwordx4 v[188:191], v1, s[16:19], s55 offen offset:0 sc1
  buffer_load_dwordx4 v[192:195], v1, s[16:19], s55 offen offset:1024 sc1
  v_cvt_pk_bf16_f32 v32, v76, v77
  v_exp_f32 v80, v80
  v_exp_f32 v81, v81
  v_cvt_pk_bf16_f32 v33, v78, v79
  s_waitcnt vmcnt(13)
  v_mfma_f32_32x32x16_bf16 v[100:115], v[204:207], v[200:203], v[100:115]
  v_exp_f32 v82, v82
  v_exp_f32 v83, v83
  v_cvt_pk_bf16_f32 v34, v80, v81
  v_cvt_pk_bf16_f32 v35, v82, v83
  s_setprio 2
  s_waitcnt lgkmcnt(2)
  v_mfma_f32_32x32x16_bf16 v[68:83], v[16:19], v[12:15], v[36:51]
  ds_read_b128 v[16:19], v3 offset:36864
  s_add_u32 s54, s8, 24576
  buffer_load_dwordx4 v[196:199], v1, s[16:19], s54 offen sc1
  v_exp_f32 v52, v52
  v_exp_f32 v53, v53
  v_exp_f32 v54, v54
  v_exp_f32 v55, v55
  s_waitcnt vmcnt(13)
  v_mfma_f32_32x32x16_bf16 v[116:131], v[208:211], v[200:203], v[116:131]
  v_cvt_pk_bf16_f32 v28, v52, v53
  v_exp_f32 v56, v56
  v_exp_f32 v57, v57
  v_cvt_pk_bf16_f32 v29, v54, v55
  s_waitcnt lgkmcnt(2)
  v_mfma_f32_32x32x16_bf16 v[84:99], v[24:27], v[32:35], v[84:99]
  v_exp_f32 v58, v58
  v_exp_f32 v59, v59
  v_cvt_pk_bf16_f32 v30, v56, v57
  v_exp_f32 v60, v60
  v_exp_f32 v61, v61
  v_cvt_pk_bf16_f32 v31, v58, v59
  v_exp_f32 v62, v62
  v_exp_f32 v63, v63
  s_waitcnt lgkmcnt(1)
  v_mfma_f32_32x32x16_bf16 v[84:99], v[20:23], v[28:31], v[84:99]
  s_mov_b64 exec, s[94:95]
  ds_read_b128 v[24:27], v5 offset:33280
  ds_read_b128 v[20:23], v5 offset:34816
  s_mov_b64 exec, -1
  s_add_u32 s55, s9, 393216
  buffer_load_dwordx4 v[200:203], v1, s[16:19], s55 offen offset:0 sc1
  v_cvt_pk_bf16_f32 v32, v60, v61
  v_exp_f32 v64, v64
  v_exp_f32 v65, v65
  v_cvt_pk_bf16_f32 v33, v62, v63
  s_waitcnt vmcnt(12)
  v_mfma_f32_32x32x16_bf16 v[100:115], v[216:219], v[212:215], v[100:115]
  v_exp_f32 v66, v66
  v_exp_f32 v67, v67
  v_cvt_pk_bf16_f32 v34, v64, v65
  v_cvt_pk_bf16_f32 v35, v66, v67
  s_waitcnt lgkmcnt(2)
  v_mfma_f32_32x32x16_bf16 v[52:67], v[16:19], v[12:15], v[36:51]
  ds_read_b128 v[16:19], v3 offset:38912
  buffer_load_dwordx4 v[204:207], v1, s[16:19], s55 offen offset:1024 sc1
  v_exp_f32 v68, v68
  v_exp_f32 v69, v69
  v_exp_f32 v70, v70
  v_exp_f32 v71, v71
  s_waitcnt vmcnt(12)
  v_mfma_f32_32x32x16_bf16 v[116:131], v[220:223], v[212:215], v[116:131]
  v_cvt_pk_bf16_f32 v28, v68, v69
  v_exp_f32 v72, v72
  v_exp_f32 v73, v73
  v_cvt_pk_bf16_f32 v29, v70, v71
  s_waitcnt lgkmcnt(2)
  v_mfma_f32_32x32x16_bf16 v[84:99], v[24:27], v[32:35], v[84:99]
  v_exp_f32 v74, v74
  v_exp_f32 v75, v75
  v_cvt_pk_bf16_f32 v30, v72, v73
  v_exp_f32 v76, v76
  v_exp_f32 v77, v77
  v_cvt_pk_bf16_f32 v31, v74, v75
  v_exp_f32 v78, v78
  v_exp_f32 v79, v79
  s_waitcnt lgkmcnt(1)
  v_mfma_f32_32x32x16_bf16 v[84:99], v[20:23], v[28:31], v[84:99]
  s_mov_b64 exec, s[94:95]
  ds_read_b128 v[24:27], v5 offset:35328
  ds_read_b128 v[20:23], v5 offset:36864
  s_mov_b64 exec, -1
  s_add_u32 s54, s8, 25600
  buffer_load_dwordx4 v[208:211], v1, s[16:19], s54 offen sc1
  v_cvt_pk_bf16_f32 v32, v76, v77
  v_exp_f32 v80, v80
  v_exp_f32 v81, v81
  v_cvt_pk_bf16_f32 v33, v78, v79
  v_exp_f32 v82, v82
  v_exp_f32 v83, v83
  v_cvt_pk_bf16_f32 v34, v80, v81
  v_cvt_pk_bf16_f32 v35, v82, v83
  s_waitcnt lgkmcnt(2)
  v_mfma_f32_32x32x16_bf16 v[68:83], v[16:19], v[12:15], v[36:51]
  ds_read_b128 v[16:19], v3 offset:40960
  s_add_u32 s55, s9, 409600
  buffer_load_dwordx4 v[212:215], v1, s[16:19], s55 offen offset:0 sc1
  v_exp_f32 v52, v52
  v_exp_f32 v53, v53
  v_exp_f32 v54, v54
  v_exp_f32 v55, v55
  s_waitcnt vmcnt(12)
  v_mfma_f32_32x32x16_bf16 v[100:115], v[164:167], v[224:227], v[100:115]
  v_cvt_pk_bf16_f32 v28, v52, v53
  v_exp_f32 v56, v56
  v_exp_f32 v57, v57
  v_cvt_pk_bf16_f32 v29, v54, v55
  s_waitcnt lgkmcnt(2)
  v_mfma_f32_32x32x16_bf16 v[84:99], v[24:27], v[32:35], v[84:99]
  v_exp_f32 v58, v58
  v_exp_f32 v59, v59
  v_cvt_pk_bf16_f32 v30, v56, v57
  v_exp_f32 v60, v60
  v_exp_f32 v61, v61
  v_cvt_pk_bf16_f32 v31, v58, v59
  v_exp_f32 v62, v62
  v_exp_f32 v63, v63
  s_waitcnt lgkmcnt(1)
  v_mfma_f32_32x32x16_bf16 v[84:99], v[20:23], v[28:31], v[84:99]
  s_mov_b64 exec, s[94:95]
  ds_read_b128 v[24:27], v5 offset:37376
  ds_read_b128 v[20:23], v5 offset:38912
  s_mov_b64 exec, -1
  buffer_load_dwordx4 v[216:219], v1, s[16:19], s55 offen offset:1024 sc1
  v_cvt_pk_bf16_f32 v32, v60, v61
  v_exp_f32 v64, v64
  v_exp_f32 v65, v65
  v_cvt_pk_bf16_f32 v33, v62, v63
  s_waitcnt vmcnt(12)
  v_mfma_f32_32x32x16_bf16 v[116:131], v[168:171], v[224:227], v[116:131]
  v_exp_f32 v66, v66
  v_exp_f32 v67, v67
  v_cvt_pk_bf16_f32 v34, v64, v65
  v_cvt_pk_bf16_f32 v35, v66, v67
  s_setprio 0
  s_waitcnt lgkmcnt(2)
  v_mfma_f32_32x32x16_bf16 v[52:67], v[16:19], v[12:15], v[36:51]
  ds_read_b128 v[16:19], v3 offset:43008
  s_add_u32 s54, s8, 26624
  buffer_load_dwordx4 v[220:223], v1, s[16:19], s54 offen sc1
  v_exp_f32 v68, v68
  v_exp_f32 v69, v69
  v_exp_f32 v70, v70
  v_exp_f32 v71, v71
  v_cvt_pk_bf16_f32 v28, v68, v69
  v_exp_f32 v72, v72
  v_exp_f32 v73, v73
  v_cvt_pk_bf16_f32 v29, v70, v71
  s_waitcnt lgkmcnt(2)
  v_mfma_f32_32x32x16_bf16 v[84:99], v[24:27], v[32:35], v[84:99]
  v_exp_f32 v74, v74
  v_exp_f32 v75, v75
  v_cvt_pk_bf16_f32 v30, v72, v73
  v_exp_f32 v76, v76
  v_exp_f32 v77, v77
  v_cvt_pk_bf16_f32 v31, v74, v75
  v_exp_f32 v78, v78
  v_exp_f32 v79, v79
  s_waitcnt lgkmcnt(1)
  v_mfma_f32_32x32x16_bf16 v[84:99], v[20:23], v[28:31], v[84:99]
  s_mov_b64 exec, s[94:95]
  ds_read_b128 v[24:27], v5 offset:39424
  ds_read_b128 v[20:23], v5 offset:40960
  s_mov_b64 exec, -1
  s_add_u32 s55, s9, 425984
  buffer_load_dwordx4 v[224:227], v1, s[16:19], s55 offen offset:0 sc1
  v_cvt_pk_bf16_f32 v32, v76, v77
  v_exp_f32 v80, v80
  v_exp_f32 v81, v81
  v_cvt_pk_bf16_f32 v33, v78, v79
  s_waitcnt vmcnt(12)
  v_mfma_f32_32x32x16_bf16 v[100:115], v[176:179], v[172:175], v[100:115]
  v_exp_f32 v82, v82
  v_exp_f32 v83, v83
  v_cvt_pk_bf16_f32 v34, v80, v81
  v_cvt_pk_bf16_f32 v35, v82, v83
  s_setprio 2
  s_waitcnt lgkmcnt(2)
  v_mfma_f32_32x32x16_bf16 v[68:83], v[16:19], v[12:15], v[36:51]
  ds_read_b128 v[16:19], v3 offset:45056
  buffer_load_dwordx4 v[164:167], v1, s[16:19], s55 offen offset:1024 sc1
  s_add_u32 s54, s8, 27648
  buffer_load_dwordx4 v[168:171], v1, s[16:19], s54 offen sc1
  v_exp_f32 v52, v52
  v_exp_f32 v53, v53
  v_exp_f32 v54, v54
  v_exp_f32 v55, v55
  s_waitcnt vmcnt(13)
  v_mfma_f32_32x32x16_bf16 v[116:131], v[180:183], v[172:175], v[116:131]
  v_cvt_pk_bf16_f32 v28, v52, v53
  v_exp_f32 v56, v56
  v_exp_f32 v57, v57
  v_cvt_pk_bf16_f32 v29, v54, v55
  s_waitcnt lgkmcnt(2)
  v_mfma_f32_32x32x16_bf16 v[84:99], v[24:27], v[32:35], v[84:99]
  v_exp_f32 v58, v58
  v_exp_f32 v59, v59
  v_cvt_pk_bf16_f32 v30, v56, v57
  v_exp_f32 v60, v60
  v_exp_f32 v61, v61
  v_cvt_pk_bf16_f32 v31, v58, v59
  v_exp_f32 v62, v62
  v_exp_f32 v63, v63
  s_waitcnt lgkmcnt(1)
  v_mfma_f32_32x32x16_bf16 v[84:99], v[20:23], v[28:31], v[84:99]
  s_mov_b64 exec, s[94:95]
  ds_read_b128 v[24:27], v5 offset:41472
  ds_read_b128 v[20:23], v5 offset:43008
  s_mov_b64 exec, -1
  s_add_u32 s55, s9, 442368
  buffer_load_dwordx4 v[172:175], v1, s[16:19], s55 offen offset:0 sc1
  v_cvt_pk_bf16_f32 v32, v60, v61
  v_exp_f32 v64, v64
  v_exp_f32 v65, v65
  v_cvt_pk_bf16_f32 v33, v62, v63
  v_exp_f32 v66, v66
  v_exp_f32 v67, v67
  v_cvt_pk_bf16_f32 v34, v64, v65
  v_cvt_pk_bf16_f32 v35, v66, v67
  s_waitcnt lgkmcnt(2)
  v_mfma_f32_32x32x16_bf16 v[52:67], v[16:19], v[12:15], v[36:51]
  ds_read_b128 v[16:19], v3 offset:47104
  buffer_load_dwordx4 v[176:179], v1, s[16:19], s55 offen offset:1024 sc1
  v_exp_f32 v68, v68
  v_exp_f32 v69, v69
  v_exp_f32 v70, v70
  v_exp_f32 v71, v71
  s_waitcnt vmcnt(13)
  v_mfma_f32_32x32x16_bf16 v[100:115], v[188:191], v[184:187], v[100:115]
  s_waitcnt vmcnt(12)
  v_mfma_f32_32x32x16_bf16 v[116:131], v[192:195], v[184:187], v[116:131]
  v_cvt_pk_bf16_f32 v28, v68, v69
  v_exp_f32 v72, v72
  v_exp_f32 v73, v73
  v_cvt_pk_bf16_f32 v29, v70, v71
  s_waitcnt lgkmcnt(2)
  v_mfma_f32_32x32x16_bf16 v[84:99], v[24:27], v[32:35], v[84:99]
  v_exp_f32 v74, v74
  v_exp_f32 v75, v75
  v_cvt_pk_bf16_f32 v30, v72, v73
  v_exp_f32 v76, v76
  v_exp_f32 v77, v77
  v_cvt_pk_bf16_f32 v31, v74, v75
  v_exp_f32 v78, v78
  v_exp_f32 v79, v79
  s_waitcnt lgkmcnt(1)
  v_mfma_f32_32x32x16_bf16 v[84:99], v[20:23], v[28:31], v[84:99]
  s_mov_b64 exec, s[94:95]
  ds_read_b128 v[24:27], v5 offset:43520
  ds_read_b128 v[20:23], v5 offset:45056
  s_mov_b64 exec, -1
  s_lshl_b32 s54, s45, 2
  s_add_u32 s54, s54, 0
  s_and_b32 s54, s54, 15
  s_lshl_b32 s54, s54, 14
  s_add_u32 s54, s54, s10
  buffer_load_dwordx4 v[180:183], v1, s[16:19], s54 offen sc1
  v_cvt_pk_bf16_f32 v32, v76, v77
  v_exp_f32 v80, v80
  v_exp_f32 v81, v81
  v_cvt_pk_bf16_f32 v33, v78, v79
  v_exp_f32 v82, v82
  v_exp_f32 v83, v83
  v_cvt_pk_bf16_f32 v34, v80, v81
  v_cvt_pk_bf16_f32 v35, v82, v83
  s_waitcnt lgkmcnt(2)
  v_mfma_f32_32x32x16_bf16 v[68:83], v[16:19], v[12:15], v[36:51]
  ds_read_b128 v[16:19], v3 offset:49152
  s_lshl_b32 s54, s45, 2
  s_add_u32 s54, s54, 1
  s_and_b32 s54, s54, 15
  s_lshl_b32 s54, s54, 14
  s_add_u32 s54, s54, s10
  buffer_load_dwordx4 v[184:187], v1, s[16:19], s54 offen sc1
  v_exp_f32 v52, v52
  v_exp_f32 v53, v53
  v_exp_f32 v54, v54
  v_exp_f32 v55, v55
  s_waitcnt vmcnt(12)
  v_mfma_f32_32x32x16_bf16 v[100:115], v[200:203], v[196:199], v[100:115]
  v_cvt_pk_bf16_f32 v28, v52, v53
  v_exp_f32 v56, v56
  v_exp_f32 v57, v57
  v_cvt_pk_bf16_f32 v29, v54, v55
  s_waitcnt lgkmcnt(2)
  v_mfma_f32_32x32x16_bf16 v[84:99], v[24:27], v[32:35], v[84:99]
  v_exp_f32 v58, v58
  v_exp_f32 v59, v59
  v_cvt_pk_bf16_f32 v30, v56, v57
  v_exp_f32 v60, v60
  v_exp_f32 v61, v61
  v_cvt_pk_bf16_f32 v31, v58, v59
  v_exp_f32 v62, v62
  v_exp_f32 v63, v63
  s_waitcnt lgkmcnt(1)
  v_mfma_f32_32x32x16_bf16 v[84:99], v[20:23], v[28:31], v[84:99]
  s_mov_b64 exec, s[94:95]
  ds_read_b128 v[24:27], v5 offset:45568
  ds_read_b128 v[20:23], v5 offset:47104
  s_mov_b64 exec, -1
  s_lshl_b32 s54, s45, 2
  s_add_u32 s54, s54, 2
  s_and_b32 s54, s54, 15
  s_lshl_b32 s54, s54, 14
  s_add_u32 s54, s54, s10
  buffer_load_dwordx4 v[188:191], v1, s[16:19], s54 offen sc1
  v_cvt_pk_bf16_f32 v32, v60, v61
  v_exp_f32 v64, v64
  v_exp_f32 v65, v65
  v_cvt_pk_bf16_f32 v33, v62, v63
  s_waitcnt vmcnt(12)
  v_mfma_f32_32x32x16_bf16 v[116:131], v[204:207], v[196:199], v[116:131]
  v_exp_f32 v66, v66
  v_exp_f32 v67, v67
  v_cvt_pk_bf16_f32 v34, v64, v65
  v_cvt_pk_bf16_f32 v35, v66, v67
  s_setprio 0
  s_waitcnt lgkmcnt(2)
  v_mfma_f32_32x32x16_bf16 v[52:67], v[16:19], v[12:15], v[36:51]
  ds_read_b128 v[16:19], v3 offset:51200
  s_lshl_b32 s54, s45, 2
  s_add_u32 s54, s54, 3
  s_and_b32 s54, s54, 15
  s_lshl_b32 s54, s54, 14
  s_add_u32 s54, s54, s10
  buffer_load_dwordx4 v[192:195], v1, s[16:19], s54 offen sc1
  v_exp_f32 v68, v68
  v_exp_f32 v69, v69
  v_exp_f32 v70, v70
  v_exp_f32 v71, v71
  v_cvt_pk_bf16_f32 v28, v68, v69
  v_exp_f32 v72, v72
  v_exp_f32 v73, v73
  v_cvt_pk_bf16_f32 v29, v70, v71
  s_waitcnt lgkmcnt(2)
  v_mfma_f32_32x32x16_bf16 v[84:99], v[24:27], v[32:35], v[84:99]
  v_exp_f32 v74, v74
  v_exp_f32 v75, v75
  v_cvt_pk_bf16_f32 v30, v72, v73
  v_exp_f32 v76, v76
  v_exp_f32 v77, v77
  v_cvt_pk_bf16_f32 v31, v74, v75
  v_exp_f32 v78, v78
  v_exp_f32 v79, v79
  s_waitcnt lgkmcnt(1)
  v_mfma_f32_32x32x16_bf16 v[84:99], v[20:23], v[28:31], v[84:99]
  s_mov_b64 exec, s[94:95]
  ds_read_b128 v[24:27], v5 offset:47616
  ds_read_b128 v[20:23], v5 offset:49152
  s_mov_b64 exec, -1
  s_lshl_b32 s54, s45, 2
  s_add_u32 s54, s54, 4
  s_and_b32 s54, s54, 15
  s_lshl_b32 s54, s54, 14
  s_add_u32 s54, s54, s10
  buffer_load_dwordx4 v[196:199], v1, s[16:19], s54 offen sc1
  v_cvt_pk_bf16_f32 v32, v76, v77
  v_exp_f32 v80, v80
  v_exp_f32 v81, v81
  v_cvt_pk_bf16_f32 v33, v78, v79
  s_waitcnt vmcnt(12)
  v_mfma_f32_32x32x16_bf16 v[100:115], v[212:215], v[208:211], v[100:115]
  v_exp_f32 v82, v82
  v_exp_f32 v83, v83
  v_cvt_pk_bf16_f32 v34, v80, v81
  v_cvt_pk_bf16_f32 v35, v82, v83
  s_setprio 2
  s_waitcnt lgkmcnt(2)
  v_mfma_f32_32x32x16_bf16 v[68:83], v[16:19], v[12:15], v[36:51]
  ds_read_b128 v[16:19], v3 offset:53248
  s_lshl_b32 s54, s45, 2
  s_add_u32 s54, s54, 5
  s_and_b32 s54, s54, 15
  s_lshl_b32 s54, s54, 14
  s_add_u32 s54, s54, s10
  buffer_load_dwordx4 v[200:203], v1, s[16:19], s54 offen sc1
  v_exp_f32 v52, v52
  v_exp_f32 v53, v53
  v_exp_f32 v54, v54
  v_exp_f32 v55, v55
  s_waitcnt vmcnt(12)
  v_mfma_f32_32x32x16_bf16 v[116:131], v[216:219], v[208:211], v[116:131]
  v_cvt_pk_bf16_f32 v28, v52, v53
  v_exp_f32 v56, v56
  v_exp_f32 v57, v57
  v_cvt_pk_bf16_f32 v29, v54, v55
  s_waitcnt lgkmcnt(2)
  v_mfma_f32_32x32x16_bf16 v[84:99], v[24:27], v[32:35], v[84:99]
  v_exp_f32 v58, v58
  v_exp_f32 v59, v59
  v_cvt_pk_bf16_f32 v30, v56, v57
  v_exp_f32 v60, v60
  v_exp_f32 v61, v61
  v_cvt_pk_bf16_f32 v31, v58, v59
  v_exp_f32 v62, v62
  v_exp_f32 v63, v63
  s_waitcnt lgkmcnt(1)
  v_mfma_f32_32x32x16_bf16 v[84:99], v[20:23], v[28:31], v[84:99]
  s_mov_b64 exec, s[94:95]
  ds_read_b128 v[24:27], v5 offset:49664
  ds_read_b128 v[20:23], v5 offset:51200
  s_mov_b64 exec, -1
  s_lshl_b32 s54, s45, 2
  s_add_u32 s54, s54, 6
  s_and_b32 s54, s54, 15
  s_lshl_b32 s54, s54, 14
  s_add_u32 s54, s54, s10
  buffer_load_dwordx4 v[204:207], v1, s[16:19], s54 offen sc1
  s_lshl_b32 s54, s45, 2
  s_add_u32 s54, s54, 7
  s_and_b32 s54, s54, 15
  s_lshl_b32 s54, s54, 14
  s_add_u32 s54, s54, s10
  buffer_load_dwordx4 v[208:211], v1, s[16:19], s54 offen sc1
  v_cvt_pk_bf16_f32 v32, v60, v61
  v_exp_f32 v64, v64
  v_exp_f32 v65, v65
  v_cvt_pk_bf16_f32 v33, v62, v63
  v_exp_f32 v66, v66
  v_exp_f32 v67, v67
  v_cvt_pk_bf16_f32 v34, v64, v65
  v_cvt_pk_bf16_f32 v35, v66, v67
  s_waitcnt lgkmcnt(2)
  v_mfma_f32_32x32x16_bf16 v[52:67], v[16:19], v[12:15], v[36:51]
  ds_read_b128 v[16:19], v3 offset:55296
  s_lshl_b32 s54, s45, 2
  s_add_u32 s54, s54, 8
  s_and_b32 s54, s54, 15
  s_lshl_b32 s54, s54, 14
  s_add_u32 s54, s54, s10
  buffer_load_dwordx4 v[212:215], v1, s[16:19], s54 offen sc1
  v_exp_f32 v68, v68
  v_exp_f32 v69, v69
  v_exp_f32 v70, v70
  v_exp_f32 v71, v71
  s_waitcnt vmcnt(13)
  v_mfma_f32_32x32x16_bf16 v[100:115], v[224:227], v[220:223], v[100:115]
  v_cvt_pk_bf16_f32 v28, v68, v69
  v_exp_f32 v72, v72
  v_exp_f32 v73, v73
  v_cvt_pk_bf16_f32 v29, v70, v71
  s_waitcnt lgkmcnt(2)
  v_mfma_f32_32x32x16_bf16 v[84:99], v[24:27], v[32:35], v[84:99]
  v_exp_f32 v74, v74
  v_exp_f32 v75, v75
  v_cvt_pk_bf16_f32 v30, v72, v73
  v_exp_f32 v76, v76
  v_exp_f32 v77, v77
  v_cvt_pk_bf16_f32 v31, v74, v75
  v_exp_f32 v78, v78
  v_exp_f32 v79, v79
  s_waitcnt lgkmcnt(1)
  v_mfma_f32_32x32x16_bf16 v[84:99], v[20:23], v[28:31], v[84:99]
  s_mov_b64 exec, s[94:95]
  ds_read_b128 v[24:27], v5 offset:51712
  ds_read_b128 v[20:23], v5 offset:53248
  s_mov_b64 exec, -1
  s_lshl_b32 s54, s45, 2
  s_add_u32 s54, s54, 9
  s_and_b32 s54, s54, 15
  s_lshl_b32 s54, s54, 14
  s_add_u32 s54, s54, s10
  buffer_load_dwordx4 v[216:219], v1, s[16:19], s54 offen sc1
  v_cvt_pk_bf16_f32 v32, v76, v77
  v_exp_f32 v80, v80
  v_exp_f32 v81, v81
  v_cvt_pk_bf16_f32 v33, v78, v79
  s_waitcnt vmcnt(13)
  v_mfma_f32_32x32x16_bf16 v[116:131], v[164:167], v[220:223], v[116:131]
  v_exp_f32 v82, v82
  v_exp_f32 v83, v83
  v_cvt_pk_bf16_f32 v34, v80, v81
  v_cvt_pk_bf16_f32 v35, v82, v83
  s_waitcnt lgkmcnt(2)
  v_mfma_f32_32x32x16_bf16 v[68:83], v[16:19], v[12:15], v[36:51]
  ds_read_b128 v[16:19], v3 offset:57344
  s_lshl_b32 s54, s45, 2
  s_add_u32 s54, s54, 10
  s_and_b32 s54, s54, 15
  s_lshl_b32 s54, s54, 14
  s_add_u32 s54, s54, s10
  buffer_load_dwordx4 v[220:223], v1, s[16:19], s54 offen sc1
  v_exp_f32 v52, v52
  v_exp_f32 v53, v53
  v_exp_f32 v54, v54
  v_exp_f32 v55, v55
  s_waitcnt vmcnt(12)
  v_mfma_f32_32x32x16_bf16 v[100:115], v[172:175], v[168:171], v[100:115]
  v_cvt_pk_bf16_f32 v28, v52, v53
  v_exp_f32 v56, v56
  v_exp_f32 v57, v57
  v_cvt_pk_bf16_f32 v29, v54, v55
  s_waitcnt lgkmcnt(2)
  v_mfma_f32_32x32x16_bf16 v[84:99], v[24:27], v[32:35], v[84:99]
  v_exp_f32 v58, v58
  v_exp_f32 v59, v59
  v_cvt_pk_bf16_f32 v30, v56, v57
  v_exp_f32 v60, v60
  v_exp_f32 v61, v61
  v_cvt_pk_bf16_f32 v31, v58, v59
  v_exp_f32 v62, v62
  v_exp_f32 v63, v63
  s_waitcnt lgkmcnt(1)
  v_mfma_f32_32x32x16_bf16 v[84:99], v[20:23], v[28:31], v[84:99]
  s_mov_b64 exec, s[94:95]
  ds_read_b128 v[24:27], v5 offset:53760
  ds_read_b128 v[20:23], v5 offset:55296
  s_mov_b64 exec, -1
  s_lshl_b32 s54, s45, 2
  s_add_u32 s54, s54, 11
  s_and_b32 s54, s54, 15
  s_lshl_b32 s54, s54, 14
  s_add_u32 s54, s54, s10
  buffer_load_dwordx4 v[224:227], v1, s[16:19], s54 offen sc1
  v_cvt_pk_bf16_f32 v32, v60, v61
  v_exp_f32 v64, v64
  v_exp_f32 v65, v65
  v_cvt_pk_bf16_f32 v33, v62, v63
  s_waitcnt vmcnt(12)
  v_mfma_f32_32x32x16_bf16 v[116:131], v[176:179], v[168:171], v[116:131]
  v_exp_f32 v66, v66
  v_exp_f32 v67, v67
  v_cvt_pk_bf16_f32 v34, v64, v65
  v_cvt_pk_bf16_f32 v35, v66, v67
  s_setprio 0
  s_waitcnt lgkmcnt(2)
  v_mfma_f32_32x32x16_bf16 v[52:67], v[16:19], v[12:15], v[36:51]
  ds_read_b128 v[16:19], v3 offset:59392
  s_lshl_b32 s54, s45, 2
  s_add_u32 s54, s54, 12
  s_and_b32 s54, s54, 15
  s_lshl_b32 s54, s54, 14
  s_add_u32 s54, s54, s10
  buffer_load_dwordx4 v[164:167], v1, s[16:19], s54 offen sc1
  v_exp_f32 v68, v68
  v_exp_f32 v69, v69
  v_exp_f32 v70, v70
  v_exp_f32 v71, v71
  v_cvt_pk_bf16_f32 v28, v68, v69
  v_exp_f32 v72, v72
  v_exp_f32 v73, v73
  v_cvt_pk_bf16_f32 v29, v70, v71
  s_waitcnt lgkmcnt(2)
  v_mfma_f32_32x32x16_bf16 v[84:99], v[24:27], v[32:35], v[84:99]
  v_exp_f32 v74, v74
  v_exp_f32 v75, v75
  v_cvt_pk_bf16_f32 v30, v72, v73
  v_exp_f32 v76, v76
  v_exp_f32 v77, v77
  v_cvt_pk_bf16_f32 v31, v74, v75
  v_exp_f32 v78, v78
  v_exp_f32 v79, v79
  s_waitcnt lgkmcnt(1)
  v_mfma_f32_32x32x16_bf16 v[84:99], v[20:23], v[28:31], v[84:99]
  s_mov_b64 exec, s[94:95]
  ds_read_b128 v[24:27], v5 offset:55808
  ds_read_b128 v[20:23], v5 offset:57344
  s_mov_b64 exec, -1
  s_lshl_b32 s54, s45, 2
  s_add_u32 s54, s54, 13
  s_and_b32 s54, s54, 15
  s_lshl_b32 s54, s54, 14
  s_add_u32 s54, s54, s10
  buffer_load_dwordx4 v[168:171], v1, s[16:19], s54 offen sc1
  v_cvt_pk_bf16_f32 v32, v76, v77
  v_exp_f32 v80, v80
  v_exp_f32 v81, v81
  v_cvt_pk_bf16_f32 v33, v78, v79
  v_exp_f32 v82, v82
  v_exp_f32 v83, v83
  v_cvt_pk_bf16_f32 v34, v80, v81
  v_cvt_pk_bf16_f32 v35, v82, v83
  s_setprio 2
  s_waitcnt lgkmcnt(2)
  v_mfma_f32_32x32x16_bf16 v[68:83], v[16:19], v[12:15], v[36:51]
  ds_read_b128 v[16:19], v3 offset:61440
  s_lshl_b32 s54, s45, 2
  s_add_u32 s54, s54, 14
  s_and_b32 s54, s54, 15
  s_lshl_b32 s54, s54, 14
  s_add_u32 s54, s54, s10
  buffer_load_dwordx4 v[172:175], v1, s[16:19], s54 offen sc1
  v_exp_f32 v52, v52
  v_exp_f32 v53, v53
  v_exp_f32 v54, v54
  v_exp_f32 v55, v55
  v_cvt_pk_bf16_f32 v28, v52, v53
  v_exp_f32 v56, v56
  v_exp_f32 v57, v57
  v_cvt_pk_bf16_f32 v29, v54, v55
  s_waitcnt lgkmcnt(2)
  v_mfma_f32_32x32x16_bf16 v[84:99], v[24:27], v[32:35], v[84:99]
  v_exp_f32 v58, v58
  v_exp_f32 v59, v59
  v_cvt_pk_bf16_f32 v30, v56, v57
  v_exp_f32 v60, v60
  v_exp_f32 v61, v61
  v_cvt_pk_bf16_f32 v31, v58, v59
  v_exp_f32 v62, v62
  v_exp_f32 v63, v63
  s_waitcnt lgkmcnt(1)
  v_mfma_f32_32x32x16_bf16 v[84:99], v[20:23], v[28:31], v[84:99]
  s_mov_b64 exec, s[94:95]
  ds_read_b128 v[24:27], v5 offset:57856
  ds_read_b128 v[20:23], v5 offset:59392
  s_mov_b64 exec, -1
  s_lshl_b32 s54, s45, 2
  s_add_u32 s54, s54, 15
  s_and_b32 s54, s54, 15
  s_lshl_b32 s54, s54, 14
  s_add_u32 s54, s54, s10
  buffer_load_dwordx4 v[176:179], v1, s[16:19], s54 offen sc1
  v_cvt_pk_bf16_f32 v32, v60, v61
  v_exp_f32 v64, v64
  v_exp_f32 v65, v65
  v_cvt_pk_bf16_f32 v33, v62, v63
  v_exp_f32 v66, v66
  v_exp_f32 v67, v67
  v_cvt_pk_bf16_f32 v34, v64, v65
  v_cvt_pk_bf16_f32 v35, v66, v67
  s_waitcnt lgkmcnt(2)
  v_mfma_f32_32x32x16_bf16 v[52:67], v[16:19], v[12:15], v[36:51]
  ds_read_b128 v[16:19], v3 offset:63488
  s_lshl_b32 s52, s25, 8
  s_lshl_b32 s53, s45, 6
  s_add_u32 s52, s52, s53
  s_lshl_b32 s53, s46, 5
  s_add_u32 s52, s52, s53
  v_lshrrev_b32 v6, 5, v0
  v_lshlrev_b32 v6, 3, v6
  v_add_u32 v6, s52, v6
  v_and_b32 v7, 31, v0
  v_lshlrev_b32 v7, 10, v7
  s_lshl_b32 s53, s24, 15
  v_add3_u32 v7, v7, v6, s53
  buffer_load_dwordx2 v[232:233], v6, s[32:35], 0 offen
  buffer_load_dwordx2 v[234:235], v6, s[32:35], 0 offen offset:16
  buffer_load_dwordx2 v[228:229], v7, s[4:7], 0 offen
  buffer_load_dwordx2 v[230:231], v7, s[4:7], 0 offen offset:16
  v_lshrrev_b32 v8, 5, v0
  v_lshlrev_b32 v8, 4, v8
  v_and_b32 v236, 31, v0
  v_lshlrev_b32 v236, 10, v236
  s_add_u32 s52, s52, s53
  v_add3_u32 v236, v236, v8, s52
  v_exp_f32 v68, v68
  v_exp_f32 v69, v69
  v_exp_f32 v70, v70
  v_exp_f32 v71, v71
  v_cvt_pk_bf16_f32 v28, v68, v69
  v_exp_f32 v72, v72
  v_exp_f32 v73, v73
  v_cvt_pk_bf16_f32 v29, v70, v71
  s_waitcnt lgkmcnt(2)
  v_mfma_f32_32x32x16_bf16 v[84:99], v[24:27], v[32:35], v[84:99]
  v_exp_f32 v74, v74
  v_exp_f32 v75, v75
  v_cvt_pk_bf16_f32 v30, v72, v73
  v_exp_f32 v76, v76
  v_exp_f32 v77, v77
  v_cvt_pk_bf16_f32 v31, v74, v75
  v_exp_f32 v78, v78
  v_exp_f32 v79, v79
  s_waitcnt lgkmcnt(1)
  v_mfma_f32_32x32x16_bf16 v[84:99], v[20:23], v[28:31], v[84:99]
  s_mov_b64 exec, s[94:95]
  ds_read_b128 v[24:27], v5 offset:59904
  ds_read_b128 v[20:23], v5 offset:61440
  s_mov_b64 exec, -1
  v_cvt_pk_bf16_f32 v32, v76, v77
  v_exp_f32 v80, v80
  v_exp_f32 v81, v81
  v_cvt_pk_bf16_f32 v33, v78, v79
  v_exp_f32 v82, v82
  v_exp_f32 v83, v83
  v_cvt_pk_bf16_f32 v34, v80, v81
  v_cvt_pk_bf16_f32 v35, v82, v83
  s_waitcnt lgkmcnt(2)
  v_mfma_f32_32x32x16_bf16 v[68:83], v[16:19], v[12:15], v[36:51]
  v_exp_f32 v52, v52
  v_exp_f32 v53, v53
  v_exp_f32 v54, v54
  v_exp_f32 v55, v55
  v_cvt_pk_bf16_f32 v28, v52, v53
  v_exp_f32 v56, v56
  v_exp_f32 v57, v57
  v_cvt_pk_bf16_f32 v29, v54, v55
  s_waitcnt lgkmcnt(1)
  v_mfma_f32_32x32x16_bf16 v[84:99], v[24:27], v[32:35], v[84:99]
  v_exp_f32 v58, v58
  v_exp_f32 v59, v59
  v_cvt_pk_bf16_f32 v30, v56, v57
  v_exp_f32 v60, v60
  v_exp_f32 v61, v61
  v_cvt_pk_bf16_f32 v31, v58, v59
  v_exp_f32 v62, v62
  v_exp_f32 v63, v63
  s_waitcnt lgkmcnt(0)
  v_mfma_f32_32x32x16_bf16 v[84:99], v[20:23], v[28:31], v[84:99]
  s_mov_b64 exec, s[94:95]
  ds_read_b128 v[24:27], v5 offset:61952
  ds_read_b128 v[20:23], v5 offset:63488
  s_mov_b64 exec, -1
  v_cvt_pk_bf16_f32 v32, v60, v61
  v_exp_f32 v64, v64
  v_exp_f32 v65, v65
  v_cvt_pk_bf16_f32 v33, v62, v63
  v_exp_f32 v66, v66
  v_exp_f32 v67, v67
  v_cvt_pk_bf16_f32 v34, v64, v65
  v_cvt_pk_bf16_f32 v35, v66, v67
  s_setprio 0
  v_exp_f32 v68, v68
  v_exp_f32 v69, v69
  v_exp_f32 v70, v70
  v_exp_f32 v71, v71
  v_cvt_pk_bf16_f32 v28, v68, v69
  v_exp_f32 v72, v72
  v_exp_f32 v73, v73
  v_cvt_pk_bf16_f32 v29, v70, v71
  s_waitcnt lgkmcnt(1)
  v_mfma_f32_32x32x16_bf16 v[84:99], v[24:27], v[32:35], v[84:99]
  v_exp_f32 v74, v74
  v_exp_f32 v75, v75
  v_cvt_pk_bf16_f32 v30, v72, v73
  v_exp_f32 v76, v76
  v_exp_f32 v77, v77
  v_cvt_pk_bf16_f32 v31, v74, v75
  v_exp_f32 v78, v78
  v_exp_f32 v79, v79
  s_waitcnt lgkmcnt(0)
  v_mfma_f32_32x32x16_bf16 v[84:99], v[20:23], v[28:31], v[84:99]
  s_mov_b64 exec, s[94:95]
  ds_read_b128 v[24:27], v5 offset:64000
  s_mov_b64 exec, -1
  v_cvt_pk_bf16_f32 v32, v76, v77
  v_exp_f32 v80, v80
  v_exp_f32 v81, v81
  v_cvt_pk_bf16_f32 v33, v78, v79
  v_exp_f32 v82, v82
  v_exp_f32 v83, v83
  v_cvt_pk_bf16_f32 v34, v80, v81
  v_cvt_pk_bf16_f32 v35, v82, v83
  s_setprio 0
s_branch recurrent_scan__softmax_full_mha__mixer_channel_mlp__prompt_kernel_att
recurrent_scan__softmax_full_mha__mixer_channel_mlp__prompt_kernel_g1:
  s_add_u32 s58, s93, 0
  s_and_b32 s58, s58, 7
  s_lshl_b32 s57, s58, 7
  s_mul_i32 s58, s58, 196608
  s_add_u32 m0, s61, 0
s_nop 0
  buffer_load_dwordx4 v4, s[4:7], s57 offen lds
  s_add_u32 m0, s61, 1024
s_nop 0
  buffer_load_dwordx4 v5, s[4:7], s57 offen lds
  s_add_u32 m0, s62, 0
s_nop 0
  buffer_load_dwordx4 v6, s[8:11], s58 offen lds
  s_add_u32 m0, s62, 4096
  s_add_u32 s54, s58, 1024
  buffer_load_dwordx4 v6, s[8:11], s54 offen lds
  s_mov_b32 s16, s88
  s_mov_b32 s17, s89
  s_mov_b32 s40, s86
  s_mov_b32 s41, s87
  s_mov_b32 s12, s76
  s_mov_b32 s13, s77
  s_mov_b32 s20, s80
  s_mov_b32 s21, s81
  s_mov_b32 s24, s72
  s_mov_b32 s25, s73
  s_mov_b32 s28, s78
  s_mov_b32 s29, s79
  s_mov_b32 s32, s82
  s_mov_b32 s33, s83
  s_mov_b32 s36, s84
  s_mov_b32 s37, s85
  v_mov_b32 v20, 0
  v_mov_b32 v21, 0
  v_mov_b32 v22, 0
  v_mov_b32 v23, 0
  v_mov_b32 v24, 163824
  ds_write_b32 v24, v20
  s_or_b32 s52, s2, s44
  s_cmp_lg_u32 s52, 0
s_cbranch_scc1 noinit_12
  v_lshrrev_b32 v1, 2, v0
  v_lshlrev_b32 v1, 8, v1
  v_and_b32 v2, 3, v0
  v_lshlrev_b32 v2, 4, v2
  v_add_u32 v1, v1, v2
  s_mov_b32 s52, 18874368
  s_mov_b32 s53, 18878464
  s_mov_b32 s54, 18882560
  buffer_store_dwordx4 v[20:23], v1, s[16:19], s52 offen sc1
  buffer_store_dwordx4 v[20:23], v1, s[16:19], s53 offen sc1
  buffer_store_dwordx4 v[20:23], v1, s[16:19], s54 offen sc1
s_nop 1
noinit_12:
  v_and_b32 v1, 31, v0
  v_lshrrev_b32 v2, 5, v0
  v_bfe_u32 v3, v0, 1, 3
  v_xor_b32 v2, v2, v3
  v_lshlrev_b32 v2, 4, v2
  s_lshl_b32 s52, s45, 5
  v_add_u32 v1, s52, v1
  v_lshlrev_b32 v1, 7, v1
  s_xor_b32 s52, s45, 0
  s_lshl_b32 s52, s52, 5
  v_xor_b32 v3, s52, v2
  v_add_u32 v8, v1, v3
  s_xor_b32 s52, s45, 1
  s_lshl_b32 s52, s52, 5
  v_xor_b32 v3, s52, v2
  v_add_u32 v9, v1, v3
  s_xor_b32 s52, s45, 2
  s_lshl_b32 s52, s52, 5
  v_xor_b32 v3, s52, v2
  v_add_u32 v10, v1, v3
  s_xor_b32 s52, s45, 3
  s_lshl_b32 s52, s52, 5
  v_xor_b32 v3, s52, v2
  v_add_u32 v11, v1, v3
  v_lshrrev_b32 v1, 5, v0
  v_lshlrev_b32 v1, 9, v1
  v_bfe_u32 v2, v0, 2, 2
  v_lshlrev_b32 v2, 6, v2
  v_add_u32 v1, v1, v2
  v_bfe_u32 v2, v0, 4, 1
  v_lshlrev_b32 v2, 5, v2
  v_add_u32 v1, v1, v2
  v_and_b32 v2, 1, v0
  v_lshlrev_b32 v2, 4, v2
  v_add_u32 v1, v1, v2
  v_and_b32 v2, 2, v0
  v_lshlrev_b32 v2, 2, v2
  v_add_u32 v1, v1, v2
  s_xor_b32 s52, s45, 0
  s_lshl_b32 s52, s52, 10
  s_add_u32 s52, s52, 81920
  v_add_u32 v12, s52, v1
  s_xor_b32 s52, s45, 1
  s_lshl_b32 s52, s52, 10
  s_add_u32 s52, s52, 81920
  v_add_u32 v13, s52, v1
  s_xor_b32 s52, s45, 2
  s_lshl_b32 s52, s52, 10
  s_add_u32 s52, s52, 81920
  v_add_u32 v14, s52, v1
  s_xor_b32 s52, s45, 3
  s_lshl_b32 s52, s52, 10
  s_add_u32 s52, s52, 81920
  v_add_u32 v15, s52, v1
  v_and_b32 v1, 15, v0
  v_bfe_u32 v2, v0, 4, 1
  v_cmp_eq_u32 vcc, v1, v2
  v_mov_b32 v1, 0x3f803f80
s_nop 0
  v_cndmask_b32 v40, 0, v1, vcc
  v_cndmask_b32 v41, 0, v1, vcc
  v_cndmask_b32 v42, 0, v1, vcc
  v_cndmask_b32 v43, 0, v1, vcc
  v_mov_b32 v16, 0
  v_mov_b32 v17, 0
  v_mov_b32 v18, 0
  v_mov_b32 v19, 0
  v_lshlrev_b32 v1, 4, v0
  v_and_b32 v18, 15, v0
  v_lshlrev_b32 v19, 6, v18
  v_lshlrev_b32 v18, 8, v18
  v_lshrrev_b32 v2, 4, v0
  v_lshlrev_b32 v3, 6, v2
  s_lshl_b32 s52, s45, 2
  s_add_u32 s52, s52, 147456
  v_add3_u32 v18, v18, v3, s52
  v_lshlrev_b32 v3, 4, v2
  s_lshl_b32 s52, s45, 7
  s_add_u32 s52, s52, 145408
  v_add3_u32 v19, v19, v3, s52
  s_mov_b32 s96, 0x00030003
  s_mov_b32 s97, 0x00030003
  s_add_u32 s58, s93, 1
  s_and_b32 s58, s58, 7
  s_lshl_b32 s57, s58, 7
  s_mul_i32 s58, s58, 196608
  s_add_u32 m0, s61, 16384
s_nop 0
  buffer_load_dwordx4 v4, s[4:7], s57 offen lds
  s_add_u32 m0, s61, 17408
s_nop 0
  buffer_load_dwordx4 v5, s[4:7], s57 offen lds
  s_add_u32 m0, s62, 12288
s_nop 0
  buffer_load_dwordx4 v6, s[8:11], s58 offen lds
  s_add_u32 m0, s62, 16384
  s_add_u32 s54, s58, 1024
  buffer_load_dwordx4 v6, s[8:11], s54 offen lds
  s_add_u32 s58, s93, 2
  s_and_b32 s58, s58, 7
  s_lshl_b32 s57, s58, 7
  s_mul_i32 s58, s58, 196608
  s_add_u32 m0, s61, 32768
s_nop 0
  buffer_load_dwordx4 v4, s[4:7], s57 offen lds
  s_add_u32 m0, s61, 33792
s_nop 0
  buffer_load_dwordx4 v5, s[4:7], s57 offen lds
  s_add_u32 m0, s62, 24576
s_nop 0
  buffer_load_dwordx4 v6, s[8:11], s58 offen lds
  s_add_u32 m0, s62, 28672
  s_add_u32 s54, s58, 1024
  buffer_load_dwordx4 v6, s[8:11], s54 offen lds
  s_waitcnt vmcnt(8)
  s_barrier
  ds_read_b128 v[128:131], v8 offset:0
  ds_read_b64_tr_b16 v[96:97], v12 offset:8192
  ds_read_b64_tr_b16 v[98:99], v12 offset:8448
  ds_read_b128 v[132:135], v9 offset:0
  ds_read_b64_tr_b16 v[104:105], v13 offset:8192
  ds_read_b64_tr_b16 v[106:107], v13 offset:8448
  s_waitcnt lgkmcnt(3)
  v_mfma_f32_32x32x16_bf16 v[64:79], v[128:131], v[96:99], 0
  ds_read_b128 v[136:139], v10 offset:0
  ds_read_b64_tr_b16 v[112:113], v14 offset:8192
  ds_read_b64_tr_b16 v[114:115], v14 offset:8448
  v_and_b32 v20, s60, v130
  v_lshlrev_b32 v21, 16, v130
  v_fmac_f32 v16, v20, v20
  v_fmac_f32 v17, v21, v21
  v_mfma_f32_16x16x32_bf16 v[24:27], v[96:99], v[40:43], 0
  s_add_u32 s58, s93, 3
  s_and_b32 s58, s58, 7
  s_lshl_b32 s57, s58, 7
  s_mul_i32 s58, s58, 196608
  s_add_u32 m0, s61, 49152
s_nop 0
  buffer_load_dwordx4 v4, s[4:7], s57 offen lds
  s_add_u32 m0, s61, 50176
s_nop 0
  buffer_load_dwordx4 v5, s[4:7], s57 offen lds
  v_and_b32 v22, s60, v131
  v_lshlrev_b32 v23, 16, v131
  v_fmac_f32 v16, v22, v22
  v_fmac_f32 v17, v23, v23
  v_mfma_f32_16x16x32_bf16 v[28:31], v[128:131], v[40:43], 0
  s_waitcnt lgkmcnt(3)
  v_mfma_f32_32x32x16_bf16 v[64:79], v[132:135], v[104:107], v[64:79]
  ds_read_b128 v[140:143], v11 offset:0
  ds_read_b64_tr_b16 v[120:121], v15 offset:8192
  ds_read_b64_tr_b16 v[122:123], v15 offset:8448
  v_and_b32 v20, s60, v134
  v_lshlrev_b32 v21, 16, v134
  v_fmac_f32 v16, v20, v20
  v_fmac_f32 v17, v21, v21
  v_mfma_f32_16x16x32_bf16 v[28:31], v[132:135], v[40:43], v[28:31]
  s_add_u32 m0, s62, 36864
s_nop 0
  buffer_load_dwordx4 v6, s[8:11], s58 offen lds
  s_add_u32 m0, s62, 40960
  s_add_u32 s54, s58, 1024
  buffer_load_dwordx4 v6, s[8:11], s54 offen lds
  v_and_b32 v22, s60, v135
  v_lshlrev_b32 v23, 16, v135
  v_fmac_f32 v16, v22, v22
  v_fmac_f32 v17, v23, v23
  s_waitcnt vmcnt(8)
  s_barrier
  s_waitcnt lgkmcnt(3)
  v_mfma_f32_32x32x16_bf16 v[64:79], v[136:139], v[112:115], v[64:79]
  ds_read_b128 v[144:147], v8 offset:16384
  ds_read_b64_tr_b16 v[96:97], v12 offset:20480
  ds_read_b64_tr_b16 v[98:99], v12 offset:20736
  v_and_b32 v20, s60, v138
  v_lshlrev_b32 v21, 16, v138
  v_fmac_f32 v16, v20, v20
  v_fmac_f32 v17, v21, v21
  v_mfma_f32_16x16x32_bf16 v[28:31], v[136:139], v[40:43], v[28:31]
  s_add_u32 s58, s93, 4
  s_and_b32 s58, s58, 7
  s_lshl_b32 s57, s58, 7
  s_mul_i32 s58, s58, 196608
  s_add_u32 m0, s61, 65536
s_nop 0
  buffer_load_dwordx4 v4, s[4:7], s57 offen lds
  v_and_b32 v22, s60, v139
  v_lshlrev_b32 v23, 16, v139
  v_fmac_f32 v16, v22, v22
  v_fmac_f32 v17, v23, v23
  s_waitcnt lgkmcnt(3)
  v_mfma_f32_32x32x16_bf16 v[64:79], v[140:143], v[120:123], v[64:79]
  ds_read_b128 v[148:151], v9 offset:16384
  ds_read_b64_tr_b16 v[104:105], v13 offset:20480
  ds_read_b64_tr_b16 v[106:107], v13 offset:20736
  v_and_b32 v20, s60, v142
  v_lshlrev_b32 v21, 16, v142
  v_fmac_f32 v16, v20, v20
  v_fmac_f32 v17, v21, v21
  v_mfma_f32_16x16x32_bf16 v[28:31], v[140:143], v[40:43], v[28:31]
  s_add_u32 m0, s61, 66560
s_nop 0
  buffer_load_dwordx4 v5, s[4:7], s57 offen lds
  v_and_b32 v22, s60, v143
  v_lshlrev_b32 v23, 16, v143
  v_fmac_f32 v16, v22, v22
  v_fmac_f32 v17, v23, v23
  s_waitcnt lgkmcnt(3)
  v_mfma_f32_32x32x16_bf16 v[64:79], v[144:147], v[96:99], v[64:79]
  ds_read_b128 v[152:155], v10 offset:16384
  ds_read_b64_tr_b16 v[112:113], v14 offset:20480
  ds_read_b64_tr_b16 v[114:115], v14 offset:20736
  v_and_b32 v20, s60, v146
  v_lshlrev_b32 v21, 16, v146
  v_fmac_f32 v16, v20, v20
  v_fmac_f32 v17, v21, v21
  v_mfma_f32_16x16x32_bf16 v[24:27], v[96:99], v[40:43], v[24:27]
  s_add_u32 m0, s62, 49152
s_nop 0
  buffer_load_dwordx4 v6, s[8:11], s58 offen lds
  v_and_b32 v22, s60, v147
  v_lshlrev_b32 v23, 16, v147
  v_fmac_f32 v16, v22, v22
  v_fmac_f32 v17, v23, v23
  v_mfma_f32_16x16x32_bf16 v[28:31], v[144:147], v[40:43], v[28:31]
  s_waitcnt lgkmcnt(3)
  v_mfma_f32_32x32x16_bf16 v[64:79], v[148:151], v[104:107], v[64:79]
  ds_read_b128 v[156:159], v11 offset:16384
  ds_read_b64_tr_b16 v[120:121], v15 offset:20480
  ds_read_b64_tr_b16 v[122:123], v15 offset:20736
  v_and_b32 v20, s60, v150
  v_lshlrev_b32 v21, 16, v150
  v_fmac_f32 v16, v20, v20
  v_fmac_f32 v17, v21, v21
  v_mfma_f32_16x16x32_bf16 v[28:31], v[148:151], v[40:43], v[28:31]
  s_add_u32 m0, s62, 53248
  s_add_u32 s54, s58, 1024
  buffer_load_dwordx4 v6, s[8:11], s54 offen lds
  v_and_b32 v22, s60, v151
  v_lshlrev_b32 v23, 16, v151
  v_fmac_f32 v16, v22, v22
  v_fmac_f32 v17, v23, v23
  s_waitcnt vmcnt(8)
  s_barrier
  s_waitcnt lgkmcnt(3)
  v_mfma_f32_32x32x16_bf16 v[64:79], v[152:155], v[112:115], v[64:79]
  ds_read_b128 v[160:163], v8 offset:32768
  ds_read_b64_tr_b16 v[96:97], v12 offset:32768
  ds_read_b64_tr_b16 v[98:99], v12 offset:33024
  v_and_b32 v20, s60, v154
  v_lshlrev_b32 v21, 16, v154
  v_fmac_f32 v16, v20, v20
  v_fmac_f32 v17, v21, v21
  v_mfma_f32_16x16x32_bf16 v[28:31], v[152:155], v[40:43], v[28:31]
  s_add_u32 s58, s93, 5
  s_and_b32 s58, s58, 7
  s_lshl_b32 s57, s58, 7
  s_mul_i32 s58, s58, 196608
  s_add_u32 m0, s61, 0
s_nop 0
  buffer_load_dwordx4 v4, s[4:7], s57 offen lds
  v_and_b32 v22, s60, v155
  v_lshlrev_b32 v23, 16, v155
  v_fmac_f32 v16, v22, v22
  v_fmac_f32 v17, v23, v23
  s_waitcnt lgkmcnt(3)
  v_mfma_f32_32x32x16_bf16 v[64:79], v[156:159], v[120:123], v[64:79]
  ds_read_b128 v[164:167], v9 offset:32768
  ds_read_b64_tr_b16 v[104:105], v13 offset:32768
  ds_read_b64_tr_b16 v[106:107], v13 offset:33024
  v_and_b32 v20, s60, v158
  v_lshlrev_b32 v21, 16, v158
  v_fmac_f32 v16, v20, v20
  v_fmac_f32 v17, v21, v21
  v_mfma_f32_16x16x32_bf16 v[28:31], v[156:159], v[40:43], v[28:31]
  s_add_u32 m0, s61, 1024
s_nop 0
  buffer_load_dwordx4 v5, s[4:7], s57 offen lds
  v_and_b32 v22, s60, v159
  v_lshlrev_b32 v23, 16, v159
  v_fmac_f32 v16, v22, v22
  v_fmac_f32 v17, v23, v23
  s_waitcnt lgkmcnt(3)
  v_mfma_f32_32x32x16_bf16 v[64:79], v[160:163], v[96:99], v[64:79]
  ds_read_b128 v[168:171], v10 offset:32768
  ds_read_b64_tr_b16 v[112:113], v14 offset:32768
  ds_read_b64_tr_b16 v[114:115], v14 offset:33024
  v_and_b32 v20, s60, v162
  v_lshlrev_b32 v21, 16, v162
  v_fmac_f32 v16, v20, v20
  v_fmac_f32 v17, v21, v21
  v_mfma_f32_16x16x32_bf16 v[24:27], v[96:99], v[40:43], v[24:27]
  s_add_u32 m0, s62, 0
s_nop 0
  buffer_load_dwordx4 v6, s[8:11], s58 offen lds
  v_and_b32 v22, s60, v163
  v_lshlrev_b32 v23, 16, v163
  v_fmac_f32 v16, v22, v22
  v_fmac_f32 v17, v23, v23
  v_mfma_f32_16x16x32_bf16 v[28:31], v[160:163], v[40:43], v[28:31]
  s_waitcnt lgkmcnt(3)
  v_mfma_f32_32x32x16_bf16 v[64:79], v[164:167], v[104:107], v[64:79]
  ds_read_b128 v[172:175], v11 offset:32768
  ds_read_b64_tr_b16 v[120:121], v15 offset:32768
  ds_read_b64_tr_b16 v[122:123], v15 offset:33024
  v_and_b32 v20, s60, v166
  v_lshlrev_b32 v21, 16, v166
  v_fmac_f32 v16, v20, v20
  v_fmac_f32 v17, v21, v21
  v_mfma_f32_16x16x32_bf16 v[28:31], v[164:167], v[40:43], v[28:31]
  s_add_u32 m0, s62, 4096
  s_add_u32 s54, s58, 1024
  buffer_load_dwordx4 v6, s[8:11], s54 offen lds
  v_and_b32 v22, s60, v167
  v_lshlrev_b32 v23, 16, v167
  v_fmac_f32 v16, v22, v22
  v_fmac_f32 v17, v23, v23
  s_waitcnt vmcnt(8)
  s_barrier
  s_waitcnt lgkmcnt(3)
  v_mfma_f32_32x32x16_bf16 v[64:79], v[168:171], v[112:115], v[64:79]
  ds_read_b128 v[176:179], v8 offset:49152
  ds_read_b64_tr_b16 v[96:97], v12 offset:45056
  ds_read_b64_tr_b16 v[98:99], v12 offset:45312
  v_and_b32 v20, s60, v170
  v_lshlrev_b32 v21, 16, v170
  v_fmac_f32 v16, v20, v20
  v_fmac_f32 v17, v21, v21
  v_mfma_f32_16x16x32_bf16 v[28:31], v[168:171], v[40:43], v[28:31]
  s_add_u32 s58, s93, 6
  s_and_b32 s58, s58, 7
  s_lshl_b32 s57, s58, 7
  s_mul_i32 s58, s58, 196608
  s_add_u32 m0, s61, 16384
s_nop 0
  buffer_load_dwordx4 v4, s[4:7], s57 offen lds
  v_and_b32 v22, s60, v171
  v_lshlrev_b32 v23, 16, v171
  v_fmac_f32 v16, v22, v22
  v_fmac_f32 v17, v23, v23
  s_waitcnt lgkmcnt(3)
  v_mfma_f32_32x32x16_bf16 v[64:79], v[172:175], v[120:123], v[64:79]
  ds_read_b128 v[180:183], v9 offset:49152
  ds_read_b64_tr_b16 v[104:105], v13 offset:45056
  ds_read_b64_tr_b16 v[106:107], v13 offset:45312
  v_and_b32 v20, s60, v174
  v_lshlrev_b32 v21, 16, v174
  v_fmac_f32 v16, v20, v20
  v_fmac_f32 v17, v21, v21
  v_mfma_f32_16x16x32_bf16 v[28:31], v[172:175], v[40:43], v[28:31]
  s_add_u32 m0, s61, 17408
s_nop 0
  buffer_load_dwordx4 v5, s[4:7], s57 offen lds
  v_and_b32 v22, s60, v175
  v_lshlrev_b32 v23, 16, v175
  v_fmac_f32 v16, v22, v22
  v_fmac_f32 v17, v23, v23
  s_waitcnt lgkmcnt(3)
  v_mfma_f32_32x32x16_bf16 v[64:79], v[176:179], v[96:99], v[64:79]
  ds_read_b128 v[184:187], v10 offset:49152
  ds_read_b64_tr_b16 v[112:113], v14 offset:45056
  ds_read_b64_tr_b16 v[114:115], v14 offset:45312
  v_and_b32 v20, s60, v178
  v_lshlrev_b32 v21, 16, v178
  v_fmac_f32 v16, v20, v20
  v_fmac_f32 v17, v21, v21
  v_mfma_f32_16x16x32_bf16 v[24:27], v[96:99], v[40:43], v[24:27]
  s_add_u32 m0, s62, 12288
s_nop 0
  buffer_load_dwordx4 v6, s[8:11], s58 offen lds
  v_and_b32 v22, s60, v179
  v_lshlrev_b32 v23, 16, v179
  v_fmac_f32 v16, v22, v22
  v_fmac_f32 v17, v23, v23
  v_mfma_f32_16x16x32_bf16 v[28:31], v[176:179], v[40:43], v[28:31]
  s_waitcnt lgkmcnt(3)
  v_mfma_f32_32x32x16_bf16 v[64:79], v[180:183], v[104:107], v[64:79]
  ds_read_b128 v[188:191], v11 offset:49152
  ds_read_b64_tr_b16 v[120:121], v15 offset:45056
  ds_read_b64_tr_b16 v[122:123], v15 offset:45312
  v_and_b32 v20, s60, v182
  v_lshlrev_b32 v21, 16, v182
  v_fmac_f32 v16, v20, v20
  v_fmac_f32 v17, v21, v21
  v_mfma_f32_16x16x32_bf16 v[28:31], v[180:183], v[40:43], v[28:31]
  s_add_u32 m0, s62, 16384
  s_add_u32 s54, s58, 1024
  buffer_load_dwordx4 v6, s[8:11], s54 offen lds
  v_and_b32 v22, s60, v183
  v_lshlrev_b32 v23, 16, v183
  v_fmac_f32 v16, v22, v22
  v_fmac_f32 v17, v23, v23
  s_waitcnt vmcnt(8)
  s_barrier
  v_add_u32 v8, 0x10000, v8
  v_add_u32 v9, 0x10000, v9
  v_add_u32 v10, 0x10000, v10
  v_add_u32 v11, 0x10000, v11
  s_waitcnt lgkmcnt(3)
  v_mfma_f32_32x32x16_bf16 v[64:79], v[184:187], v[112:115], v[64:79]
  ds_read_b128 v[192:195], v8 offset:0
  ds_read_b64_tr_b16 v[96:97], v12 offset:57344
  ds_read_b64_tr_b16 v[98:99], v12 offset:57600
  v_and_b32 v20, s60, v186
  v_lshlrev_b32 v21, 16, v186
  v_fmac_f32 v16, v20, v20
  v_fmac_f32 v17, v21, v21
  v_mfma_f32_16x16x32_bf16 v[28:31], v[184:187], v[40:43], v[28:31]
  s_add_u32 s58, s93, 7
  s_and_b32 s58, s58, 7
  s_lshl_b32 s57, s58, 7
  s_mul_i32 s58, s58, 196608
  s_add_u32 m0, s61, 32768
s_nop 0
  buffer_load_dwordx4 v4, s[4:7], s57 offen lds
  v_and_b32 v22, s60, v187
  v_lshlrev_b32 v23, 16, v187
  v_fmac_f32 v16, v22, v22
  v_fmac_f32 v17, v23, v23
  s_waitcnt lgkmcnt(3)
  v_mfma_f32_32x32x16_bf16 v[64:79], v[188:191], v[120:123], v[64:79]
  ds_read_b128 v[196:199], v9 offset:0
  ds_read_b64_tr_b16 v[104:105], v13 offset:57344
  ds_read_b64_tr_b16 v[106:107], v13 offset:57600
  v_and_b32 v20, s60, v190
  v_lshlrev_b32 v21, 16, v190
  v_fmac_f32 v16, v20, v20
  v_fmac_f32 v17, v21, v21
  v_mfma_f32_16x16x32_bf16 v[28:31], v[188:191], v[40:43], v[28:31]
  s_add_u32 m0, s61, 33792
s_nop 0
  buffer_load_dwordx4 v5, s[4:7], s57 offen lds
  v_and_b32 v22, s60, v191
  v_lshlrev_b32 v23, 16, v191
  v_fmac_f32 v16, v22, v22
  v_fmac_f32 v17, v23, v23
  s_waitcnt lgkmcnt(3)
  v_mfma_f32_32x32x16_bf16 v[64:79], v[192:195], v[96:99], v[64:79]
  ds_read_b128 v[200:203], v10 offset:0
  ds_read_b64_tr_b16 v[112:113], v14 offset:57344
  ds_read_b64_tr_b16 v[114:115], v14 offset:57600
  v_and_b32 v20, s60, v194
  v_lshlrev_b32 v21, 16, v194
  v_fmac_f32 v16, v20, v20
  v_fmac_f32 v17, v21, v21
  v_mfma_f32_16x16x32_bf16 v[24:27], v[96:99], v[40:43], v[24:27]
  s_add_u32 m0, s62, 24576
s_nop 0
  buffer_load_dwordx4 v6, s[8:11], s58 offen lds
  v_and_b32 v22, s60, v195
  v_lshlrev_b32 v23, 16, v195
  v_fmac_f32 v16, v22, v22
  v_fmac_f32 v17, v23, v23
  v_mfma_f32_16x16x32_bf16 v[28:31], v[192:195], v[40:43], v[28:31]
  s_waitcnt lgkmcnt(3)
  v_mfma_f32_32x32x16_bf16 v[64:79], v[196:199], v[104:107], v[64:79]
  ds_read_b128 v[204:207], v11 offset:0
  ds_read_b64_tr_b16 v[120:121], v15 offset:57344
  ds_read_b64_tr_b16 v[122:123], v15 offset:57600
  v_and_b32 v20, s60, v198
  v_lshlrev_b32 v21, 16, v198
  v_fmac_f32 v16, v20, v20
  v_fmac_f32 v17, v21, v21
  v_mfma_f32_16x16x32_bf16 v[28:31], v[196:199], v[40:43], v[28:31]
  s_add_u32 m0, s62, 28672
  s_add_u32 s54, s58, 1024
  buffer_load_dwordx4 v6, s[8:11], s54 offen lds
  v_and_b32 v22, s60, v199
  v_lshlrev_b32 v23, 16, v199
  v_fmac_f32 v16, v22, v22
  v_fmac_f32 v17, v23, v23
  s_waitcnt vmcnt(8)
  s_barrier
  v_subrev_u32 v8, 0x10000, v8
  v_subrev_u32 v9, 0x10000, v9
  v_subrev_u32 v10, 0x10000, v10
  v_subrev_u32 v11, 0x10000, v11
  s_waitcnt lgkmcnt(3)
  v_mfma_f32_32x32x16_bf16 v[64:79], v[200:203], v[112:115], v[64:79]
  ds_read_b128 v[208:211], v8 offset:0
  ds_read_b64_tr_b16 v[96:97], v12 offset:8192
  ds_read_b64_tr_b16 v[98:99], v12 offset:8448
  v_and_b32 v20, s60, v202
  v_lshlrev_b32 v21, 16, v202
  v_fmac_f32 v16, v20, v20
  v_fmac_f32 v17, v21, v21
  v_mfma_f32_16x16x32_bf16 v[28:31], v[200:203], v[40:43], v[28:31]
  s_add_u32 m0, s63, 49152
  s_add_u32 s54, s98, 0
  s_and_b32 s54, s54, 7
  s_mul_i32 s54, s54, 229376
  buffer_load_dwordx4 v7, s[12:15], s54 offen lds
  v_and_b32 v22, s60, v203
  v_lshlrev_b32 v23, 16, v203
  v_fmac_f32 v16, v22, v22
  v_fmac_f32 v17, v23, v23
  s_waitcnt lgkmcnt(3)
  v_mfma_f32_32x32x16_bf16 v[64:79], v[204:207], v[120:123], v[64:79]
  ds_read_b128 v[212:215], v9 offset:0
  ds_read_b64_tr_b16 v[104:105], v13 offset:8192
  ds_read_b64_tr_b16 v[106:107], v13 offset:8448
  v_and_b32 v20, s60, v206
  v_lshlrev_b32 v21, 16, v206
  v_fmac_f32 v16, v20, v20
  v_fmac_f32 v17, v21, v21
  v_mfma_f32_16x16x32_bf16 v[28:31], v[204:207], v[40:43], v[28:31]
  s_add_u32 m0, s63, 50176
  s_add_u32 s54, s98, 0
  s_and_b32 s54, s54, 7
  s_mul_i32 s54, s54, 229376
  s_add_u32 s54, s54, 57344
  buffer_load_dwordx4 v7, s[12:15], s54 offen lds
  v_and_b32 v22, s60, v207
  v_lshlrev_b32 v23, 16, v207
  v_fmac_f32 v16, v22, v22
  v_fmac_f32 v17, v23, v23
  s_waitcnt lgkmcnt(3)
  v_mfma_f32_32x32x16_bf16 v[64:79], v[208:211], v[96:99], v[64:79]
  ds_read_b128 v[216:219], v10 offset:0
  ds_read_b64_tr_b16 v[112:113], v14 offset:8192
  ds_read_b64_tr_b16 v[114:115], v14 offset:8448
  v_and_b32 v20, s60, v210
  v_lshlrev_b32 v21, 16, v210
  v_fmac_f32 v16, v20, v20
  v_fmac_f32 v17, v21, v21
  v_mfma_f32_16x16x32_bf16 v[24:27], v[96:99], v[40:43], v[24:27]
  v_and_b32 v22, s60, v211
  v_lshlrev_b32 v23, 16, v211
  v_fmac_f32 v16, v22, v22
  v_fmac_f32 v17, v23, v23
  v_mfma_f32_16x16x32_bf16 v[28:31], v[208:211], v[40:43], v[28:31]
  s_waitcnt lgkmcnt(3)
  v_mfma_f32_32x32x16_bf16 v[64:79], v[212:215], v[104:107], v[64:79]
  ds_read_b128 v[220:223], v11 offset:0
  ds_read_b64_tr_b16 v[120:121], v15 offset:8192
  ds_read_b64_tr_b16 v[122:123], v15 offset:8448
  v_and_b32 v20, s60, v214
  v_lshlrev_b32 v21, 16, v214
  v_fmac_f32 v16, v20, v20
  v_fmac_f32 v17, v21, v21
  v_mfma_f32_16x16x32_bf16 v[28:31], v[212:215], v[40:43], v[28:31]
  v_and_b32 v22, s60, v215
  v_lshlrev_b32 v23, 16, v215
  v_fmac_f32 v16, v22, v22
  v_fmac_f32 v17, v23, v23
  s_waitcnt vmcnt(6)
  s_barrier
  buffer_load_dword v6, off, s[40:43], 0 sc1
  s_waitcnt lgkmcnt(3)
  v_mfma_f32_32x32x16_bf16 v[64:79], v[216:219], v[112:115], v[64:79]
  ds_read_b128 v[224:227], v8 offset:16384
  ds_read_b64_tr_b16 v[96:97], v12 offset:20480
  ds_read_b64_tr_b16 v[98:99], v12 offset:20736
  v_and_b32 v20, s60, v218
  v_lshlrev_b32 v21, 16, v218
  v_fmac_f32 v16, v20, v20
  v_fmac_f32 v17, v21, v21
  v_mfma_f32_16x16x32_bf16 v[28:31], v[216:219], v[40:43], v[28:31]
  s_add_u32 m0, s63, 65536
  s_add_u32 s54, s98, 2
  s_and_b32 s54, s54, 7
  s_mul_i32 s54, s54, 229376
  buffer_load_dwordx4 v7, s[12:15], s54 offen lds
  v_and_b32 v22, s60, v219
  v_lshlrev_b32 v23, 16, v219
  v_fmac_f32 v16, v22, v22
  v_fmac_f32 v17, v23, v23
  s_waitcnt lgkmcnt(3)
  v_mfma_f32_32x32x16_bf16 v[64:79], v[220:223], v[120:123], v[64:79]
  ds_read_b128 v[228:231], v9 offset:16384
  ds_read_b64_tr_b16 v[104:105], v13 offset:20480
  ds_read_b64_tr_b16 v[106:107], v13 offset:20736
  v_and_b32 v20, s60, v222
  v_lshlrev_b32 v21, 16, v222
  v_fmac_f32 v16, v20, v20
  v_fmac_f32 v17, v21, v21
  v_mfma_f32_16x16x32_bf16 v[28:31], v[220:223], v[40:43], v[28:31]
  s_add_u32 m0, s63, 66560
  s_add_u32 s54, s98, 2
  s_and_b32 s54, s54, 7
  s_mul_i32 s54, s54, 229376
  s_add_u32 s54, s54, 57344
  buffer_load_dwordx4 v7, s[12:15], s54 offen lds
  v_and_b32 v22, s60, v223
  v_lshlrev_b32 v23, 16, v223
  v_fmac_f32 v16, v22, v22
  v_fmac_f32 v17, v23, v23
  s_waitcnt lgkmcnt(3)
  v_mfma_f32_32x32x16_bf16 v[64:79], v[224:227], v[96:99], v[64:79]
  ds_read_b128 v[232:235], v10 offset:16384
  ds_read_b64_tr_b16 v[112:113], v14 offset:20480
  ds_read_b64_tr_b16 v[114:115], v14 offset:20736
  v_and_b32 v20, s60, v226
  v_lshlrev_b32 v21, 16, v226
  v_fmac_f32 v16, v20, v20
  v_fmac_f32 v17, v21, v21
  v_mfma_f32_16x16x32_bf16 v[24:27], v[96:99], v[40:43], v[24:27]
  v_and_b32 v22, s60, v227
  v_lshlrev_b32 v23, 16, v227
  v_fmac_f32 v16, v22, v22
  v_fmac_f32 v17, v23, v23
  v_mfma_f32_16x16x32_bf16 v[28:31], v[224:227], v[40:43], v[28:31]
  s_waitcnt lgkmcnt(3)
  v_mfma_f32_32x32x16_bf16 v[64:79], v[228:231], v[104:107], v[64:79]
  ds_read_b128 v[236:239], v11 offset:16384
  ds_read_b64_tr_b16 v[120:121], v15 offset:20480
  ds_read_b64_tr_b16 v[122:123], v15 offset:20736
  v_and_b32 v20, s60, v230
  v_lshlrev_b32 v21, 16, v230
  v_fmac_f32 v16, v20, v20
  v_fmac_f32 v17, v21, v21
  v_mfma_f32_16x16x32_bf16 v[28:31], v[228:231], v[40:43], v[28:31]
  v_and_b32 v22, s60, v231
  v_lshlrev_b32 v23, 16, v231
  v_fmac_f32 v16, v22, v22
  v_fmac_f32 v17, v23, v23
  s_waitcnt vmcnt(5)
  s_barrier
  s_waitcnt lgkmcnt(3)
  v_mfma_f32_32x32x16_bf16 v[64:79], v[232:235], v[112:115], v[64:79]
  ds_read_b128 v[240:243], v8 offset:32768
  ds_read_b64_tr_b16 v[96:97], v12 offset:32768
  ds_read_b64_tr_b16 v[98:99], v12 offset:33024
  v_and_b32 v20, s60, v234
  v_lshlrev_b32 v21, 16, v234
  v_fmac_f32 v16, v20, v20
  v_fmac_f32 v17, v21, v21
  v_mfma_f32_16x16x32_bf16 v[28:31], v[232:235], v[40:43], v[28:31]
  s_add_u32 m0, s63, 0
  s_add_u32 s54, s98, 4
  s_and_b32 s54, s54, 7
  s_mul_i32 s54, s54, 229376
  buffer_load_dwordx4 v7, s[12:15], s54 offen lds
  v_and_b32 v22, s60, v235
  v_lshlrev_b32 v23, 16, v235
  v_fmac_f32 v16, v22, v22
  v_fmac_f32 v17, v23, v23
  s_waitcnt lgkmcnt(3)
  v_mfma_f32_32x32x16_bf16 v[64:79], v[236:239], v[120:123], v[64:79]
  ds_read_b128 v[244:247], v9 offset:32768
  ds_read_b64_tr_b16 v[104:105], v13 offset:32768
  ds_read_b64_tr_b16 v[106:107], v13 offset:33024
  v_and_b32 v20, s60, v238
  v_lshlrev_b32 v21, 16, v238
  v_fmac_f32 v16, v20, v20
  v_fmac_f32 v17, v21, v21
  v_mfma_f32_16x16x32_bf16 v[28:31], v[236:239], v[40:43], v[28:31]
  s_add_u32 m0, s63, 1024
  s_add_u32 s54, s98, 4
  s_and_b32 s54, s54, 7
  s_mul_i32 s54, s54, 229376
  s_add_u32 s54, s54, 57344
  buffer_load_dwordx4 v7, s[12:15], s54 offen lds
  v_and_b32 v22, s60, v239
  v_lshlrev_b32 v23, 16, v239
  v_fmac_f32 v16, v22, v22
  v_fmac_f32 v17, v23, v23
  s_waitcnt lgkmcnt(3)
  v_mfma_f32_32x32x16_bf16 v[64:79], v[240:243], v[96:99], v[64:79]
  ds_read_b128 v[248:251], v10 offset:32768
  ds_read_b64_tr_b16 v[112:113], v14 offset:32768
  ds_read_b64_tr_b16 v[114:115], v14 offset:33024
  v_and_b32 v20, s60, v242
  v_lshlrev_b32 v21, 16, v242
  v_fmac_f32 v16, v20, v20
  v_fmac_f32 v17, v21, v21
  v_mfma_f32_16x16x32_bf16 v[24:27], v[96:99], v[40:43], v[24:27]
  v_and_b32 v22, s60, v243
  v_lshlrev_b32 v23, 16, v243
  v_fmac_f32 v16, v22, v22
  v_fmac_f32 v17, v23, v23
  v_mfma_f32_16x16x32_bf16 v[28:31], v[240:243], v[40:43], v[28:31]
  s_waitcnt lgkmcnt(3)
  v_mfma_f32_32x32x16_bf16 v[64:79], v[244:247], v[104:107], v[64:79]
  ds_read_b128 v[252:255], v11 offset:32768
  ds_read_b64_tr_b16 v[120:121], v15 offset:32768
  ds_read_b64_tr_b16 v[122:123], v15 offset:33024
  v_and_b32 v20, s60, v246
  v_lshlrev_b32 v21, 16, v246
  v_fmac_f32 v16, v20, v20
  v_fmac_f32 v17, v21, v21
  v_mfma_f32_16x16x32_bf16 v[28:31], v[244:247], v[40:43], v[28:31]
  v_and_b32 v22, s60, v247
  v_lshlrev_b32 v23, 16, v247
  v_fmac_f32 v16, v22, v22
  v_fmac_f32 v17, v23, v23
  s_waitcnt lgkmcnt(3)
  v_mfma_f32_32x32x16_bf16 v[64:79], v[248:251], v[112:115], v[64:79]
  v_and_b32 v20, s60, v250
  v_lshlrev_b32 v21, 16, v250
  v_fmac_f32 v16, v20, v20
  v_fmac_f32 v17, v21, v21
  v_mfma_f32_16x16x32_bf16 v[28:31], v[248:251], v[40:43], v[28:31]
  v_and_b32 v22, s60, v251
  v_lshlrev_b32 v23, 16, v251
  v_fmac_f32 v16, v22, v22
  v_fmac_f32 v17, v23, v23
  s_waitcnt lgkmcnt(0)
  v_mfma_f32_32x32x16_bf16 v[64:79], v[252:255], v[120:123], v[64:79]
  v_and_b32 v20, s60, v254
  v_lshlrev_b32 v21, 16, v254
  v_fmac_f32 v16, v20, v20
  v_fmac_f32 v17, v21, v21
  v_mfma_f32_16x16x32_bf16 v[28:31], v[252:255], v[40:43], v[28:31]
  v_and_b32 v22, s60, v255
  v_lshlrev_b32 v23, 16, v255
  v_fmac_f32 v16, v22, v22
  v_fmac_f32 v17, v23, v23
  v_add_f32 v16, v16, v17
  v_and_b32 v96, 31, v0
  v_lshlrev_b32 v97, 4, v96
  s_lshl_b32 s52, s45, 9
  s_add_u32 s52, s52, 143360
  v_add_u32 v97, s52, v97
  v_lshrrev_b32 v98, 5, v0
  v_lshlrev_b32 v98, 2, v98
  v_add3_u32 v98, v98, v97, 8
  ds_write_b32 v98, v16
  s_mov_b64 exec, s[96:97]
  ds_write_b32 v18, v24 offset:1024
  ds_write_b32 v18, v25 offset:1040
  ds_write_b32 v18, v26 offset:1056
  ds_write_b32 v18, v27 offset:1072
  ds_write_b128 v19, v[28:31]
  s_mov_b64 exec, -1
  v_lshlrev_b32 v98, 2, v96
  s_lshl_b32 s52, s45, 7
  s_add_u32 s52, s52, 145408
  v_add_u32 v98, s52, v98
  v_lshlrev_b32 v99, 4, v96
  v_add_u32 v99, 147456, v99
  s_waitcnt lgkmcnt(0)
  s_waitcnt vmcnt(4)
  v_cmp_eq_u32 vcc, 1, v6
s_nop 3
s_cbranch_vccnz ok_13
  s_mov_b32 s11, 20000
spin_14:
  s_sleep 1
  buffer_load_dword v6, off, s[40:43], 0 sc1
  s_waitcnt vmcnt(0)
  v_cmp_eq_u32 vcc, 1, v6
s_nop 3
s_cbranch_vccnz ok_13
  s_sub_u32 s11, s11, 1
  s_cmp_lg_u32 s11, 0
s_cbranch_scc1 spin_14
  v_mov_b32 v6, 1
  buffer_store_dword v6, off, s[40:43], 0 offset:4
s_nop 0
ok_13:
  s_barrier
  ds_read_b128 v[100:103], v97
  ds_read_b32 v108, v98
  ds_read_b128 v[104:107], v99 offset:1024
  v_lshrrev_b32 v44, 2, v0
  v_lshlrev_b32 v44, 10, v44
  v_and_b32 v45, 3, v0
  v_lshlrev_b32 v45, 4, v45
  s_and_b32 s52, s2, 1
  s_lshl_b32 s52, s52, 3
  s_add_u32 s52, s52, s44
  s_lshl_b32 s52, s52, 6
  v_add3_u32 v44, v44, v45, s52
  s_lshr_b32 s58, s2, 1
  s_lshl_b32 s53, s44, 10
  s_add_u32 m0, s53, 81920
  s_lshl_b32 s54, s58, 14
  s_cmp_ge_u32 s2, 224
s_cbranch_scc1 prep_wo_15
  buffer_load_dwordx4 v44, s[20:23], s54 offen lds
s_branch prep_j_16
prep_wo_15:
  s_sub_u32 s54, s54, 1835008
  buffer_load_dwordx4 v44, s[24:27], s54 offen lds
prep_j_16:
  s_cmp_ge_u32 s2, 32
  s_cselect_b32 s57, 0x40000000, 0
  s_lshr_b32 s54, s2, 1
  s_add_u32 s54, s54, 16
  s_lshl_b32 s54, s54, 14
  s_add_u32 m0, s53, 90112
  v_add_u32 v44, s57, v44
  buffer_load_dwordx4 v44, s[24:27], s54 offen lds
  v_and_b32 v46, 31, v0
  v_and_b32 v47, 19, v46
  v_bfe_u32 v24, v0, 2, 1
  v_lshlrev_b32 v24, 3, v24
  v_bfe_u32 v25, v0, 3, 1
  v_lshlrev_b32 v25, 2, v25
  v_add3_u32 v47, v47, v24, v25
  v_lshlrev_b32 v47, 1, v47
  s_lshl_b32 s52, s46, 1
  s_add_u32 s52, s52, s51
  s_lshl_b32 s52, s52, 6
  s_add_u32 s53, s52, s64
  buffer_load_ushort v16, v47, s[28:31], s52 offen
  buffer_load_ushort v17, v47, s[28:31], s53 offen
  s_waitcnt lgkmcnt(1)
  v_add_f32 v100, v100, v101
  v_add_f32 v102, v102, v103
  v_mul_f32 v2, 0x3b000000, v108
  v_add_f32 v100, v100, v102
  v_mul_f32 v100, 0x3b000000, v100
  v_fma_f32 v100, -v2, v2, v100
  v_max_f32 v100, 0, v100
  v_add_f32 v101, 0x3727c5ac, v100
  v_rsq_f32 v3, v101
  s_add_u32 m0, s63, 16384
  s_add_u32 s54, s98, 6
  s_and_b32 s54, s54, 7
  s_mul_i32 s54, s54, 229376
  buffer_load_dwordx4 v7, s[12:15], s54 offen lds
  s_waitcnt lgkmcnt(0)
  v_add_f32 v104, v104, v105
  v_add_f32 v106, v106, v107
  v_mul_f32 v101, v3, v3
  v_mul_f32 v101, v101, v100
  v_add_f32 v101, 0x3727c5ac, v101
  v_rsq_f32 v101, v101
  v_add_f32 v104, v104, v106
  s_lshl_b32 s52, s44, 8
  s_add_u32 s52, s52, 151040
  v_lshlrev_b32 v20, 2, v0
  v_add_u32 v20, s52, v20
  v_lshrrev_b32 v21, 5, v0
  v_lshlrev_b32 v21, 4, v21
  v_add_u32 v21, s52, v21
  v_mul_f32 v4, v3, v101
  v_mul_f32 v5, v2, v4
  v_mul_f32 v105, v2, v3
  v_cmp_gt_u32 vcc, 32, v0
s_nop 1
  v_cndmask_b32 v105, v105, v3, vcc
  ds_write_b32 v20, v105
  v_mov_b32 v22, v104
  v_bfe_u32 v23, v0, 4, 1
  v_lshlrev_b32 v23, 17, v23
  v_and_b32 v99, 15, v0
  v_lshlrev_b32 v99, 4, v99
  v_add_u32 v23, v23, v99
  v_lshrrev_b32 v99, 5, v0
  v_lshlrev_b32 v99, 8, v99
  v_add_u32 v23, v23, v99
  s_add_u32 m0, s63, 17408
  s_add_u32 s54, s98, 6
  s_and_b32 s54, s54, 7
  s_mul_i32 s54, s54, 229376
  s_add_u32 s54, s54, 57344
  buffer_load_dwordx4 v7, s[12:15], s54 offen lds
  s_lshl_b32 s52, s50, 17
  s_lshl_b32 s53, s65, 10
  s_add_u32 s66, s52, s53
  s_lshl_b32 s52, s50, 18
  s_lshl_b32 s53, s65, 11
  s_add_u32 s67, s52, s53
  s_add_u32 s67, s67, 2097152
  s_lshl_b32 s52, s46, 13
  s_sub_u32 s52, s52, 81920
  v_add_u32 v12, s52, v12
  v_add_u32 v13, s52, v13
  v_add_u32 v14, s52, v14
  v_add_u32 v15, s52, v15
  v_add_u32 v8, 0x10000, v12
  v_add_u32 v9, 0x10000, v13
  v_add_u32 v10, 0x10000, v14
  v_add_u32 v11, 0x10000, v15
  s_add_u32 m0, s63, 32768
  s_add_u32 s54, s98, 0
  s_and_b32 s54, s54, 7
  s_mul_i32 s54, s54, 229376
  s_add_u32 s54, s54, s64
  buffer_load_dwordx4 v7, s[12:15], s54 offen lds
  s_add_u32 m0, s63, 33792
  s_add_u32 s54, s98, 0
  s_and_b32 s54, s54, 7
  s_mul_i32 s54, s54, 229376
  s_add_u32 s54, s54, 57344
  s_add_u32 s54, s54, s64
  buffer_load_dwordx4 v7, s[12:15], s54 offen lds
  s_barrier
  ds_read_b64_tr_b16 v[96:97], v12 offset:49152
  ds_read_b64_tr_b16 v[98:99], v12 offset:49408
  ds_read_b128 v[24:27], v21 offset:0
  ds_read_b128 v[28:31], v21 offset:128
  ds_read_b128 v[80:83], v21 offset:32
  ds_read_b128 v[84:87], v21 offset:160
  s_waitcnt lgkmcnt(2)
  v_mul_f32 v28, v22, v28
  v_mul_f32 v29, v22, v29
  v_mul_f32 v30, v22, v30
  v_mul_f32 v31, v22, v31
  ds_read_b64_tr_b16 v[100:101], v12 offset:53248
  ds_read_b64_tr_b16 v[102:103], v12 offset:53504
  v_fma_f32 v64, v64, v24, -v28
  v_fma_f32 v65, v65, v25, -v29
  v_fma_f32 v66, v66, v26, -v30
  v_fma_f32 v67, v67, v27, -v31
  ds_read_b128 v[24:27], v21 offset:64
  ds_read_b128 v[28:31], v21 offset:192
  v_cvt_pk_bf16_f32 v64, v64, v65
  ds_read_b64_tr_b16 v[104:105], v13 offset:49152
  ds_read_b64_tr_b16 v[106:107], v13 offset:49408
  v_cvt_pk_bf16_f32 v65, v66, v67
  s_waitcnt lgkmcnt(6)
  v_mul_f32 v84, v22, v84
  v_mul_f32 v85, v22, v85
  v_mul_f32 v86, v22, v86
  v_mul_f32 v87, v22, v87
  ds_read_b64_tr_b16 v[108:109], v13 offset:53248
  ds_read_b64_tr_b16 v[110:111], v13 offset:53504
  v_fma_f32 v68, v68, v80, -v84
  v_fma_f32 v69, v69, v81, -v85
  v_fma_f32 v70, v70, v82, -v86
  v_fma_f32 v71, v71, v83, -v87
  ds_read_b128 v[80:83], v21 offset:96
  ds_read_b128 v[84:87], v21 offset:224
  v_cvt_pk_bf16_f32 v66, v68, v69
  v_mfma_f32_32x32x16_bf16 v[48:63], v[96:99], v[128:131], 0
  ds_read_b64_tr_b16 v[112:113], v14 offset:49152
  ds_read_b64_tr_b16 v[114:115], v14 offset:49408
  v_cvt_pk_bf16_f32 v67, v70, v71
  buffer_store_dwordx4 v[64:67], v23, s[16:19], s67 offen offset:1024 sc1
  s_waitcnt lgkmcnt(8)
  v_mul_f32 v28, v22, v28
  v_mfma_f32_16x16x32_bf16 v[32:35], v[96:99], v[40:43], 0
  v_mfma_f32_32x32x16_bf16 v[48:63], v[100:103], v[144:147], v[48:63]
  ds_read_b64_tr_b16 v[116:117], v14 offset:53248
  ds_read_b64_tr_b16 v[118:119], v14 offset:53504
  v_mul_f32 v29, v22, v29
  v_mul_f32 v30, v22, v30
  v_mul_f32 v31, v22, v31
  v_mfma_f32_16x16x32_bf16 v[32:35], v[100:103], v[40:43], v[32:35]
  s_waitcnt lgkmcnt(8)
  v_mfma_f32_32x32x16_bf16 v[48:63], v[104:107], v[132:135], v[48:63]
  ds_read_b64_tr_b16 v[120:121], v15 offset:49152
  ds_read_b64_tr_b16 v[122:123], v15 offset:49408
  v_fma_f32 v72, v72, v24, -v28
  v_fma_f32 v73, v73, v25, -v29
  v_fma_f32 v74, v74, v26, -v30
  s_waitcnt lgkmcnt(8)
  v_mfma_f32_32x32x16_bf16 v[48:63], v[108:111], v[148:151], v[48:63]
  ds_read_b64_tr_b16 v[124:125], v15 offset:53248
  ds_read_b64_tr_b16 v[126:127], v15 offset:53504
  v_fma_f32 v75, v75, v27, -v31
  v_cvt_pk_bf16_f32 v68, v72, v73
  v_cvt_pk_bf16_f32 v69, v74, v75
  s_waitcnt vmcnt(11)
  s_barrier
  s_waitcnt lgkmcnt(6)
  v_mfma_f32_32x32x16_bf16 v[48:63], v[112:115], v[136:139], v[48:63]
  ds_read_b64_tr_b16 v[96:97], v8 offset:0
  ds_read_b64_tr_b16 v[98:99], v8 offset:256
  v_mul_f32 v84, v22, v84
  v_mul_f32 v85, v22, v85
  s_waitcnt lgkmcnt(6)
  v_mfma_f32_32x32x16_bf16 v[48:63], v[116:119], v[152:155], v[48:63]
  ds_read_b64_tr_b16 v[100:101], v8 offset:4096
  ds_read_b64_tr_b16 v[102:103], v8 offset:4352
  s_add_u32 m0, s63, 98304
  s_add_u32 s54, s98, 2
  s_and_b32 s54, s54, 7
  s_mul_i32 s54, s54, 229376
  s_add_u32 s54, s54, s64
  buffer_load_dwordx4 v7, s[12:15], s54 offen lds
  v_mul_f32 v86, v22, v86
  v_mul_f32 v87, v22, v87
  v_fma_f32 v76, v76, v80, -v84
  s_waitcnt lgkmcnt(6)
  v_mfma_f32_32x32x16_bf16 v[48:63], v[120:123], v[140:143], v[48:63]
  ds_read_b64_tr_b16 v[104:105], v9 offset:0
  ds_read_b64_tr_b16 v[106:107], v9 offset:256
  v_fma_f32 v77, v77, v81, -v85
  v_fma_f32 v78, v78, v82, -v86
  v_fma_f32 v79, v79, v83, -v87
  s_waitcnt lgkmcnt(6)
  v_mfma_f32_32x32x16_bf16 v[48:63], v[124:127], v[156:159], v[48:63]
  ds_read_b64_tr_b16 v[108:109], v9 offset:4096
  ds_read_b64_tr_b16 v[110:111], v9 offset:4352
  v_cvt_pk_bf16_f32 v70, v76, v77
  v_cvt_pk_bf16_f32 v71, v78, v79
  buffer_store_dwordx4 v[68:71], v23, s[16:19], s67 offen offset:1536 sc1
  s_waitcnt lgkmcnt(6)
  v_mfma_f32_32x32x16_bf16 v[48:63], v[96:99], v[160:163], v[48:63]
  ds_read_b64_tr_b16 v[112:113], v10 offset:0
  ds_read_b64_tr_b16 v[114:115], v10 offset:256
  v_mfma_f32_16x16x32_bf16 v[32:35], v[96:99], v[40:43], v[32:35]
  s_waitcnt lgkmcnt(6)
  v_mfma_f32_32x32x16_bf16 v[48:63], v[100:103], v[176:179], v[48:63]
  ds_read_b64_tr_b16 v[116:117], v10 offset:4096
  ds_read_b64_tr_b16 v[118:119], v10 offset:4352
  s_add_u32 m0, s63, 99328
  s_add_u32 s54, s98, 2
  s_and_b32 s54, s54, 7
  s_mul_i32 s54, s54, 229376
  s_add_u32 s54, s54, 57344
  s_add_u32 s54, s54, s64
  buffer_load_dwordx4 v7, s[12:15], s54 offen lds
  v_mfma_f32_16x16x32_bf16 v[32:35], v[100:103], v[40:43], v[32:35]
  s_waitcnt lgkmcnt(6)
  v_mfma_f32_32x32x16_bf16 v[48:63], v[104:107], v[164:167], v[48:63]
  ds_read_b64_tr_b16 v[120:121], v11 offset:0
  ds_read_b64_tr_b16 v[122:123], v11 offset:256
  s_waitcnt lgkmcnt(6)
  v_mfma_f32_32x32x16_bf16 v[48:63], v[108:111], v[180:183], v[48:63]
  ds_read_b64_tr_b16 v[124:125], v11 offset:4096
  ds_read_b64_tr_b16 v[126:127], v11 offset:4352
  s_waitcnt vmcnt(12)
  s_barrier
  s_waitcnt lgkmcnt(6)
  v_mfma_f32_32x32x16_bf16 v[48:63], v[112:115], v[168:171], v[48:63]
  ds_read_b64_tr_b16 v[96:97], v12 offset:0
  ds_read_b64_tr_b16 v[98:99], v12 offset:256
  s_lshl_b32 s52, s47, 2
  s_lshr_b32 s25, s48, 3
  s_add_u32 s20, s52, s25
  s_and_b32 s53, s48, 7
  s_lshl_b32 s21, s53, 3
  s_add_u32 s21, s21, s44
  s_waitcnt lgkmcnt(6)
  v_mfma_f32_32x32x16_bf16 v[48:63], v[116:119], v[184:187], v[48:63]
  ds_read_b64_tr_b16 v[100:101], v12 offset:4096
  ds_read_b64_tr_b16 v[102:103], v12 offset:4352
  s_add_u32 m0, s63, 114688
  s_add_u32 s54, s98, 4
  s_and_b32 s54, s54, 7
  s_mul_i32 s54, s54, 229376
  s_add_u32 s54, s54, s64
  buffer_load_dwordx4 v7, s[12:15], s54 offen lds
  s_lshl_b32 s23, s44, 10
  s_lshl_b32 s22, s20, 17
  s_add_u32 s22, s22, 2097152
  s_add_u32 s22, s22, s23
  s_lshl_b32 s26, s21, 5
  s_waitcnt lgkmcnt(6)
  v_mfma_f32_32x32x16_bf16 v[48:63], v[120:123], v[172:175], v[48:63]
  ds_read_b64_tr_b16 v[104:105], v13 offset:0
  ds_read_b64_tr_b16 v[106:107], v13 offset:256
  s_add_u32 s26, s26, s20
  s_lshl_b32 s26, s26, 10
  s_add_u32 s26, s26, 16777216
  s_lshl_b32 s52, s47, 3
  s_add_u32 s24, s52, s53
  s_lshl_b32 s27, s24, 3
  s_waitcnt lgkmcnt(6)
  v_mfma_f32_32x32x16_bf16 v[48:63], v[124:127], v[188:191], v[48:63]
  ds_read_b64_tr_b16 v[108:109], v13 offset:4096
  ds_read_b64_tr_b16 v[110:111], v13 offset:4352
  s_add_u32 s27, s27, s44
  s_lshl_b32 s27, s27, 12
  s_add_u32 s27, s27, 16777216
  s_mul_i32 s52, s45, 28
  s_mul_i32 s8, s24, 112
  s_waitcnt lgkmcnt(6)
  v_mfma_f32_32x32x16_bf16 v[48:63], v[96:99], v[192:195], v[48:63]
  ds_read_b64_tr_b16 v[112:113], v14 offset:0
  ds_read_b64_tr_b16 v[114:115], v14 offset:256
  s_add_u32 s8, s8, s52
  s_lshl_b32 s8, s8, 10
  s_add_u32 s8, s8, 6291456
  s_lshl_b32 s9, s52, 4
  s_lshl_b32 s53, s25, 2
  s_add_u32 s9, s9, s53
  v_mfma_f32_16x16x32_bf16 v[32:35], v[96:99], v[40:43], v[32:35]
  s_waitcnt lgkmcnt(6)
  v_mfma_f32_32x32x16_bf16 v[48:63], v[100:103], v[208:211], v[48:63]
  ds_read_b64_tr_b16 v[116:117], v14 offset:4096
  ds_read_b64_tr_b16 v[118:119], v14 offset:4352
  s_add_u32 m0, s63, 115712
  s_add_u32 s54, s98, 4
  s_and_b32 s54, s54, 7
  s_mul_i32 s54, s54, 229376
  s_add_u32 s54, s54, 57344
  s_add_u32 s54, s54, s64
  buffer_load_dwordx4 v7, s[12:15], s54 offen lds
  s_add_u32 s9, s9, s46
  s_add_u32 s9, s9, s46
  s_lshl_b32 s9, s9, 10
  s_add_u32 s9, s9, 13631488
  s_lshl_b32 s10, s46, 4
  v_mfma_f32_16x16x32_bf16 v[32:35], v[100:103], v[40:43], v[32:35]
  s_waitcnt lgkmcnt(6)
  v_mfma_f32_32x32x16_bf16 v[48:63], v[104:107], v[196:199], v[48:63]
  ds_read_b64_tr_b16 v[120:121], v15 offset:0
  ds_read_b64_tr_b16 v[122:123], v15 offset:256
  s_add_u32 s10, s10, 112
  s_lshl_b32 s10, s10, 4
  s_add_u32 s10, s10, s53
  s_add_u32 s10, s10, s45
  s_lshl_b32 s10, s10, 10
  s_add_u32 s10, s10, 13631488
  s_waitcnt lgkmcnt(6)
  v_mfma_f32_32x32x16_bf16 v[48:63], v[108:111], v[212:215], v[48:63]
  ds_read_b64_tr_b16 v[124:125], v15 offset:4096
  ds_read_b64_tr_b16 v[126:127], v15 offset:4352
  v_mov_b32 v24, -1
  v_mov_b32 v25, -1
  v_mov_b32 v26, -1
  v_mov_b32 v27, -1
  buffer_store_dwordx4 v[24:27], v1, s[16:19], s26 offen sc1
  s_waitcnt vmcnt(9)
  s_barrier
  s_waitcnt lgkmcnt(6)
  v_mfma_f32_32x32x16_bf16 v[48:63], v[112:115], v[200:203], v[48:63]
  ds_read_b64_tr_b16 v[96:97], v12 offset:16384
  ds_read_b64_tr_b16 v[98:99], v12 offset:16640
  v_lshrrev_b32 v80, 5, v0
  v_lshlrev_b32 v80, 9, v80
  v_bfe_u32 v81, v0, 2, 2
  v_lshlrev_b32 v81, 6, v81
  v_add_u32 v80, v80, v81
  s_waitcnt lgkmcnt(6)
  v_mfma_f32_32x32x16_bf16 v[48:63], v[116:119], v[216:219], v[48:63]
  ds_read_b64_tr_b16 v[100:101], v12 offset:20480
  ds_read_b64_tr_b16 v[102:103], v12 offset:20736
  v_bfe_u32 v81, v0, 4, 1
  v_lshlrev_b32 v81, 5, v81
  v_add_u32 v80, v80, v81
  v_and_b32 v81, 3, v0
  v_lshlrev_b32 v81, 3, v81
  s_waitcnt lgkmcnt(6)
  v_mfma_f32_32x32x16_bf16 v[48:63], v[120:123], v[204:207], v[48:63]
  ds_read_b64_tr_b16 v[104:105], v13 offset:16384
  ds_read_b64_tr_b16 v[106:107], v13 offset:16640
  s_lshl_b32 s52, s44, 10
  s_add_u32 s52, s52, 81920
  v_add3_u32 v80, v80, v81, s52
  v_add_u32 v82, s57, v1
  s_waitcnt lgkmcnt(6)
  v_mfma_f32_32x32x16_bf16 v[48:63], v[124:127], v[220:223], v[48:63]
  ds_read_b64_tr_b16 v[108:109], v13 offset:20480
  ds_read_b64_tr_b16 v[110:111], v13 offset:20736
  ds_read_b64_tr_b16 v[84:85], v80
  ds_read_b64_tr_b16 v[86:87], v80 offset:256
  ds_read_b64_tr_b16 v[88:89], v80 offset:8192
  ds_read_b64_tr_b16 v[90:91], v80 offset:8448
  s_waitcnt lgkmcnt(10)
  v_mfma_f32_32x32x16_bf16 v[48:63], v[96:99], v[224:227], v[48:63]
  ds_read_b64_tr_b16 v[112:113], v14 offset:16384
  ds_read_b64_tr_b16 v[114:115], v14 offset:16640
  v_mfma_f32_16x16x32_bf16 v[32:35], v[96:99], v[40:43], v[32:35]
  s_waitcnt lgkmcnt(10)
  v_mfma_f32_32x32x16_bf16 v[48:63], v[100:103], v[240:243], v[48:63]
  ds_read_b64_tr_b16 v[116:117], v14 offset:20480
  ds_read_b64_tr_b16 v[118:119], v14 offset:20736
  v_mfma_f32_16x16x32_bf16 v[32:35], v[100:103], v[40:43], v[32:35]
  s_waitcnt lgkmcnt(10)
  v_mfma_f32_32x32x16_bf16 v[48:63], v[104:107], v[228:231], v[48:63]
  ds_read_b64_tr_b16 v[120:121], v15 offset:16384
  ds_read_b64_tr_b16 v[122:123], v15 offset:16640
  s_lshl_b32 s58, s2, 3
  s_add_u32 s58, s58, s44
  s_lshl_b32 s58, s58, 10
  s_add_u32 s58, s58, 13631488
  s_waitcnt lgkmcnt(6)
  buffer_store_dwordx4 v[84:87], v1, s[16:19], s58 offen sc1
  s_add_u32 s58, s58, 2097152
  buffer_store_dwordx4 v[88:91], v82, s[16:19], s58 offen sc1
  v_mfma_f32_32x32x16_bf16 v[48:63], v[108:111], v[244:247], v[48:63]
  ds_read_b64_tr_b16 v[124:125], v15 offset:20480
  ds_read_b64_tr_b16 v[126:127], v15 offset:20736
  s_mov_b64 exec, s[96:97]
  ds_write_b32 v18, v32 offset:2560
  ds_write_b32 v18, v33 offset:2576
  ds_write_b32 v18, v34 offset:2592
  ds_write_b32 v18, v35 offset:2608
  s_mov_b64 exec, -1
  s_waitcnt lgkmcnt(0)
  s_waitcnt vmcnt(9)
  s_waitcnt vmcnt(6)
  s_barrier
  v_mfma_f32_32x32x16_bf16 v[48:63], v[112:115], v[232:235], v[48:63]
  ds_read_b64_tr_b16 v[96:97], v12 offset:32768
  ds_read_b64_tr_b16 v[98:99], v12 offset:33024
  v_and_b32 v28, 31, v0
  v_lshlrev_b32 v28, 4, v28
  v_add_u32 v28, 147456, v28
  ds_read_b128 v[24:27], v28 offset:2560
  v_mfma_f32_32x32x16_bf16 v[48:63], v[116:119], v[248:251], v[48:63]
  ds_read_b64_tr_b16 v[100:101], v12 offset:36864
  ds_read_b64_tr_b16 v[102:103], v12 offset:37120
  s_add_u32 m0, s63, 49152
  s_add_u32 s54, s98, 6
  s_and_b32 s54, s54, 7
  s_mul_i32 s54, s54, 229376
  s_add_u32 s54, s54, s64
  buffer_load_dwordx4 v7, s[12:15], s54 offen lds
  v_lshlrev_b32 v28, 16, v16
  v_cmp_gt_u32 vcc, 32, v0
  s_waitcnt lgkmcnt(2)
  v_add_f32 v24, v24, v25
  v_mfma_f32_32x32x16_bf16 v[48:63], v[120:123], v[236:239], v[48:63]
  ds_read_b64_tr_b16 v[104:105], v13 offset:32768
  ds_read_b64_tr_b16 v[106:107], v13 offset:33024
  v_add_f32 v26, v26, v27
  v_add_f32 v24, v24, v26
  v_cndmask_b32 v24, v28, v24, vcc
  ds_write_b32 v20, v24
  v_mfma_f32_32x32x16_bf16 v[48:63], v[124:127], v[252:255], v[48:63]
  ds_read_b64_tr_b16 v[108:109], v13 offset:36864
  ds_read_b64_tr_b16 v[110:111], v13 offset:37120
  s_mov_b32 s59, 0xbdd2d3e8
  v_mov_b32 v46, 0xc0135761
  ds_read_b128 v[80:83], v21 offset:0
  ds_read_b128 v[84:87], v21 offset:128
  v_mfma_f32_32x32x16_bf16 v[64:79], v[96:99], v[128:131], 0
  ds_read_b64_tr_b16 v[112:113], v14 offset:32768
  ds_read_b64_tr_b16 v[114:115], v14 offset:33024
  v_mfma_f32_16x16x32_bf16 v[36:39], v[96:99], v[40:43], 0
  s_waitcnt lgkmcnt(9)
  v_mfma_f32_32x32x16_bf16 v[64:79], v[100:103], v[144:147], v[64:79]
  ds_read_b64_tr_b16 v[116:117], v14 offset:36864
  ds_read_b64_tr_b16 v[118:119], v14 offset:37120
  s_add_u32 m0, s63, 50176
  s_add_u32 s54, s98, 6
  s_and_b32 s54, s54, 7
  s_mul_i32 s54, s54, 229376
  s_add_u32 s54, s54, 57344
  s_add_u32 s54, s54, s64
  buffer_load_dwordx4 v7, s[12:15], s54 offen lds
  s_waitcnt lgkmcnt(4)
  v_fma_f32 v84, -v5, v80, v84
  v_fma_f32 v85, -v5, v81, v85
  v_fma_f32 v86, -v5, v82, v86
  v_fma_f32 v87, -v5, v83, v87
  v_fma_f32 v48, v4, v48, v84
  v_mfma_f32_16x16x32_bf16 v[36:39], v[100:103], v[40:43], v[36:39]
  v_mfma_f32_32x32x16_bf16 v[64:79], v[104:107], v[132:135], v[64:79]
  ds_read_b64_tr_b16 v[120:121], v15 offset:32768
  ds_read_b64_tr_b16 v[122:123], v15 offset:33024
  v_fma_f32 v49, v4, v49, v85
  v_fma_f32 v50, v4, v50, v86
  v_fma_f32 v51, v4, v51, v87
  ds_read_b128 v[80:83], v21 offset:32
  ds_read_b128 v[84:87], v21 offset:160
  v_mul_f32 v88, v48, v48
  v_mfma_f32_32x32x16_bf16 v[64:79], v[108:111], v[148:151], v[64:79]
  ds_read_b64_tr_b16 v[124:125], v15 offset:36864
  ds_read_b64_tr_b16 v[126:127], v15 offset:37120
  v_mul_f32 v89, v49, v49
  v_mul_f32 v90, v50, v50
  v_mul_f32 v91, v51, v51
  v_fma_f32 v88, v88, s59, v46
  v_fma_f32 v89, v89, s59, v46
  s_waitcnt vmcnt(7)
  s_barrier
  s_waitcnt lgkmcnt(8)
  v_mfma_f32_32x32x16_bf16 v[64:79], v[112:115], v[136:139], v[64:79]
  ds_read_b64_tr_b16 v[96:97], v8 offset:32768
  ds_read_b64_tr_b16 v[98:99], v8 offset:33024
  v_fma_f32 v90, v90, s59, v46
  v_fma_f32 v91, v91, s59, v46
  v_mul_f32 v88, v88, v48
  v_mul_f32 v89, v89, v49
  v_mul_f32 v90, v90, v50
  v_mul_f32 v91, v91, v51
  s_waitcnt lgkmcnt(8)
  v_mfma_f32_32x32x16_bf16 v[64:79], v[116:119], v[152:155], v[64:79]
  ds_read_b64_tr_b16 v[100:101], v8 offset:36864
  ds_read_b64_tr_b16 v[102:103], v8 offset:37120
  v_exp_f32 v92, v88
  v_exp_f32 v93, v89
  v_exp_f32 v94, v90
  v_exp_f32 v95, v91
  v_add_f32 v92, 1.0, v92
  s_waitcnt lgkmcnt(8)
  v_mfma_f32_32x32x16_bf16 v[64:79], v[120:123], v[140:143], v[64:79]
  ds_read_b64_tr_b16 v[104:105], v9 offset:32768
  ds_read_b64_tr_b16 v[106:107], v9 offset:33024
  v_add_f32 v93, 1.0, v93
  v_add_f32 v94, 1.0, v94
  v_add_f32 v95, 1.0, v95
  v_rcp_f32 v92, v92
  v_rcp_f32 v93, v93
  v_rcp_f32 v94, v94
  s_waitcnt lgkmcnt(6)
  v_mfma_f32_32x32x16_bf16 v[64:79], v[124:127], v[156:159], v[64:79]
  ds_read_b64_tr_b16 v[108:109], v9 offset:36864
  ds_read_b64_tr_b16 v[110:111], v9 offset:37120
  v_rcp_f32 v95, v95
  v_mul_f32 v48, v48, v92
  v_mul_f32 v49, v49, v93
  v_mul_f32 v50, v50, v94
  v_mul_f32 v51, v51, v95
  v_cvt_pk_bf16_f32 v48, v48, v49
  s_waitcnt lgkmcnt(6)
  v_mfma_f32_32x32x16_bf16 v[64:79], v[96:99], v[160:163], v[64:79]
  ds_read_b64_tr_b16 v[112:113], v10 offset:32768
  ds_read_b64_tr_b16 v[114:115], v10 offset:33024
  v_cvt_pk_bf16_f32 v49, v50, v51
  v_fma_f32 v84, -v5, v80, v84
  v_fma_f32 v85, -v5, v81, v85
  v_fma_f32 v86, -v5, v82, v86
  v_mfma_f32_16x16x32_bf16 v[36:39], v[96:99], v[40:43], v[36:39]
  s_waitcnt lgkmcnt(6)
  v_mfma_f32_32x32x16_bf16 v[64:79], v[100:103], v[176:179], v[64:79]
  ds_read_b64_tr_b16 v[116:117], v10 offset:36864
  ds_read_b64_tr_b16 v[118:119], v10 offset:37120
  v_fma_f32 v87, -v5, v83, v87
  v_fma_f32 v52, v4, v52, v84
  v_fma_f32 v53, v4, v53, v85
  v_fma_f32 v54, v4, v54, v86
  v_fma_f32 v55, v4, v55, v87
  ds_read_b128 v[80:83], v21 offset:64
  v_mfma_f32_16x16x32_bf16 v[36:39], v[100:103], v[40:43], v[36:39]
  s_waitcnt lgkmcnt(7)
  v_mfma_f32_32x32x16_bf16 v[64:79], v[104:107], v[164:167], v[64:79]
  ds_read_b64_tr_b16 v[120:121], v11 offset:32768
  ds_read_b64_tr_b16 v[122:123], v11 offset:33024
  ds_read_b128 v[84:87], v21 offset:192
  v_mul_f32 v88, v52, v52
  v_mul_f32 v89, v53, v53
  v_mul_f32 v90, v54, v54
  v_mul_f32 v91, v55, v55
  s_waitcnt lgkmcnt(8)
  v_mfma_f32_32x32x16_bf16 v[64:79], v[108:111], v[180:183], v[64:79]
  ds_read_b64_tr_b16 v[124:125], v11 offset:36864
  ds_read_b64_tr_b16 v[126:127], v11 offset:37120
  v_fma_f32 v88, v88, s59, v46
  v_fma_f32 v89, v89, s59, v46
  v_fma_f32 v90, v90, s59, v46
  v_fma_f32 v91, v91, s59, v46
  v_mul_f32 v88, v88, v52
  v_mul_f32 v89, v89, v53
  s_waitcnt vmcnt(5)
  s_waitcnt vmcnt(2)
  s_barrier
  s_waitcnt lgkmcnt(8)
  v_mfma_f32_32x32x16_bf16 v[64:79], v[112:115], v[168:171], v[64:79]
  ds_read_b64_tr_b16 v[96:97], v8 offset:49152
  ds_read_b64_tr_b16 v[98:99], v8 offset:49408
  v_mul_f32 v90, v90, v54
  v_mul_f32 v91, v91, v55
  v_exp_f32 v92, v88
  v_exp_f32 v93, v89
  v_exp_f32 v94, v90
  v_exp_f32 v95, v91
  s_waitcnt lgkmcnt(8)
  v_mfma_f32_32x32x16_bf16 v[64:79], v[116:119], v[184:187], v[64:79]
  ds_read_b64_tr_b16 v[100:101], v8 offset:53248
  ds_read_b64_tr_b16 v[102:103], v8 offset:53504
  v_add_f32 v92, 1.0, v92
  v_add_f32 v93, 1.0, v93
  v_add_f32 v94, 1.0, v94
  v_add_f32 v95, 1.0, v95
  v_rcp_f32 v92, v92
  s_waitcnt lgkmcnt(7)
  v_mfma_f32_32x32x16_bf16 v[64:79], v[120:123], v[172:175], v[64:79]
  ds_read_b64_tr_b16 v[104:105], v9 offset:49152
  ds_read_b64_tr_b16 v[106:107], v9 offset:49408
  v_rcp_f32 v93, v93
  v_rcp_f32 v94, v94
  v_rcp_f32 v95, v95
  v_mul_f32 v52, v52, v92
  v_mul_f32 v53, v53, v93
  v_mul_f32 v54, v54, v94
  s_waitcnt lgkmcnt(6)
  v_mfma_f32_32x32x16_bf16 v[64:79], v[124:127], v[188:191], v[64:79]
  ds_read_b64_tr_b16 v[108:109], v9 offset:53248
  ds_read_b64_tr_b16 v[110:111], v9 offset:53504
  v_mul_f32 v55, v55, v95
  v_cvt_pk_bf16_f32 v50, v52, v53
  v_cvt_pk_bf16_f32 v51, v54, v55
  v_fma_f32 v84, -v5, v80, v84
  s_waitcnt lgkmcnt(6)
  v_mfma_f32_32x32x16_bf16 v[64:79], v[96:99], v[192:195], v[64:79]
  ds_read_b64_tr_b16 v[112:113], v10 offset:49152
  ds_read_b64_tr_b16 v[114:115], v10 offset:49408
  v_fma_f32 v85, -v5, v81, v85
  v_fma_f32 v86, -v5, v82, v86
  v_fma_f32 v87, -v5, v83, v87
  v_fma_f32 v56, v4, v56, v84
  v_fma_f32 v57, v4, v57, v85
  v_fma_f32 v58, v4, v58, v86
  v_mfma_f32_16x16x32_bf16 v[36:39], v[96:99], v[40:43], v[36:39]
  s_waitcnt lgkmcnt(6)
  v_mfma_f32_32x32x16_bf16 v[64:79], v[100:103], v[208:211], v[64:79]
  ds_read_b64_tr_b16 v[116:117], v10 offset:53248
  ds_read_b64_tr_b16 v[118:119], v10 offset:53504
  v_fma_f32 v59, v4, v59, v87
  ds_read_b128 v[80:83], v21 offset:96
  ds_read_b128 v[84:87], v21 offset:224
  v_mul_f32 v88, v56, v56
  v_mul_f32 v89, v57, v57
  v_mfma_f32_16x16x32_bf16 v[36:39], v[100:103], v[40:43], v[36:39]
  s_waitcnt lgkmcnt(8)
  v_mfma_f32_32x32x16_bf16 v[64:79], v[104:107], v[196:199], v[64:79]
  ds_read_b64_tr_b16 v[120:121], v11 offset:49152
  ds_read_b64_tr_b16 v[122:123], v11 offset:49408
  v_mul_f32 v90, v58, v58
  v_mul_f32 v91, v59, v59
  v_fma_f32 v88, v88, s59, v46
  v_fma_f32 v89, v89, s59, v46
  v_fma_f32 v90, v90, s59, v46
  v_fma_f32 v91, v91, s59, v46
  s_waitcnt lgkmcnt(8)
  v_mfma_f32_32x32x16_bf16 v[64:79], v[108:111], v[212:215], v[64:79]
  ds_read_b64_tr_b16 v[124:125], v11 offset:53248
  ds_read_b64_tr_b16 v[126:127], v11 offset:53504
  v_mul_f32 v88, v88, v56
  v_mul_f32 v89, v89, v57
  v_mul_f32 v90, v90, v58
  v_mul_f32 v91, v91, v59
  v_exp_f32 v92, v88
  v_exp_f32 v93, v89
  s_waitcnt vmcnt(0)
  s_barrier
  s_waitcnt lgkmcnt(8)
  v_mfma_f32_32x32x16_bf16 v[64:79], v[112:115], v[200:203], v[64:79]
  ds_read_b64_tr_b16 v[96:97], v12 offset:49152
  ds_read_b64_tr_b16 v[98:99], v12 offset:49408
  v_and_b32 v22, 15, v0
  v_lshlrev_b32 v22, 2, v22
  s_lshr_b32 s53, s20, 1
  s_lshl_b32 s53, s53, 8
  s_add_u32 s53, s53, 18874368
  buffer_load_dword v23, v22, s[16:19], s53 offen sc1
  v_exp_f32 v94, v90
  v_exp_f32 v95, v91
  v_add_f32 v92, 1.0, v92
  v_add_f32 v93, 1.0, v93
  v_add_f32 v94, 1.0, v94
  s_waitcnt lgkmcnt(8)
  v_mfma_f32_32x32x16_bf16 v[64:79], v[116:119], v[216:219], v[64:79]
  ds_read_b64_tr_b16 v[100:101], v12 offset:53248
  ds_read_b64_tr_b16 v[102:103], v12 offset:53504
  v_add_f32 v95, 1.0, v95
  v_rcp_f32 v92, v92
  v_rcp_f32 v93, v93
  v_rcp_f32 v94, v94
  v_rcp_f32 v95, v95
  v_mul_f32 v56, v56, v92
  s_waitcnt lgkmcnt(6)
  v_mfma_f32_32x32x16_bf16 v[64:79], v[120:123], v[204:207], v[64:79]
  ds_read_b64_tr_b16 v[104:105], v13 offset:49152
  ds_read_b64_tr_b16 v[106:107], v13 offset:49408
  v_mul_f32 v57, v57, v93
  v_mul_f32 v58, v58, v94
  v_mul_f32 v59, v59, v95
  v_cvt_pk_bf16_f32 v52, v56, v57
  v_cvt_pk_bf16_f32 v53, v58, v59
  s_waitcnt lgkmcnt(6)
  v_mfma_f32_32x32x16_bf16 v[64:79], v[124:127], v[220:223], v[64:79]
  ds_read_b64_tr_b16 v[108:109], v13 offset:53248
  ds_read_b64_tr_b16 v[110:111], v13 offset:53504
  v_fma_f32 v84, -v5, v80, v84
  v_fma_f32 v85, -v5, v81, v85
  v_fma_f32 v86, -v5, v82, v86
  v_fma_f32 v87, -v5, v83, v87
  v_fma_f32 v60, v4, v60, v84
  s_waitcnt lgkmcnt(6)
  v_mfma_f32_32x32x16_bf16 v[64:79], v[96:99], v[224:227], v[64:79]
  ds_read_b64_tr_b16 v[112:113], v14 offset:49152
  ds_read_b64_tr_b16 v[114:115], v14 offset:49408
  v_fma_f32 v61, v4, v61, v85
  v_fma_f32 v62, v4, v62, v86
  v_fma_f32 v63, v4, v63, v87
  v_mul_f32 v88, v60, v60
  v_mul_f32 v89, v61, v61
  v_mul_f32 v90, v62, v62
  v_mfma_f32_16x16x32_bf16 v[36:39], v[96:99], v[40:43], v[36:39]
  s_waitcnt lgkmcnt(6)
  v_mfma_f32_32x32x16_bf16 v[64:79], v[100:103], v[240:243], v[64:79]
  ds_read_b64_tr_b16 v[116:117], v14 offset:53248
  ds_read_b64_tr_b16 v[118:119], v14 offset:53504
  v_mul_f32 v91, v63, v63
  v_fma_f32 v88, v88, s59, v46
  v_fma_f32 v89, v89, s59, v46
  v_fma_f32 v90, v90, s59, v46
  v_fma_f32 v91, v91, s59, v46
  v_mfma_f32_16x16x32_bf16 v[36:39], v[100:103], v[40:43], v[36:39]
  s_waitcnt lgkmcnt(6)
  v_mfma_f32_32x32x16_bf16 v[64:79], v[104:107], v[228:231], v[64:79]
  ds_read_b64_tr_b16 v[120:121], v15 offset:49152
  ds_read_b64_tr_b16 v[122:123], v15 offset:49408
  v_mul_f32 v88, v88, v60
  v_mul_f32 v89, v89, v61
  v_mul_f32 v90, v90, v62
  v_mul_f32 v91, v91, v63
  v_exp_f32 v92, v88
  v_exp_f32 v93, v89
  s_waitcnt lgkmcnt(6)
  v_mfma_f32_32x32x16_bf16 v[64:79], v[108:111], v[244:247], v[64:79]
  ds_read_b64_tr_b16 v[124:125], v15 offset:53248
  ds_read_b64_tr_b16 v[126:127], v15 offset:53504
  v_exp_f32 v94, v90
  v_exp_f32 v95, v91
  v_add_f32 v92, 1.0, v92
  v_add_f32 v93, 1.0, v93
  v_add_f32 v94, 1.0, v94
  s_waitcnt lgkmcnt(6)
  v_mfma_f32_32x32x16_bf16 v[64:79], v[112:115], v[232:235], v[64:79]
  v_add_f32 v95, 1.0, v95
  v_rcp_f32 v92, v92
  v_rcp_f32 v93, v93
  v_rcp_f32 v94, v94
  v_rcp_f32 v95, v95
  v_mul_f32 v60, v60, v92
  s_waitcnt lgkmcnt(4)
  v_mfma_f32_32x32x16_bf16 v[64:79], v[116:119], v[248:251], v[64:79]
  v_mul_f32 v61, v61, v93
  v_mul_f32 v62, v62, v94
  v_mul_f32 v63, v63, v95
  v_cvt_pk_bf16_f32 v54, v60, v61
  v_cvt_pk_bf16_f32 v55, v62, v63
  s_waitcnt lgkmcnt(2)
  v_mfma_f32_32x32x16_bf16 v[64:79], v[120:123], v[236:239], v[64:79]
  s_waitcnt lgkmcnt(0)
  v_mfma_f32_32x32x16_bf16 v[64:79], v[124:127], v[252:255], v[64:79]
  s_mov_b64 exec, s[96:97]
  ds_write_b32 v18, v36 offset:3072
  ds_write_b32 v18, v37 offset:3088
  ds_write_b32 v18, v38 offset:3104
  ds_write_b32 v18, v39 offset:3120
  s_mov_b64 exec, -1
  s_waitcnt lgkmcnt(0)
  s_waitcnt vmcnt(0)
  s_barrier
  v_cmp_ne_u32 vcc, 1, v23
s_nop 3
s_cbranch_vccz ok_17
  s_mov_b32 s11, 20000
spin_18:
  s_sleep 1
  s_lshr_b32 s53, s20, 1
  s_lshl_b32 s53, s53, 8
  s_add_u32 s53, s53, 18874368
  buffer_load_dword v23, v22, s[16:19], s53 offen sc1
  s_waitcnt vmcnt(0)
  v_cmp_ne_u32 vcc, 1, v23
s_nop 3
s_cbranch_vccz ok_17
  s_sub_u32 s11, s11, 1
  s_cmp_lg_u32 s11, 0
s_cbranch_scc1 spin_18
  v_mov_b32 v6, 2
  buffer_store_dword v6, off, s[40:43], 0 offset:8
s_nop 0
ok_17:
  s_cmp_eq_u32 s64, 0
s_cbranch_scc1 skipb_19
  v_and_b32 v28, 31, v0
  v_lshlrev_b32 v28, 4, v28
  v_add_u32 v28, 147456, v28
  ds_read_b128 v[24:27], v28 offset:3072
  s_lshl_b32 s54, s20, 6
  s_add_u32 s54, s54, s21
  s_lshl_b32 s54, s54, 10
  buffer_load_dwordx4 v[12:15], v1, s[16:19], s54 offen sc1
  v_lshlrev_b32 v28, 16, v17
  v_cmp_gt_u32 vcc, 32, v0
  s_add_u32 m0, s23, 0
  s_add_u32 s54, s22, 0
  buffer_load_dwordx4 v1, s[16:19], s54 offen sc1 lds
  s_waitcnt lgkmcnt(0)
  v_add_f32 v24, v24, v25
  v_add_f32 v26, v26, v27
  v_add_f32 v24, v24, v26
  v_cndmask_b32 v24, v28, v24, vcc
  ds_write_b32 v20, v24
  ds_read_b128 v[80:83], v21 offset:0
  ds_read_b128 v[84:87], v21 offset:128
  s_add_u32 m0, s23, 8192
  s_add_u32 s54, s22, 8192
  buffer_load_dwordx4 v1, s[16:19], s54 offen sc1 lds
  s_add_u32 m0, s23, 16384
  s_add_u32 s54, s22, 16384
  buffer_load_dwordx4 v1, s[16:19], s54 offen sc1 lds
  s_waitcnt lgkmcnt(0)
  v_fma_f32 v84, -v5, v80, v84
  v_fma_f32 v85, -v5, v81, v85
  v_fma_f32 v86, -v5, v82, v86
  v_fma_f32 v87, -v5, v83, v87
  v_fma_f32 v64, v4, v64, v84
  v_fma_f32 v65, v4, v65, v85
  v_fma_f32 v66, v4, v66, v86
  v_fma_f32 v67, v4, v67, v87
  ds_read_b128 v[80:83], v21 offset:32
  ds_read_b128 v[84:87], v21 offset:160
  v_mul_f32 v88, v64, v64
  v_mul_f32 v89, v65, v65
  v_mul_f32 v90, v66, v66
  v_mul_f32 v91, v67, v67
  v_fma_f32 v88, v88, s59, v46
  v_fma_f32 v89, v89, s59, v46
  s_add_u32 m0, s23, 24576
  s_add_u32 s54, s22, 24576
  buffer_load_dwordx4 v1, s[16:19], s54 offen sc1 lds
  v_fma_f32 v90, v90, s59, v46
  v_fma_f32 v91, v91, s59, v46
  v_mul_f32 v88, v88, v64
  v_mul_f32 v89, v89, v65
  v_mul_f32 v90, v90, v66
  v_mul_f32 v91, v91, v67
  v_exp_f32 v92, v88
  v_exp_f32 v93, v89
  v_exp_f32 v94, v90
  v_exp_f32 v95, v91
  v_add_f32 v92, 1.0, v92
  v_add_f32 v93, 1.0, v93
  v_add_f32 v94, 1.0, v94
  v_add_f32 v95, 1.0, v95
  v_rcp_f32 v92, v92
  v_rcp_f32 v93, v93
  s_add_u32 m0, s23, 32768
  s_add_u32 s54, s22, 32768
  buffer_load_dwordx4 v1, s[16:19], s54 offen sc1 lds
  v_rcp_f32 v94, v94
  v_rcp_f32 v95, v95
  v_mul_f32 v64, v64, v92
  v_mul_f32 v65, v65, v93
  v_mul_f32 v66, v66, v94
  v_mul_f32 v67, v67, v95
  v_cvt_pk_bf16_f32 v64, v64, v65
  v_cvt_pk_bf16_f32 v65, v66, v67
  s_waitcnt lgkmcnt(0)
  v_fma_f32 v84, -v5, v80, v84
  v_fma_f32 v85, -v5, v81, v85
  v_fma_f32 v86, -v5, v82, v86
  v_fma_f32 v87, -v5, v83, v87
  v_fma_f32 v68, v4, v68, v84
  v_fma_f32 v69, v4, v69, v85
  v_fma_f32 v70, v4, v70, v86
  s_add_u32 m0, s23, 40960
  s_add_u32 s54, s22, 40960
  buffer_load_dwordx4 v1, s[16:19], s54 offen sc1 lds
  v_fma_f32 v71, v4, v71, v87
  ds_read_b128 v[80:83], v21 offset:64
  ds_read_b128 v[84:87], v21 offset:192
  v_mul_f32 v88, v68, v68
  v_mul_f32 v89, v69, v69
  v_mul_f32 v90, v70, v70
  v_mul_f32 v91, v71, v71
  v_fma_f32 v88, v88, s59, v46
  v_fma_f32 v89, v89, s59, v46
  v_fma_f32 v90, v90, s59, v46
  v_fma_f32 v91, v91, s59, v46
  v_mul_f32 v88, v88, v68
  v_mul_f32 v89, v89, v69
  v_mul_f32 v90, v90, v70
  v_mul_f32 v91, v91, v71
  v_exp_f32 v92, v88
  s_add_u32 m0, s23, 49152
  s_add_u32 s54, s22, 49152
  buffer_load_dwordx4 v1, s[16:19], s54 offen sc1 lds
  v_exp_f32 v93, v89
  v_exp_f32 v94, v90
  v_exp_f32 v95, v91
  v_add_f32 v92, 1.0, v92
  v_add_f32 v93, 1.0, v93
  v_add_f32 v94, 1.0, v94
  v_add_f32 v95, 1.0, v95
  v_rcp_f32 v92, v92
  v_rcp_f32 v93, v93
  v_rcp_f32 v94, v94
  v_rcp_f32 v95, v95
  v_mul_f32 v68, v68, v92
  v_mul_f32 v69, v69, v93
  v_mul_f32 v70, v70, v94
  v_mul_f32 v71, v71, v95
  v_cvt_pk_bf16_f32 v66, v68, v69
  s_add_u32 m0, s23, 57344
  s_add_u32 s54, s22, 57344
  buffer_load_dwordx4 v1, s[16:19], s54 offen sc1 lds
  v_cvt_pk_bf16_f32 v67, v70, v71
  s_waitcnt lgkmcnt(0)
  v_fma_f32 v84, -v5, v80, v84
  v_fma_f32 v85, -v5, v81, v85
  v_fma_f32 v86, -v5, v82, v86
  v_fma_f32 v87, -v5, v83, v87
  v_fma_f32 v72, v4, v72, v84
  v_fma_f32 v73, v4, v73, v85
  v_fma_f32 v74, v4, v74, v86
  v_fma_f32 v75, v4, v75, v87
  ds_read_b128 v[80:83], v21 offset:96
  ds_read_b128 v[84:87], v21 offset:224
  v_mul_f32 v88, v72, v72
  v_mul_f32 v89, v73, v73
  v_mul_f32 v90, v74, v74
  v_mul_f32 v91, v75, v75
  v_fma_f32 v88, v88, s59, v46
  v_fma_f32 v89, v89, s59, v46
  v_fma_f32 v90, v90, s59, v46
  v_fma_f32 v91, v91, s59, v46
  v_mul_f32 v88, v88, v72
  v_mul_f32 v89, v89, v73
  v_mul_f32 v90, v90, v74
  v_mul_f32 v91, v91, v75
  v_exp_f32 v92, v88
  v_exp_f32 v93, v89
  v_exp_f32 v94, v90
  v_exp_f32 v95, v91
  v_add_f32 v92, 1.0, v92
  v_add_f32 v93, 1.0, v93
  v_add_f32 v94, 1.0, v94
  v_add_f32 v95, 1.0, v95
  v_rcp_f32 v92, v92
  v_rcp_f32 v93, v93
  v_rcp_f32 v94, v94
  v_rcp_f32 v95, v95
  v_mul_f32 v72, v72, v92
  v_mul_f32 v73, v73, v93
  v_mul_f32 v74, v74, v94
  v_mul_f32 v75, v75, v95
  v_cvt_pk_bf16_f32 v68, v72, v73
  v_cvt_pk_bf16_f32 v69, v74, v75
  s_waitcnt lgkmcnt(0)
  v_fma_f32 v84, -v5, v80, v84
  v_fma_f32 v85, -v5, v81, v85
  v_fma_f32 v86, -v5, v82, v86
  v_fma_f32 v87, -v5, v83, v87
  v_fma_f32 v76, v4, v76, v84
  v_fma_f32 v77, v4, v77, v85
  v_fma_f32 v78, v4, v78, v86
  v_fma_f32 v79, v4, v79, v87
  v_mul_f32 v88, v76, v76
  v_mul_f32 v89, v77, v77
  v_mul_f32 v90, v78, v78
  v_mul_f32 v91, v79, v79
  v_fma_f32 v88, v88, s59, v46
  v_fma_f32 v89, v89, s59, v46
  v_fma_f32 v90, v90, s59, v46
  v_fma_f32 v91, v91, s59, v46
  v_mul_f32 v88, v88, v76
  v_mul_f32 v89, v89, v77
  v_mul_f32 v90, v90, v78
  v_mul_f32 v91, v91, v79
  v_exp_f32 v92, v88
  v_exp_f32 v93, v89
  v_exp_f32 v94, v90
  v_exp_f32 v95, v91
  v_add_f32 v92, 1.0, v92
  v_add_f32 v93, 1.0, v93
  v_add_f32 v94, 1.0, v94
  v_add_f32 v95, 1.0, v95
  v_rcp_f32 v92, v92
  v_rcp_f32 v93, v93
  v_rcp_f32 v94, v94
  v_rcp_f32 v95, v95
  v_mul_f32 v76, v76, v92
  v_mul_f32 v77, v77, v93
  v_mul_f32 v78, v78, v94
  v_mul_f32 v79, v79, v95
  v_cvt_pk_bf16_f32 v70, v76, v77
  v_cvt_pk_bf16_f32 v71, v78, v79
  s_mul_i32 s56, s65, 112
  s_lshl_b32 s52, s46, 1
  s_add_u32 s52, s52, s51
  s_add_u32 s52, s52, 0
  s_lshl_b32 s52, s52, 1
  s_add_u32 s56, s56, s52
  s_lshl_b32 s56, s56, 10
  s_add_u32 s56, s56, 6291456
  buffer_store_dwordx4 v[48:51], v1, s[16:19], s56 offen sc1
  buffer_store_dwordx4 v[52:55], v1, s[16:19], s56 offen offset:1024 sc1
  s_mul_i32 s56, s65, 112
  s_lshl_b32 s52, s46, 1
  s_add_u32 s52, s52, s51
  s_add_u32 s52, s52, 1
  s_lshl_b32 s52, s52, 1
  s_add_u32 s56, s56, s52
  s_lshl_b32 s56, s56, 10
  s_add_u32 s56, s56, 6291456
  buffer_store_dwordx4 v[64:67], v1, s[16:19], s56 offen sc1
  buffer_store_dwordx4 v[68:71], v1, s[16:19], s56 offen offset:1024 sc1
s_nop 0
s_branch joinb_20
skipb_19:
  s_lshl_b32 s54, s20, 6
  s_add_u32 s54, s54, s21
  s_lshl_b32 s54, s54, 10
  buffer_load_dwordx4 v[12:15], v1, s[16:19], s54 offen sc1
  s_add_u32 m0, s23, 0
  s_add_u32 s54, s22, 0
  buffer_load_dwordx4 v1, s[16:19], s54 offen sc1 lds
  s_add_u32 m0, s23, 8192
  s_add_u32 s54, s22, 8192
  buffer_load_dwordx4 v1, s[16:19], s54 offen sc1 lds
  s_add_u32 m0, s23, 16384
  s_add_u32 s54, s22, 16384
  buffer_load_dwordx4 v1, s[16:19], s54 offen sc1 lds
  s_add_u32 m0, s23, 24576
  s_add_u32 s54, s22, 24576
  buffer_load_dwordx4 v1, s[16:19], s54 offen sc1 lds
  s_add_u32 m0, s23, 32768
  s_add_u32 s54, s22, 32768
  buffer_load_dwordx4 v1, s[16:19], s54 offen sc1 lds
  s_add_u32 m0, s23, 40960
  s_add_u32 s54, s22, 40960
  buffer_load_dwordx4 v1, s[16:19], s54 offen sc1 lds
  s_add_u32 m0, s23, 49152
  s_add_u32 s54, s22, 49152
  buffer_load_dwordx4 v1, s[16:19], s54 offen sc1 lds
  s_add_u32 m0, s23, 57344
  s_add_u32 s54, s22, 57344
  buffer_load_dwordx4 v1, s[16:19], s54 offen sc1 lds
  s_mul_i32 s56, s65, 112
  s_lshl_b32 s52, s46, 1
  s_add_u32 s52, s52, s51
  s_add_u32 s52, s52, 0
  s_lshl_b32 s52, s52, 1
  s_add_u32 s56, s56, s52
  s_lshl_b32 s56, s56, 10
  s_add_u32 s56, s56, 6291456
  buffer_store_dwordx4 v[48:51], v1, s[16:19], s56 offen sc1
  buffer_store_dwordx4 v[52:55], v1, s[16:19], s56 offen offset:1024 sc1
  buffer_load_dword v10, v1, s[16:19], s22 offen
  buffer_load_dword v11, v1, s[16:19], s22 offen
joinb_20:
  s_waitcnt lgkmcnt(0)
  v_mov_b32 v2, v1
  v_add_u32 v3, 0x10000, v1
  v_and_b32 v6, 15, v0
  v_lshrrev_b32 v7, 5, v0
  v_lshlrev_b32 v7, 4, v7
  v_add_u32 v6, v6, v7
  v_lshlrev_b32 v6, 4, v6
  v_add_u32 v4, 0x400, v6
  v_add_u32 v5, 0x10400, v6
  s_mov_b32 s94, 0xffff
  s_mov_b32 s95, 0xffff
  v_and_b32 v6, 27, v0
  v_cmp_eq_u32 vcc, 16, v6
  v_mov_b32 v6, 0x3f803f80
s_nop 0
  v_cndmask_b32 v20, 0, v6, vcc
  v_cndmask_b32 v24, 0, v6, vcc
  v_cndmask_b32 v21, 0, v6, vcc
  v_cndmask_b32 v25, 0, v6, vcc
  v_cndmask_b32 v22, 0, v6, vcc
  v_cndmask_b32 v26, 0, v6, vcc
  v_cndmask_b32 v23, 0, v6, vcc
  v_cndmask_b32 v27, 0, v6, vcc
  s_waitcnt vmcnt(4)
  s_barrier
  ds_read_b128 v[16:19], v2 offset:0
  s_mov_b64 exec, s[94:95]
  ds_read_b128 v[20:23], v4 offset:0
  s_mov_b64 exec, -1
  s_waitcnt lgkmcnt(1)
  v_mfma_f32_32x32x16_bf16 v[52:67], v[16:19], v[12:15], 0
s_nop 11
  v_max3_f32 v6, v52, v53, v54
  v_max3_f32 v7, v55, v56, v57
  v_max3_f32 v6, v6, v58, v59
  v_max3_f32 v7, v7, v60, v61
  v_max3_f32 v6, v6, v62, v63
  v_max3_f32 v7, v7, v64, v65
  v_max3_f32 v6, v6, v66, v67
  v_max_f32 v6, v6, v7
  v_mov_b32 v7, v6
s_nop 1
  v_permlane32_swap_b32 v6, v7
  v_max_f32 v6, v6, v7
  v_sub_f32 v36, 0, v6
  v_sub_f32 v37, 0, v6
  v_sub_f32 v38, 0, v6
  v_sub_f32 v39, 0, v6
  v_sub_f32 v40, 0, v6
  v_sub_f32 v41, 0, v6
  v_sub_f32 v42, 0, v6
  v_sub_f32 v43, 0, v6
  v_sub_f32 v44, 0, v6
  v_sub_f32 v45, 0, v6
  v_sub_f32 v46, 0, v6
  v_sub_f32 v47, 0, v6
  v_sub_f32 v48, 0, v6
  v_sub_f32 v49, 0, v6
  v_sub_f32 v50, 0, v6
  v_sub_f32 v51, 0, v6
s_nop 1
  v_mfma_f32_32x32x16_bf16 v[52:67], v[16:19], v[12:15], v[36:51]
  ds_read_b128 v[16:19], v2 offset:2048
  s_setprio 1
  s_waitcnt lgkmcnt(0)
  v_mfma_f32_32x32x16_bf16 v[68:83], v[16:19], v[12:15], v[36:51]
  ds_read_b128 v[16:19], v2 offset:4096
  s_add_u32 m0, s23, 65536
  s_add_u32 s54, s22, 65536
  buffer_load_dwordx4 v1, s[16:19], s54 offen sc1 lds
s_nop 3
  v_exp_f32 v52, v52
  v_exp_f32 v53, v53
  v_exp_f32 v54, v54
  v_exp_f32 v55, v55
  v_cvt_pk_bf16_f32 v28, v52, v53
  v_exp_f32 v56, v56
  v_exp_f32 v57, v57
  v_cvt_pk_bf16_f32 v29, v54, v55
  v_exp_f32 v58, v58
  v_exp_f32 v59, v59
  v_cvt_pk_bf16_f32 v30, v56, v57
  v_exp_f32 v60, v60
  v_exp_f32 v61, v61
  v_cvt_pk_bf16_f32 v31, v58, v59
  v_exp_f32 v62, v62
  v_exp_f32 v63, v63
  v_mfma_f32_32x32x16_bf16 v[84:99], v[20:23], v[28:31], 0
  s_mov_b64 exec, s[94:95]
  ds_read_b128 v[24:27], v4 offset:512
  ds_read_b128 v[20:23], v4 offset:2048
  s_mov_b64 exec, -1
  v_cvt_pk_bf16_f32 v32, v60, v61
  v_exp_f32 v64, v64
  v_exp_f32 v65, v65
  v_cvt_pk_bf16_f32 v33, v62, v63
  v_exp_f32 v66, v66
  v_exp_f32 v67, v67
  v_cvt_pk_bf16_f32 v34, v64, v65
  v_cvt_pk_bf16_f32 v35, v66, v67
  s_waitcnt lgkmcnt(2)
  v_mfma_f32_32x32x16_bf16 v[52:67], v[16:19], v[12:15], v[36:51]
  ds_read_b128 v[16:19], v2 offset:6144
  s_add_u32 m0, s23, 73728
  s_add_u32 s54, s22, 73728
  buffer_load_dwordx4 v1, s[16:19], s54 offen sc1 lds
  v_exp_f32 v68, v68
  v_exp_f32 v69, v69
  v_exp_f32 v70, v70
  v_exp_f32 v71, v71
  v_cvt_pk_bf16_f32 v28, v68, v69
  v_exp_f32 v72, v72
  v_exp_f32 v73, v73
  v_cvt_pk_bf16_f32 v29, v70, v71
  s_waitcnt lgkmcnt(2)
  v_mfma_f32_32x32x16_bf16 v[84:99], v[24:27], v[32:35], v[84:99]
  v_exp_f32 v74, v74
  v_exp_f32 v75, v75
  v_cvt_pk_bf16_f32 v30, v72, v73
  v_exp_f32 v76, v76
  v_exp_f32 v77, v77
  v_cvt_pk_bf16_f32 v31, v74, v75
  v_exp_f32 v78, v78
  v_exp_f32 v79, v79
  s_waitcnt lgkmcnt(1)
  v_mfma_f32_32x32x16_bf16 v[84:99], v[20:23], v[28:31], v[84:99]
  s_mov_b64 exec, s[94:95]
  ds_read_b128 v[24:27], v4 offset:2560
  ds_read_b128 v[20:23], v4 offset:4096
  s_mov_b64 exec, -1
  v_cvt_pk_bf16_f32 v32, v76, v77
  v_exp_f32 v80, v80
  v_exp_f32 v81, v81
  v_cvt_pk_bf16_f32 v33, v78, v79
  v_exp_f32 v82, v82
  v_exp_f32 v83, v83
  v_cvt_pk_bf16_f32 v34, v80, v81
  v_cvt_pk_bf16_f32 v35, v82, v83
  s_waitcnt vmcnt(2)
  v_mov_b32 v6, 163824
  v_mov_b32 v7, 1
  s_mov_b64 exec, 1
  ds_add_rtn_u32 v7, v6, v7
  s_mov_b64 exec, -1
  s_waitcnt lgkmcnt(3)
  v_mfma_f32_32x32x16_bf16 v[68:83], v[16:19], v[12:15], v[36:51]
  ds_read_b128 v[16:19], v2 offset:8192
  s_add_u32 m0, s23, 81920
  s_add_u32 s54, s22, 81920
  buffer_load_dwordx4 v1, s[16:19], s54 offen sc1 lds
  v_exp_f32 v52, v52
  v_exp_f32 v53, v53
  v_exp_f32 v54, v54
  v_exp_f32 v55, v55
  v_cvt_pk_bf16_f32 v28, v52, v53
  v_exp_f32 v56, v56
  v_exp_f32 v57, v57
  v_cvt_pk_bf16_f32 v29, v54, v55
  s_waitcnt lgkmcnt(3)
  v_mfma_f32_32x32x16_bf16 v[84:99], v[24:27], v[32:35], v[84:99]
  v_exp_f32 v58, v58
  v_exp_f32 v59, v59
  v_cvt_pk_bf16_f32 v30, v56, v57
  v_exp_f32 v60, v60
  v_exp_f32 v61, v61
  v_cvt_pk_bf16_f32 v31, v58, v59
  v_exp_f32 v62, v62
  v_exp_f32 v63, v63
  s_waitcnt lgkmcnt(2)
  v_mfma_f32_32x32x16_bf16 v[84:99], v[20:23], v[28:31], v[84:99]
  s_mov_b64 exec, s[94:95]
  ds_read_b128 v[24:27], v4 offset:4608
  ds_read_b128 v[20:23], v4 offset:6144
  s_mov_b64 exec, -1
  v_cvt_pk_bf16_f32 v32, v60, v61
  v_exp_f32 v64, v64
  v_exp_f32 v65, v65
  v_cvt_pk_bf16_f32 v33, v62, v63
  v_exp_f32 v66, v66
  v_exp_f32 v67, v67
  v_cvt_pk_bf16_f32 v34, v64, v65
  v_cvt_pk_bf16_f32 v35, v66, v67
  s_waitcnt lgkmcnt(3)
  v_readfirstlane_b32 s52, v7
s_nop 3
  s_cmp_lg_u32 s52, 7
s_cbranch_scc1 nofb_21
  s_lshl_b32 s52, s49, 8
  s_lshl_b32 s53, s50, 2
  s_add_u32 s52, s52, s53
  s_add_u32 s52, s52, 18882560
  s_mov_b64 exec, 1
  v_mov_b32 v7, 1
  buffer_store_dword v7, off, s[16:19], s52 sc1
  s_mov_b64 exec, -1
nofb_21:
  s_waitcnt lgkmcnt(2)
  v_mfma_f32_32x32x16_bf16 v[52:67], v[16:19], v[12:15], v[36:51]
  ds_read_b128 v[16:19], v2 offset:10240
  s_add_u32 m0, s23, 90112
  s_add_u32 s54, s22, 90112
  buffer_load_dwordx4 v1, s[16:19], s54 offen sc1 lds
  v_exp_f32 v68, v68
  v_exp_f32 v69, v69
  v_exp_f32 v70, v70
  v_exp_f32 v71, v71
  v_cvt_pk_bf16_f32 v28, v68, v69
  v_exp_f32 v72, v72
  v_exp_f32 v73, v73
  v_cvt_pk_bf16_f32 v29, v70, v71
  s_waitcnt lgkmcnt(2)
  v_mfma_f32_32x32x16_bf16 v[84:99], v[24:27], v[32:35], v[84:99]
  v_exp_f32 v74, v74
  v_exp_f32 v75, v75
  v_cvt_pk_bf16_f32 v30, v72, v73
  v_exp_f32 v76, v76
  v_exp_f32 v77, v77
  v_cvt_pk_bf16_f32 v31, v74, v75
  v_exp_f32 v78, v78
  v_exp_f32 v79, v79
  s_waitcnt lgkmcnt(1)
  v_mfma_f32_32x32x16_bf16 v[84:99], v[20:23], v[28:31], v[84:99]
  s_mov_b64 exec, s[94:95]
  ds_read_b128 v[24:27], v4 offset:6656
  ds_read_b128 v[20:23], v4 offset:8192
  s_mov_b64 exec, -1
  v_cvt_pk_bf16_f32 v32, v76, v77
  v_exp_f32 v80, v80
  v_exp_f32 v81, v81
  v_cvt_pk_bf16_f32 v33, v78, v79
  v_exp_f32 v82, v82
  v_exp_f32 v83, v83
  v_cvt_pk_bf16_f32 v34, v80, v81
  v_cvt_pk_bf16_f32 v35, v82, v83
  s_waitcnt lgkmcnt(2)
  v_mfma_f32_32x32x16_bf16 v[68:83], v[16:19], v[12:15], v[36:51]
  ds_read_b128 v[16:19], v2 offset:12288
  s_add_u32 m0, s23, 98304
  s_add_u32 s54, s22, 98304
  buffer_load_dwordx4 v1, s[16:19], s54 offen sc1 lds
  v_exp_f32 v52, v52
  v_exp_f32 v53, v53
  v_exp_f32 v54, v54
  v_exp_f32 v55, v55
  v_cvt_pk_bf16_f32 v28, v52, v53
  v_exp_f32 v56, v56
  v_exp_f32 v57, v57
  v_cvt_pk_bf16_f32 v29, v54, v55
  s_waitcnt lgkmcnt(2)
  v_mfma_f32_32x32x16_bf16 v[84:99], v[24:27], v[32:35], v[84:99]
  v_exp_f32 v58, v58
  v_exp_f32 v59, v59
  v_cvt_pk_bf16_f32 v30, v56, v57
  v_exp_f32 v60, v60
  v_exp_f32 v61, v61
  v_cvt_pk_bf16_f32 v31, v58, v59
  v_exp_f32 v62, v62
  v_exp_f32 v63, v63
  s_waitcnt lgkmcnt(1)
  v_mfma_f32_32x32x16_bf16 v[84:99], v[20:23], v[28:31], v[84:99]
  s_mov_b64 exec, s[94:95]
  ds_read_b128 v[24:27], v4 offset:8704
  ds_read_b128 v[20:23], v4 offset:10240
  s_mov_b64 exec, -1
  v_cvt_pk_bf16_f32 v32, v60, v61
  v_exp_f32 v64, v64
  v_exp_f32 v65, v65
  v_cvt_pk_bf16_f32 v33, v62, v63
  v_exp_f32 v66, v66
  v_exp_f32 v67, v67
  v_cvt_pk_bf16_f32 v34, v64, v65
  v_cvt_pk_bf16_f32 v35, v66, v67
  s_waitcnt lgkmcnt(2)
  v_mfma_f32_32x32x16_bf16 v[52:67], v[16:19], v[12:15], v[36:51]
  ds_read_b128 v[16:19], v2 offset:14336
  s_add_u32 m0, s23, 106496
  s_add_u32 s54, s22, 106496
  buffer_load_dwordx4 v1, s[16:19], s54 offen sc1 lds
  v_exp_f32 v68, v68
  v_exp_f32 v69, v69
  v_exp_f32 v70, v70
  v_exp_f32 v71, v71
  v_cvt_pk_bf16_f32 v28, v68, v69
  v_exp_f32 v72, v72
  v_exp_f32 v73, v73
  v_cvt_pk_bf16_f32 v29, v70, v71
  s_waitcnt lgkmcnt(2)
  v_mfma_f32_32x32x16_bf16 v[84:99], v[24:27], v[32:35], v[84:99]
  v_exp_f32 v74, v74
  v_exp_f32 v75, v75
  v_cvt_pk_bf16_f32 v30, v72, v73
  v_exp_f32 v76, v76
  v_exp_f32 v77, v77
  v_cvt_pk_bf16_f32 v31, v74, v75
  v_exp_f32 v78, v78
  v_exp_f32 v79, v79
  s_waitcnt lgkmcnt(1)
  v_mfma_f32_32x32x16_bf16 v[84:99], v[20:23], v[28:31], v[84:99]
  s_mov_b64 exec, s[94:95]
  ds_read_b128 v[24:27], v4 offset:10752
  ds_read_b128 v[20:23], v4 offset:12288
  s_mov_b64 exec, -1
  v_cvt_pk_bf16_f32 v32, v76, v77
  v_exp_f32 v80, v80
  v_exp_f32 v81, v81
  v_cvt_pk_bf16_f32 v33, v78, v79
  v_exp_f32 v82, v82
  v_exp_f32 v83, v83
  v_cvt_pk_bf16_f32 v34, v80, v81
  v_cvt_pk_bf16_f32 v35, v82, v83
  s_waitcnt lgkmcnt(2)
  v_mfma_f32_32x32x16_bf16 v[68:83], v[16:19], v[12:15], v[36:51]
  ds_read_b128 v[16:19], v2 offset:16384
  s_add_u32 m0, s23, 114688
  s_add_u32 s54, s22, 114688
  buffer_load_dwordx4 v1, s[16:19], s54 offen sc1 lds
  v_exp_f32 v52, v52
  v_exp_f32 v53, v53
  v_exp_f32 v54, v54
  v_exp_f32 v55, v55
  v_cvt_pk_bf16_f32 v28, v52, v53
  v_exp_f32 v56, v56
  v_exp_f32 v57, v57
  v_cvt_pk_bf16_f32 v29, v54, v55
  s_waitcnt lgkmcnt(2)
  v_mfma_f32_32x32x16_bf16 v[84:99], v[24:27], v[32:35], v[84:99]
  v_exp_f32 v58, v58
  v_exp_f32 v59, v59
  v_cvt_pk_bf16_f32 v30, v56, v57
  v_exp_f32 v60, v60
  v_exp_f32 v61, v61
  v_cvt_pk_bf16_f32 v31, v58, v59
  v_exp_f32 v62, v62
  v_exp_f32 v63, v63
  s_waitcnt lgkmcnt(1)
  v_mfma_f32_32x32x16_bf16 v[84:99], v[20:23], v[28:31], v[84:99]
  s_mov_b64 exec, s[94:95]
  ds_read_b128 v[24:27], v4 offset:12800
  ds_read_b128 v[20:23], v4 offset:14336
  s_mov_b64 exec, -1
  v_cvt_pk_bf16_f32 v32, v60, v61
  v_exp_f32 v64, v64
  v_exp_f32 v65, v65
  v_cvt_pk_bf16_f32 v33, v62, v63
  v_exp_f32 v66, v66
  v_exp_f32 v67, v67
  v_cvt_pk_bf16_f32 v34, v64, v65
  v_cvt_pk_bf16_f32 v35, v66, v67
  s_waitcnt lgkmcnt(2)
  v_mfma_f32_32x32x16_bf16 v[52:67], v[16:19], v[12:15], v[36:51]
  ds_read_b128 v[16:19], v2 offset:18432
  s_add_u32 m0, s23, 122880
  s_add_u32 s54, s22, 122880
  buffer_load_dwordx4 v1, s[16:19], s54 offen sc1 lds
  v_exp_f32 v68, v68
  v_exp_f32 v69, v69
  v_exp_f32 v70, v70
  v_exp_f32 v71, v71
  v_cvt_pk_bf16_f32 v28, v68, v69
  v_exp_f32 v72, v72
  v_exp_f32 v73, v73
  v_cvt_pk_bf16_f32 v29, v70, v71
  s_waitcnt lgkmcnt(2)
  v_mfma_f32_32x32x16_bf16 v[84:99], v[24:27], v[32:35], v[84:99]
  v_exp_f32 v74, v74
  v_exp_f32 v75, v75
  v_cvt_pk_bf16_f32 v30, v72, v73
  v_exp_f32 v76, v76
  v_exp_f32 v77, v77
  v_cvt_pk_bf16_f32 v31, v74, v75
  v_exp_f32 v78, v78
  v_exp_f32 v79, v79
  s_waitcnt lgkmcnt(1)
  v_mfma_f32_32x32x16_bf16 v[84:99], v[20:23], v[28:31], v[84:99]
  s_mov_b64 exec, s[94:95]
  ds_read_b128 v[24:27], v4 offset:14848
  ds_read_b128 v[20:23], v4 offset:16384
  s_mov_b64 exec, -1
  v_cvt_pk_bf16_f32 v32, v76, v77
  v_exp_f32 v80, v80
  v_exp_f32 v81, v81
  v_cvt_pk_bf16_f32 v33, v78, v79
  v_exp_f32 v82, v82
  v_exp_f32 v83, v83
  v_cvt_pk_bf16_f32 v34, v80, v81
  v_cvt_pk_bf16_f32 v35, v82, v83
  s_waitcnt lgkmcnt(2)
  v_mfma_f32_32x32x16_bf16 v[68:83], v[16:19], v[12:15], v[36:51]
  ds_read_b128 v[16:19], v2 offset:20480
  v_exp_f32 v52, v52
  v_exp_f32 v53, v53
  v_exp_f32 v54, v54
  v_exp_f32 v55, v55
  v_cvt_pk_bf16_f32 v28, v52, v53
  v_exp_f32 v56, v56
  v_exp_f32 v57, v57
  v_cvt_pk_bf16_f32 v29, v54, v55
  s_waitcnt lgkmcnt(2)
  v_mfma_f32_32x32x16_bf16 v[84:99], v[24:27], v[32:35], v[84:99]
  v_exp_f32 v58, v58
  v_exp_f32 v59, v59
  v_cvt_pk_bf16_f32 v30, v56, v57
  v_exp_f32 v60, v60
  v_exp_f32 v61, v61
  v_cvt_pk_bf16_f32 v31, v58, v59
  v_exp_f32 v62, v62
  v_exp_f32 v63, v63
  s_waitcnt lgkmcnt(1)
  v_mfma_f32_32x32x16_bf16 v[84:99], v[20:23], v[28:31], v[84:99]
  s_mov_b64 exec, s[94:95]
  ds_read_b128 v[24:27], v4 offset:16896
  ds_read_b128 v[20:23], v4 offset:18432
  s_mov_b64 exec, -1
  v_cvt_pk_bf16_f32 v32, v60, v61
  v_exp_f32 v64, v64
  v_exp_f32 v65, v65
  v_cvt_pk_bf16_f32 v33, v62, v63
  v_exp_f32 v66, v66
  v_exp_f32 v67, v67
  v_cvt_pk_bf16_f32 v34, v64, v65
  v_cvt_pk_bf16_f32 v35, v66, v67
  s_waitcnt lgkmcnt(2)
  v_mfma_f32_32x32x16_bf16 v[52:67], v[16:19], v[12:15], v[36:51]
  ds_read_b128 v[16:19], v2 offset:22528
  v_exp_f32 v68, v68
  v_exp_f32 v69, v69
  v_exp_f32 v70, v70
  v_exp_f32 v71, v71
  v_cvt_pk_bf16_f32 v28, v68, v69
  v_exp_f32 v72, v72
  v_exp_f32 v73, v73
  v_cvt_pk_bf16_f32 v29, v70, v71
  s_waitcnt lgkmcnt(2)
  v_mfma_f32_32x32x16_bf16 v[84:99], v[24:27], v[32:35], v[84:99]
  v_exp_f32 v74, v74
  v_exp_f32 v75, v75
  v_cvt_pk_bf16_f32 v30, v72, v73
  v_exp_f32 v76, v76
  v_exp_f32 v77, v77
  v_cvt_pk_bf16_f32 v31, v74, v75
  v_exp_f32 v78, v78
  v_exp_f32 v79, v79
  s_waitcnt lgkmcnt(1)
  v_mfma_f32_32x32x16_bf16 v[84:99], v[20:23], v[28:31], v[84:99]
  s_mov_b64 exec, s[94:95]
  ds_read_b128 v[24:27], v4 offset:18944
  ds_read_b128 v[20:23], v4 offset:20480
  s_mov_b64 exec, -1
  v_cvt_pk_bf16_f32 v32, v76, v77
  v_exp_f32 v80, v80
  v_exp_f32 v81, v81
  v_cvt_pk_bf16_f32 v33, v78, v79
  v_exp_f32 v82, v82
  v_exp_f32 v83, v83
  v_cvt_pk_bf16_f32 v34, v80, v81
  v_cvt_pk_bf16_f32 v35, v82, v83
  s_waitcnt lgkmcnt(2)
  v_mfma_f32_32x32x16_bf16 v[68:83], v[16:19], v[12:15], v[36:51]
  ds_read_b128 v[16:19], v2 offset:24576
  v_exp_f32 v52, v52
  v_exp_f32 v53, v53
  v_exp_f32 v54, v54
  v_exp_f32 v55, v55
  v_cvt_pk_bf16_f32 v28, v52, v53
  v_exp_f32 v56, v56
  v_exp_f32 v57, v57
  v_cvt_pk_bf16_f32 v29, v54, v55
  s_waitcnt lgkmcnt(2)
  v_mfma_f32_32x32x16_bf16 v[84:99], v[24:27], v[32:35], v[84:99]
  v_exp_f32 v58, v58
  v_exp_f32 v59, v59
  v_cvt_pk_bf16_f32 v30, v56, v57
  v_exp_f32 v60, v60
  v_exp_f32 v61, v61
  v_cvt_pk_bf16_f32 v31, v58, v59
  v_exp_f32 v62, v62
  v_exp_f32 v63, v63
  s_waitcnt lgkmcnt(1)
  v_mfma_f32_32x32x16_bf16 v[84:99], v[20:23], v[28:31], v[84:99]
  s_mov_b64 exec, s[94:95]
  ds_read_b128 v[24:27], v4 offset:20992
  ds_read_b128 v[20:23], v4 offset:22528
  s_mov_b64 exec, -1
  v_cvt_pk_bf16_f32 v32, v60, v61
  v_exp_f32 v64, v64
  v_exp_f32 v65, v65
  v_cvt_pk_bf16_f32 v33, v62, v63
  v_exp_f32 v66, v66
  v_exp_f32 v67, v67
  v_cvt_pk_bf16_f32 v34, v64, v65
  v_cvt_pk_bf16_f32 v35, v66, v67
  s_waitcnt lgkmcnt(2)
  v_mfma_f32_32x32x16_bf16 v[52:67], v[16:19], v[12:15], v[36:51]
  ds_read_b128 v[16:19], v2 offset:26624
  v_exp_f32 v68, v68
  v_exp_f32 v69, v69
  v_exp_f32 v70, v70
  v_exp_f32 v71, v71
  v_cvt_pk_bf16_f32 v28, v68, v69
  v_exp_f32 v72, v72
  v_exp_f32 v73, v73
  v_cvt_pk_bf16_f32 v29, v70, v71
  s_waitcnt lgkmcnt(2)
  v_mfma_f32_32x32x16_bf16 v[84:99], v[24:27], v[32:35], v[84:99]
  v_exp_f32 v74, v74
  v_exp_f32 v75, v75
  v_cvt_pk_bf16_f32 v30, v72, v73
  v_exp_f32 v76, v76
  v_exp_f32 v77, v77
  v_cvt_pk_bf16_f32 v31, v74, v75
  v_exp_f32 v78, v78
  v_exp_f32 v79, v79
  s_waitcnt lgkmcnt(1)
  v_mfma_f32_32x32x16_bf16 v[84:99], v[20:23], v[28:31], v[84:99]
  s_mov_b64 exec, s[94:95]
  ds_read_b128 v[24:27], v4 offset:23040
  ds_read_b128 v[20:23], v4 offset:24576
  s_mov_b64 exec, -1
  v_cvt_pk_bf16_f32 v32, v76, v77
  v_exp_f32 v80, v80
  v_exp_f32 v81, v81
  v_cvt_pk_bf16_f32 v33, v78, v79
  v_exp_f32 v82, v82
  v_exp_f32 v83, v83
  v_cvt_pk_bf16_f32 v34, v80, v81
  v_cvt_pk_bf16_f32 v35, v82, v83
  s_waitcnt lgkmcnt(2)
  v_mfma_f32_32x32x16_bf16 v[68:83], v[16:19], v[12:15], v[36:51]
  ds_read_b128 v[16:19], v2 offset:28672
  v_exp_f32 v52, v52
  v_exp_f32 v53, v53
  v_exp_f32 v54, v54
  v_exp_f32 v55, v55
  v_cvt_pk_bf16_f32 v28, v52, v53
  v_exp_f32 v56, v56
  v_exp_f32 v57, v57
  v_cvt_pk_bf16_f32 v29, v54, v55
  s_waitcnt lgkmcnt(2)
  v_mfma_f32_32x32x16_bf16 v[84:99], v[24:27], v[32:35], v[84:99]
  v_exp_f32 v58, v58
  v_exp_f32 v59, v59
  v_cvt_pk_bf16_f32 v30, v56, v57
  v_exp_f32 v60, v60
  v_exp_f32 v61, v61
  v_cvt_pk_bf16_f32 v31, v58, v59
  v_exp_f32 v62, v62
  v_exp_f32 v63, v63
  s_waitcnt lgkmcnt(1)
  v_mfma_f32_32x32x16_bf16 v[84:99], v[20:23], v[28:31], v[84:99]
  s_mov_b64 exec, s[94:95]
  ds_read_b128 v[24:27], v4 offset:25088
  ds_read_b128 v[20:23], v4 offset:26624
  s_mov_b64 exec, -1
  v_cvt_pk_bf16_f32 v32, v60, v61
  v_exp_f32 v64, v64
  v_exp_f32 v65, v65
  v_cvt_pk_bf16_f32 v33, v62, v63
  v_exp_f32 v66, v66
  v_exp_f32 v67, v67
  v_cvt_pk_bf16_f32 v34, v64, v65
  v_cvt_pk_bf16_f32 v35, v66, v67
  s_waitcnt lgkmcnt(2)
  v_mfma_f32_32x32x16_bf16 v[52:67], v[16:19], v[12:15], v[36:51]
  ds_read_b128 v[16:19], v2 offset:30720
  v_exp_f32 v68, v68
  v_exp_f32 v69, v69
  v_exp_f32 v70, v70
  v_exp_f32 v71, v71
  v_cvt_pk_bf16_f32 v28, v68, v69
  v_exp_f32 v72, v72
  v_exp_f32 v73, v73
  v_cvt_pk_bf16_f32 v29, v70, v71
  s_waitcnt lgkmcnt(2)
  v_mfma_f32_32x32x16_bf16 v[84:99], v[24:27], v[32:35], v[84:99]
  v_exp_f32 v74, v74
  v_exp_f32 v75, v75
  v_cvt_pk_bf16_f32 v30, v72, v73
  v_exp_f32 v76, v76
  v_exp_f32 v77, v77
  v_cvt_pk_bf16_f32 v31, v74, v75
  v_exp_f32 v78, v78
  v_exp_f32 v79, v79
  s_waitcnt lgkmcnt(1)
  v_mfma_f32_32x32x16_bf16 v[84:99], v[20:23], v[28:31], v[84:99]
  s_mov_b64 exec, s[94:95]
  ds_read_b128 v[24:27], v4 offset:27136
  ds_read_b128 v[20:23], v4 offset:28672
  s_mov_b64 exec, -1
  v_lshrrev_b32 v6, 2, v0
  v_lshlrev_b32 v6, 8, v6
  v_and_b32 v7, 3, v0
  v_lshlrev_b32 v7, 4, v7
  v_add_u32 v6, v6, v7
  v_and_b32 v7, 15, v0
  v_lshlrev_b32 v7, 2, v7
  s_mov_b32 s53, 18878464
  s_lshr_b32 s52, s24, 2
  s_lshl_b32 s52, s52, 8
  s_add_u32 s52, s52, 18882560
  buffer_load_dwordx4 v[8:11], v6, s[16:19], s53 offen sc1
  buffer_load_dword v228, v7, s[16:19], s52 offen sc1
  v_cvt_pk_bf16_f32 v32, v76, v77
  v_exp_f32 v80, v80
  v_exp_f32 v81, v81
  v_cvt_pk_bf16_f32 v33, v78, v79
  v_exp_f32 v82, v82
  v_exp_f32 v83, v83
  v_cvt_pk_bf16_f32 v34, v80, v81
  v_cvt_pk_bf16_f32 v35, v82, v83
  s_waitcnt lgkmcnt(2)
  v_mfma_f32_32x32x16_bf16 v[68:83], v[16:19], v[12:15], v[36:51]
  ds_read_b128 v[16:19], v2 offset:32768
  v_exp_f32 v52, v52
  v_exp_f32 v53, v53
  v_exp_f32 v54, v54
  v_exp_f32 v55, v55
  v_cvt_pk_bf16_f32 v28, v52, v53
  v_exp_f32 v56, v56
  v_exp_f32 v57, v57
  v_cvt_pk_bf16_f32 v29, v54, v55
  s_waitcnt lgkmcnt(2)
  v_mfma_f32_32x32x16_bf16 v[84:99], v[24:27], v[32:35], v[84:99]
  v_exp_f32 v58, v58
  v_exp_f32 v59, v59
  v_cvt_pk_bf16_f32 v30, v56, v57
  v_exp_f32 v60, v60
  v_exp_f32 v61, v61
  v_cvt_pk_bf16_f32 v31, v58, v59
  v_exp_f32 v62, v62
  v_exp_f32 v63, v63
  s_waitcnt lgkmcnt(1)
  v_mfma_f32_32x32x16_bf16 v[84:99], v[20:23], v[28:31], v[84:99]
  s_mov_b64 exec, s[94:95]
  ds_read_b128 v[24:27], v4 offset:29184
  ds_read_b128 v[20:23], v4 offset:30720
  s_mov_b64 exec, -1
  v_cvt_pk_bf16_f32 v32, v60, v61
  v_exp_f32 v64, v64
  v_exp_f32 v65, v65
  v_cvt_pk_bf16_f32 v33, v62, v63
  v_exp_f32 v66, v66
  v_exp_f32 v67, v67
  v_cvt_pk_bf16_f32 v34, v64, v65
  v_cvt_pk_bf16_f32 v35, v66, v67
  s_waitcnt lgkmcnt(2)
  v_mfma_f32_32x32x16_bf16 v[52:67], v[16:19], v[12:15], v[36:51]
  ds_read_b128 v[16:19], v2 offset:34816
  v_exp_f32 v68, v68
  v_exp_f32 v69, v69
  v_exp_f32 v70, v70
  v_exp_f32 v71, v71
  v_cvt_pk_bf16_f32 v28, v68, v69
  v_exp_f32 v72, v72
  v_exp_f32 v73, v73
  v_cvt_pk_bf16_f32 v29, v70, v71
  s_waitcnt lgkmcnt(2)
  v_mfma_f32_32x32x16_bf16 v[84:99], v[24:27], v[32:35], v[84:99]
  v_exp_f32 v74, v74
  v_exp_f32 v75, v75
  v_cvt_pk_bf16_f32 v30, v72, v73
  v_exp_f32 v76, v76
  v_exp_f32 v77, v77
  v_cvt_pk_bf16_f32 v31, v74, v75
  v_exp_f32 v78, v78
  v_exp_f32 v79, v79
  s_waitcnt lgkmcnt(1)
  v_mfma_f32_32x32x16_bf16 v[84:99], v[20:23], v[28:31], v[84:99]
  s_mov_b64 exec, s[94:95]
  ds_read_b128 v[24:27], v4 offset:31232
  ds_read_b128 v[20:23], v4 offset:32768
  s_mov_b64 exec, -1
  v_cvt_pk_bf16_f32 v32, v76, v77
  v_exp_f32 v80, v80
  v_exp_f32 v81, v81
  v_cvt_pk_bf16_f32 v33, v78, v79
  v_exp_f32 v82, v82
  v_exp_f32 v83, v83
  v_cvt_pk_bf16_f32 v34, v80, v81
  v_cvt_pk_bf16_f32 v35, v82, v83
  s_waitcnt vmcnt(0)
  v_and_b32 v8, v8, v9
  v_and_b32 v10, v10, v11
  v_and_b32 v8, v8, v10
  v_and_b32 v8, v8, v228
  v_cmp_ne_u32 vcc, 1, v8
s_nop 3
s_cbranch_vccz ok_22
  s_mov_b32 s11, 20000
spin_23:
  s_sleep 1
  s_mov_b32 s53, 18878464
  s_lshr_b32 s52, s24, 2
  s_lshl_b32 s52, s52, 8
  s_add_u32 s52, s52, 18882560
  buffer_load_dwordx4 v[8:11], v6, s[16:19], s53 offen sc1
  buffer_load_dword v228, v7, s[16:19], s52 offen sc1
  s_waitcnt vmcnt(0)
  v_and_b32 v8, v8, v9
  v_and_b32 v10, v10, v11
  v_and_b32 v8, v8, v10
  v_and_b32 v8, v8, v228
  v_cmp_ne_u32 vcc, 1, v8
s_nop 3
s_cbranch_vccz ok_22
  s_sub_u32 s11, s11, 1
  s_cmp_lg_u32 s11, 0
s_cbranch_scc1 spin_23
  v_mov_b32 v6, 3
  buffer_store_dword v6, off, s[40:43], 0 offset:12
s_nop 0
ok_22:
  s_waitcnt lgkmcnt(2)
  v_mfma_f32_32x32x16_bf16 v[68:83], v[16:19], v[12:15], v[36:51]
  ds_read_b128 v[16:19], v2 offset:36864
  s_add_u32 s54, s8, 0
  buffer_load_dwordx4 v[164:167], v1, s[16:19], s54 offen sc1
  s_add_u32 s55, s9, 0
  buffer_load_dwordx4 v[168:171], v1, s[16:19], s55 offen offset:0 sc1
  v_exp_f32 v52, v52
  v_exp_f32 v53, v53
  v_exp_f32 v54, v54
  v_exp_f32 v55, v55
  v_cvt_pk_bf16_f32 v28, v52, v53
  v_exp_f32 v56, v56
  v_exp_f32 v57, v57
  v_cvt_pk_bf16_f32 v29, v54, v55
  s_waitcnt lgkmcnt(2)
  v_mfma_f32_32x32x16_bf16 v[84:99], v[24:27], v[32:35], v[84:99]
  v_exp_f32 v58, v58
  v_exp_f32 v59, v59
  v_cvt_pk_bf16_f32 v30, v56, v57
  v_exp_f32 v60, v60
  v_exp_f32 v61, v61
  v_cvt_pk_bf16_f32 v31, v58, v59
  v_exp_f32 v62, v62
  v_exp_f32 v63, v63
  s_waitcnt lgkmcnt(1)
  v_mfma_f32_32x32x16_bf16 v[84:99], v[20:23], v[28:31], v[84:99]
  s_mov_b64 exec, s[94:95]
  ds_read_b128 v[24:27], v4 offset:33280
  ds_read_b128 v[20:23], v4 offset:34816
  s_mov_b64 exec, -1
  buffer_load_dwordx4 v[172:175], v1, s[16:19], s55 offen offset:1024 sc1
  v_cvt_pk_bf16_f32 v32, v60, v61
  v_exp_f32 v64, v64
  v_exp_f32 v65, v65
  v_cvt_pk_bf16_f32 v33, v62, v63
  v_exp_f32 v66, v66
  v_exp_f32 v67, v67
  v_cvt_pk_bf16_f32 v34, v64, v65
  v_cvt_pk_bf16_f32 v35, v66, v67
  s_waitcnt lgkmcnt(2)
  v_mfma_f32_32x32x16_bf16 v[52:67], v[16:19], v[12:15], v[36:51]
  ds_read_b128 v[16:19], v2 offset:38912
  s_add_u32 s54, s8, 1024
  buffer_load_dwordx4 v[176:179], v1, s[16:19], s54 offen sc1
  v_exp_f32 v68, v68
  v_exp_f32 v69, v69
  v_exp_f32 v70, v70
  v_exp_f32 v71, v71
  v_cvt_pk_bf16_f32 v28, v68, v69
  v_exp_f32 v72, v72
  v_exp_f32 v73, v73
  v_cvt_pk_bf16_f32 v29, v70, v71
  s_waitcnt lgkmcnt(2)
  v_mfma_f32_32x32x16_bf16 v[84:99], v[24:27], v[32:35], v[84:99]
  v_exp_f32 v74, v74
  v_exp_f32 v75, v75
  v_cvt_pk_bf16_f32 v30, v72, v73
  v_exp_f32 v76, v76
  v_exp_f32 v77, v77
  v_cvt_pk_bf16_f32 v31, v74, v75
  v_exp_f32 v78, v78
  v_exp_f32 v79, v79
  s_waitcnt lgkmcnt(1)
  v_mfma_f32_32x32x16_bf16 v[84:99], v[20:23], v[28:31], v[84:99]
  s_mov_b64 exec, s[94:95]
  ds_read_b128 v[24:27], v4 offset:35328
  ds_read_b128 v[20:23], v4 offset:36864
  s_mov_b64 exec, -1
  s_add_u32 s55, s9, 16384
  buffer_load_dwordx4 v[180:183], v1, s[16:19], s55 offen offset:0 sc1
  v_cvt_pk_bf16_f32 v32, v76, v77
  v_exp_f32 v80, v80
  v_exp_f32 v81, v81
  v_cvt_pk_bf16_f32 v33, v78, v79
  v_exp_f32 v82, v82
  v_exp_f32 v83, v83
  v_cvt_pk_bf16_f32 v34, v80, v81
  v_cvt_pk_bf16_f32 v35, v82, v83
  s_waitcnt lgkmcnt(2)
  v_mfma_f32_32x32x16_bf16 v[68:83], v[16:19], v[12:15], v[36:51]
  ds_read_b128 v[16:19], v2 offset:40960
  buffer_load_dwordx4 v[184:187], v1, s[16:19], s55 offen offset:1024 sc1
  v_exp_f32 v52, v52
  v_exp_f32 v53, v53
  v_exp_f32 v54, v54
  v_exp_f32 v55, v55
  v_cvt_pk_bf16_f32 v28, v52, v53
  v_exp_f32 v56, v56
  v_exp_f32 v57, v57
  v_cvt_pk_bf16_f32 v29, v54, v55
  s_waitcnt lgkmcnt(2)
  v_mfma_f32_32x32x16_bf16 v[84:99], v[24:27], v[32:35], v[84:99]
  v_exp_f32 v58, v58
  v_exp_f32 v59, v59
  v_cvt_pk_bf16_f32 v30, v56, v57
  v_exp_f32 v60, v60
  v_exp_f32 v61, v61
  v_cvt_pk_bf16_f32 v31, v58, v59
  v_exp_f32 v62, v62
  v_exp_f32 v63, v63
  s_waitcnt lgkmcnt(1)
  v_mfma_f32_32x32x16_bf16 v[84:99], v[20:23], v[28:31], v[84:99]
  s_mov_b64 exec, s[94:95]
  ds_read_b128 v[24:27], v4 offset:37376
  ds_read_b128 v[20:23], v4 offset:38912
  s_mov_b64 exec, -1
  s_add_u32 s54, s8, 2048
  buffer_load_dwordx4 v[188:191], v1, s[16:19], s54 offen sc1
  v_cvt_pk_bf16_f32 v32, v60, v61
  v_exp_f32 v64, v64
  v_exp_f32 v65, v65
  v_cvt_pk_bf16_f32 v33, v62, v63
  v_exp_f32 v66, v66
  v_exp_f32 v67, v67
  v_cvt_pk_bf16_f32 v34, v64, v65
  v_cvt_pk_bf16_f32 v35, v66, v67
  s_waitcnt lgkmcnt(2)
  v_mfma_f32_32x32x16_bf16 v[52:67], v[16:19], v[12:15], v[36:51]
  ds_read_b128 v[16:19], v2 offset:43008
  s_add_u32 s55, s9, 32768
  buffer_load_dwordx4 v[192:195], v1, s[16:19], s55 offen offset:0 sc1
  v_exp_f32 v68, v68
  v_exp_f32 v69, v69
  v_exp_f32 v70, v70
  v_exp_f32 v71, v71
  v_cvt_pk_bf16_f32 v28, v68, v69
  v_exp_f32 v72, v72
  v_exp_f32 v73, v73
  v_cvt_pk_bf16_f32 v29, v70, v71
  s_waitcnt lgkmcnt(2)
  v_mfma_f32_32x32x16_bf16 v[84:99], v[24:27], v[32:35], v[84:99]
  v_exp_f32 v74, v74
  v_exp_f32 v75, v75
  v_cvt_pk_bf16_f32 v30, v72, v73
  v_exp_f32 v76, v76
  v_exp_f32 v77, v77
  v_cvt_pk_bf16_f32 v31, v74, v75
  v_exp_f32 v78, v78
  v_exp_f32 v79, v79
  s_waitcnt lgkmcnt(1)
  v_mfma_f32_32x32x16_bf16 v[84:99], v[20:23], v[28:31], v[84:99]
  s_mov_b64 exec, s[94:95]
  ds_read_b128 v[24:27], v4 offset:39424
  ds_read_b128 v[20:23], v4 offset:40960
  s_mov_b64 exec, -1
  buffer_load_dwordx4 v[196:199], v1, s[16:19], s55 offen offset:1024 sc1
  v_cvt_pk_bf16_f32 v32, v76, v77
  v_exp_f32 v80, v80
  v_exp_f32 v81, v81
  v_cvt_pk_bf16_f32 v33, v78, v79
  v_exp_f32 v82, v82
  v_exp_f32 v83, v83
  v_cvt_pk_bf16_f32 v34, v80, v81
  v_cvt_pk_bf16_f32 v35, v82, v83
  s_waitcnt lgkmcnt(2)
  v_mfma_f32_32x32x16_bf16 v[68:83], v[16:19], v[12:15], v[36:51]
  ds_read_b128 v[16:19], v2 offset:45056
  s_add_u32 s54, s8, 3072
  buffer_load_dwordx4 v[200:203], v1, s[16:19], s54 offen sc1
  v_exp_f32 v52, v52
  v_exp_f32 v53, v53
  v_exp_f32 v54, v54
  v_exp_f32 v55, v55
  v_cvt_pk_bf16_f32 v28, v52, v53
  v_exp_f32 v56, v56
  v_exp_f32 v57, v57
  v_cvt_pk_bf16_f32 v29, v54, v55
  s_waitcnt lgkmcnt(2)
  v_mfma_f32_32x32x16_bf16 v[84:99], v[24:27], v[32:35], v[84:99]
  v_exp_f32 v58, v58
  v_exp_f32 v59, v59
  v_cvt_pk_bf16_f32 v30, v56, v57
  v_exp_f32 v60, v60
  v_exp_f32 v61, v61
  v_cvt_pk_bf16_f32 v31, v58, v59
  v_exp_f32 v62, v62
  v_exp_f32 v63, v63
  s_waitcnt lgkmcnt(1)
  v_mfma_f32_32x32x16_bf16 v[84:99], v[20:23], v[28:31], v[84:99]
  s_mov_b64 exec, s[94:95]
  ds_read_b128 v[24:27], v4 offset:41472
  ds_read_b128 v[20:23], v4 offset:43008
  s_mov_b64 exec, -1
  s_add_u32 s55, s9, 49152
  buffer_load_dwordx4 v[204:207], v1, s[16:19], s55 offen offset:0 sc1
  buffer_load_dwordx4 v[208:211], v1, s[16:19], s55 offen offset:1024 sc1
  v_cvt_pk_bf16_f32 v32, v60, v61
  v_exp_f32 v64, v64
  v_exp_f32 v65, v65
  v_cvt_pk_bf16_f32 v33, v62, v63
  v_exp_f32 v66, v66
  v_exp_f32 v67, v67
  v_cvt_pk_bf16_f32 v34, v64, v65
  v_cvt_pk_bf16_f32 v35, v66, v67
  s_waitcnt lgkmcnt(2)
  v_mfma_f32_32x32x16_bf16 v[52:67], v[16:19], v[12:15], v[36:51]
  ds_read_b128 v[16:19], v2 offset:47104
  s_add_u32 s54, s8, 4096
  buffer_load_dwordx4 v[212:215], v1, s[16:19], s54 offen sc1
  v_exp_f32 v68, v68
  v_exp_f32 v69, v69
  v_exp_f32 v70, v70
  v_exp_f32 v71, v71
  v_cvt_pk_bf16_f32 v28, v68, v69
  v_exp_f32 v72, v72
  v_exp_f32 v73, v73
  v_cvt_pk_bf16_f32 v29, v70, v71
  s_waitcnt lgkmcnt(2)
  v_mfma_f32_32x32x16_bf16 v[84:99], v[24:27], v[32:35], v[84:99]
  v_exp_f32 v74, v74
  v_exp_f32 v75, v75
  v_cvt_pk_bf16_f32 v30, v72, v73
  v_exp_f32 v76, v76
  v_exp_f32 v77, v77
  v_cvt_pk_bf16_f32 v31, v74, v75
  v_exp_f32 v78, v78
  v_exp_f32 v79, v79
  s_waitcnt lgkmcnt(1)
  v_mfma_f32_32x32x16_bf16 v[84:99], v[20:23], v[28:31], v[84:99]
  s_mov_b64 exec, s[94:95]
  ds_read_b128 v[24:27], v4 offset:43520
  ds_read_b128 v[20:23], v4 offset:45056
  s_mov_b64 exec, -1
  s_add_u32 s55, s9, 65536
  buffer_load_dwordx4 v[216:219], v1, s[16:19], s55 offen offset:0 sc1
  v_cvt_pk_bf16_f32 v32, v76, v77
  v_exp_f32 v80, v80
  v_exp_f32 v81, v81
  v_cvt_pk_bf16_f32 v33, v78, v79
  s_waitcnt vmcnt(12)
  v_mfma_f32_32x32x16_bf16 v[100:115], v[168:171], v[164:167], 0
  v_exp_f32 v82, v82
  v_exp_f32 v83, v83
  v_cvt_pk_bf16_f32 v34, v80, v81
  v_cvt_pk_bf16_f32 v35, v82, v83
  s_waitcnt lgkmcnt(2)
  v_mfma_f32_32x32x16_bf16 v[68:83], v[16:19], v[12:15], v[36:51]
  ds_read_b128 v[16:19], v2 offset:49152
  buffer_load_dwordx4 v[220:223], v1, s[16:19], s55 offen offset:1024 sc1
  v_exp_f32 v52, v52
  v_exp_f32 v53, v53
  v_exp_f32 v54, v54
  v_exp_f32 v55, v55
  s_waitcnt vmcnt(12)
  v_mfma_f32_32x32x16_bf16 v[116:131], v[172:175], v[164:167], 0
  v_cvt_pk_bf16_f32 v28, v52, v53
  v_exp_f32 v56, v56
  v_exp_f32 v57, v57
  v_cvt_pk_bf16_f32 v29, v54, v55
  s_waitcnt lgkmcnt(2)
  v_mfma_f32_32x32x16_bf16 v[84:99], v[24:27], v[32:35], v[84:99]
  v_exp_f32 v58, v58
  v_exp_f32 v59, v59
  v_cvt_pk_bf16_f32 v30, v56, v57
  v_exp_f32 v60, v60
  v_exp_f32 v61, v61
  v_cvt_pk_bf16_f32 v31, v58, v59
  v_exp_f32 v62, v62
  v_exp_f32 v63, v63
  s_waitcnt lgkmcnt(1)
  v_mfma_f32_32x32x16_bf16 v[84:99], v[20:23], v[28:31], v[84:99]
  s_mov_b64 exec, s[94:95]
  ds_read_b128 v[24:27], v4 offset:45568
  ds_read_b128 v[20:23], v4 offset:47104
  s_mov_b64 exec, -1
  s_add_u32 s54, s8, 5120
  buffer_load_dwordx4 v[224:227], v1, s[16:19], s54 offen sc1
  v_cvt_pk_bf16_f32 v32, v60, v61
  v_exp_f32 v64, v64
  v_exp_f32 v65, v65
  v_cvt_pk_bf16_f32 v33, v62, v63
  v_exp_f32 v66, v66
  v_exp_f32 v67, v67
  v_cvt_pk_bf16_f32 v34, v64, v65
  v_cvt_pk_bf16_f32 v35, v66, v67
  s_waitcnt lgkmcnt(2)
  v_mfma_f32_32x32x16_bf16 v[52:67], v[16:19], v[12:15], v[36:51]
  ds_read_b128 v[16:19], v2 offset:51200
  s_add_u32 s55, s9, 81920
  buffer_load_dwordx4 v[164:167], v1, s[16:19], s55 offen offset:0 sc1
  v_exp_f32 v68, v68
  v_exp_f32 v69, v69
  v_exp_f32 v70, v70
  v_exp_f32 v71, v71
  s_waitcnt vmcnt(12)
  v_mfma_f32_32x32x16_bf16 v[100:115], v[180:183], v[176:179], v[100:115]
  v_cvt_pk_bf16_f32 v28, v68, v69
  v_exp_f32 v72, v72
  v_exp_f32 v73, v73
  v_cvt_pk_bf16_f32 v29, v70, v71
  s_waitcnt lgkmcnt(2)
  v_mfma_f32_32x32x16_bf16 v[84:99], v[24:27], v[32:35], v[84:99]
  v_exp_f32 v74, v74
  v_exp_f32 v75, v75
  v_cvt_pk_bf16_f32 v30, v72, v73
  v_exp_f32 v76, v76
  v_exp_f32 v77, v77
  v_cvt_pk_bf16_f32 v31, v74, v75
  v_exp_f32 v78, v78
  v_exp_f32 v79, v79
  s_waitcnt lgkmcnt(1)
  v_mfma_f32_32x32x16_bf16 v[84:99], v[20:23], v[28:31], v[84:99]
  s_mov_b64 exec, s[94:95]
  ds_read_b128 v[24:27], v4 offset:47616
  ds_read_b128 v[20:23], v4 offset:49152
  s_mov_b64 exec, -1
  buffer_load_dwordx4 v[168:171], v1, s[16:19], s55 offen offset:1024 sc1
  v_cvt_pk_bf16_f32 v32, v76, v77
  v_exp_f32 v80, v80
  v_exp_f32 v81, v81
  v_cvt_pk_bf16_f32 v33, v78, v79
  s_waitcnt vmcnt(12)
  v_mfma_f32_32x32x16_bf16 v[116:131], v[184:187], v[176:179], v[116:131]
  v_exp_f32 v82, v82
  v_exp_f32 v83, v83
  v_cvt_pk_bf16_f32 v34, v80, v81
  v_cvt_pk_bf16_f32 v35, v82, v83
  s_barrier
  s_waitcnt lgkmcnt(2)
  v_mfma_f32_32x32x16_bf16 v[68:83], v[16:19], v[12:15], v[36:51]
  ds_read_b128 v[16:19], v2 offset:53248
  s_add_u32 s54, s8, 6144
  buffer_load_dwordx4 v[172:175], v1, s[16:19], s54 offen sc1
  v_exp_f32 v52, v52
  v_exp_f32 v53, v53
  v_exp_f32 v54, v54
  v_exp_f32 v55, v55
  v_cvt_pk_bf16_f32 v28, v52, v53
  v_exp_f32 v56, v56
  v_exp_f32 v57, v57
  v_cvt_pk_bf16_f32 v29, v54, v55
  s_waitcnt lgkmcnt(2)
  v_mfma_f32_32x32x16_bf16 v[84:99], v[24:27], v[32:35], v[84:99]
  v_exp_f32 v58, v58
  v_exp_f32 v59, v59
  v_cvt_pk_bf16_f32 v30, v56, v57
  v_exp_f32 v60, v60
  v_exp_f32 v61, v61
  v_cvt_pk_bf16_f32 v31, v58, v59
  v_exp_f32 v62, v62
  v_exp_f32 v63, v63
  s_waitcnt lgkmcnt(1)
  v_mfma_f32_32x32x16_bf16 v[84:99], v[20:23], v[28:31], v[84:99]
  s_mov_b64 exec, s[94:95]
  ds_read_b128 v[24:27], v4 offset:49664
  ds_read_b128 v[20:23], v4 offset:51200
  s_mov_b64 exec, -1
  s_add_u32 s55, s9, 98304
  buffer_load_dwordx4 v[176:179], v1, s[16:19], s55 offen offset:0 sc1
  v_cvt_pk_bf16_f32 v32, v60, v61
  v_exp_f32 v64, v64
  v_exp_f32 v65, v65
  v_cvt_pk_bf16_f32 v33, v62, v63
  s_waitcnt vmcnt(12)
  v_mfma_f32_32x32x16_bf16 v[100:115], v[192:195], v[188:191], v[100:115]
  v_exp_f32 v66, v66
  v_exp_f32 v67, v67
  v_cvt_pk_bf16_f32 v34, v64, v65
  v_cvt_pk_bf16_f32 v35, v66, v67
  s_waitcnt lgkmcnt(2)
  v_mfma_f32_32x32x16_bf16 v[52:67], v[16:19], v[12:15], v[36:51]
  ds_read_b128 v[16:19], v2 offset:55296
  buffer_load_dwordx4 v[180:183], v1, s[16:19], s55 offen offset:1024 sc1
  s_add_u32 s54, s8, 7168
  buffer_load_dwordx4 v[184:187], v1, s[16:19], s54 offen sc1
  v_exp_f32 v68, v68
  v_exp_f32 v69, v69
  v_exp_f32 v70, v70
  v_exp_f32 v71, v71
  s_waitcnt vmcnt(13)
  v_mfma_f32_32x32x16_bf16 v[116:131], v[196:199], v[188:191], v[116:131]
  v_cvt_pk_bf16_f32 v28, v68, v69
  v_exp_f32 v72, v72
  v_exp_f32 v73, v73
  v_cvt_pk_bf16_f32 v29, v70, v71
  s_waitcnt lgkmcnt(2)
  v_mfma_f32_32x32x16_bf16 v[84:99], v[24:27], v[32:35], v[84:99]
  v_exp_f32 v74, v74
  v_exp_f32 v75, v75
  v_cvt_pk_bf16_f32 v30, v72, v73
  v_exp_f32 v76, v76
  v_exp_f32 v77, v77
  v_cvt_pk_bf16_f32 v31, v74, v75
  v_exp_f32 v78, v78
  v_exp_f32 v79, v79
  s_waitcnt lgkmcnt(1)
  v_mfma_f32_32x32x16_bf16 v[84:99], v[20:23], v[28:31], v[84:99]
  s_mov_b64 exec, s[94:95]
  ds_read_b128 v[24:27], v4 offset:51712
  ds_read_b128 v[20:23], v4 offset:53248
  s_mov_b64 exec, -1
  s_add_u32 s55, s9, 114688
  buffer_load_dwordx4 v[188:191], v1, s[16:19], s55 offen offset:0 sc1
  v_cvt_pk_bf16_f32 v32, v76, v77
  v_exp_f32 v80, v80
  v_exp_f32 v81, v81
  v_cvt_pk_bf16_f32 v33, v78, v79
  v_exp_f32 v82, v82
  v_exp_f32 v83, v83
  v_cvt_pk_bf16_f32 v34, v80, v81
  v_cvt_pk_bf16_f32 v35, v82, v83
  s_waitcnt lgkmcnt(2)
  v_mfma_f32_32x32x16_bf16 v[68:83], v[16:19], v[12:15], v[36:51]
  ds_read_b128 v[16:19], v2 offset:57344
  buffer_load_dwordx4 v[192:195], v1, s[16:19], s55 offen offset:1024 sc1
  v_exp_f32 v52, v52
  v_exp_f32 v53, v53
  v_exp_f32 v54, v54
  v_exp_f32 v55, v55
  s_waitcnt vmcnt(13)
  v_mfma_f32_32x32x16_bf16 v[100:115], v[204:207], v[200:203], v[100:115]
  s_waitcnt vmcnt(12)
  v_mfma_f32_32x32x16_bf16 v[116:131], v[208:211], v[200:203], v[116:131]
  v_cvt_pk_bf16_f32 v28, v52, v53
  v_exp_f32 v56, v56
  v_exp_f32 v57, v57
  v_cvt_pk_bf16_f32 v29, v54, v55
  s_waitcnt lgkmcnt(2)
  v_mfma_f32_32x32x16_bf16 v[84:99], v[24:27], v[32:35], v[84:99]
  v_exp_f32 v58, v58
  v_exp_f32 v59, v59
  v_cvt_pk_bf16_f32 v30, v56, v57
  v_exp_f32 v60, v60
  v_exp_f32 v61, v61
  v_cvt_pk_bf16_f32 v31, v58, v59
  v_exp_f32 v62, v62
  v_exp_f32 v63, v63
  s_waitcnt lgkmcnt(1)
  v_mfma_f32_32x32x16_bf16 v[84:99], v[20:23], v[28:31], v[84:99]
  s_mov_b64 exec, s[94:95]
  ds_read_b128 v[24:27], v4 offset:53760
  ds_read_b128 v[20:23], v4 offset:55296
  s_mov_b64 exec, -1
  s_add_u32 s54, s8, 8192
  buffer_load_dwordx4 v[196:199], v1, s[16:19], s54 offen sc1
  v_cvt_pk_bf16_f32 v32, v60, v61
  v_exp_f32 v64, v64
  v_exp_f32 v65, v65
  v_cvt_pk_bf16_f32 v33, v62, v63
  v_exp_f32 v66, v66
  v_exp_f32 v67, v67
  v_cvt_pk_bf16_f32 v34, v64, v65
  v_cvt_pk_bf16_f32 v35, v66, v67
  s_waitcnt lgkmcnt(2)
  v_mfma_f32_32x32x16_bf16 v[52:67], v[16:19], v[12:15], v[36:51]
  ds_read_b128 v[16:19], v2 offset:59392
  s_add_u32 s55, s9, 131072
  buffer_load_dwordx4 v[200:203], v1, s[16:19], s55 offen offset:0 sc1
  v_exp_f32 v68, v68
  v_exp_f32 v69, v69
  v_exp_f32 v70, v70
  v_exp_f32 v71, v71
  s_waitcnt vmcnt(12)
  v_mfma_f32_32x32x16_bf16 v[100:115], v[216:219], v[212:215], v[100:115]
  v_cvt_pk_bf16_f32 v28, v68, v69
  v_exp_f32 v72, v72
  v_exp_f32 v73, v73
  v_cvt_pk_bf16_f32 v29, v70, v71
  s_waitcnt lgkmcnt(2)
  v_mfma_f32_32x32x16_bf16 v[84:99], v[24:27], v[32:35], v[84:99]
  v_exp_f32 v74, v74
  v_exp_f32 v75, v75
  v_cvt_pk_bf16_f32 v30, v72, v73
  v_exp_f32 v76, v76
  v_exp_f32 v77, v77
  v_cvt_pk_bf16_f32 v31, v74, v75
  v_exp_f32 v78, v78
  v_exp_f32 v79, v79
  s_waitcnt lgkmcnt(1)
  v_mfma_f32_32x32x16_bf16 v[84:99], v[20:23], v[28:31], v[84:99]
  s_mov_b64 exec, s[94:95]
  ds_read_b128 v[24:27], v4 offset:55808
  ds_read_b128 v[20:23], v4 offset:57344
  s_mov_b64 exec, -1
  buffer_load_dwordx4 v[204:207], v1, s[16:19], s55 offen offset:1024 sc1
  v_cvt_pk_bf16_f32 v32, v76, v77
  v_exp_f32 v80, v80
  v_exp_f32 v81, v81
  v_cvt_pk_bf16_f32 v33, v78, v79
  s_waitcnt vmcnt(12)
  v_mfma_f32_32x32x16_bf16 v[116:131], v[220:223], v[212:215], v[116:131]
  v_exp_f32 v82, v82
  v_exp_f32 v83, v83
  v_cvt_pk_bf16_f32 v34, v80, v81
  v_cvt_pk_bf16_f32 v35, v82, v83
  s_waitcnt lgkmcnt(2)
  v_mfma_f32_32x32x16_bf16 v[68:83], v[16:19], v[12:15], v[36:51]
  ds_read_b128 v[16:19], v2 offset:61440
  s_add_u32 s54, s8, 9216
  buffer_load_dwordx4 v[208:211], v1, s[16:19], s54 offen sc1
  v_exp_f32 v52, v52
  v_exp_f32 v53, v53
  v_exp_f32 v54, v54
  v_exp_f32 v55, v55
  v_cvt_pk_bf16_f32 v28, v52, v53
  v_exp_f32 v56, v56
  v_exp_f32 v57, v57
  v_cvt_pk_bf16_f32 v29, v54, v55
  s_waitcnt lgkmcnt(2)
  v_mfma_f32_32x32x16_bf16 v[84:99], v[24:27], v[32:35], v[84:99]
  v_exp_f32 v58, v58
  v_exp_f32 v59, v59
  v_cvt_pk_bf16_f32 v30, v56, v57
  v_exp_f32 v60, v60
  v_exp_f32 v61, v61
  v_cvt_pk_bf16_f32 v31, v58, v59
  v_exp_f32 v62, v62
  v_exp_f32 v63, v63
  s_waitcnt lgkmcnt(1)
  v_mfma_f32_32x32x16_bf16 v[84:99], v[20:23], v[28:31], v[84:99]
  s_mov_b64 exec, s[94:95]
  ds_read_b128 v[24:27], v4 offset:57856
  ds_read_b128 v[20:23], v4 offset:59392
  s_mov_b64 exec, -1
  s_add_u32 s55, s9, 147456
  buffer_load_dwordx4 v[212:215], v1, s[16:19], s55 offen offset:0 sc1
  v_cvt_pk_bf16_f32 v32, v60, v61
  v_exp_f32 v64, v64
  v_exp_f32 v65, v65
  v_cvt_pk_bf16_f32 v33, v62, v63
  s_waitcnt vmcnt(12)
  v_mfma_f32_32x32x16_bf16 v[100:115], v[164:167], v[224:227], v[100:115]
  v_exp_f32 v66, v66
  v_exp_f32 v67, v67
  v_cvt_pk_bf16_f32 v34, v64, v65
  v_cvt_pk_bf16_f32 v35, v66, v67
  s_waitcnt lgkmcnt(2)
  v_mfma_f32_32x32x16_bf16 v[52:67], v[16:19], v[12:15], v[36:51]
  ds_read_b128 v[16:19], v2 offset:63488
  buffer_load_dwordx4 v[216:219], v1, s[16:19], s55 offen offset:1024 sc1
  v_exp_f32 v68, v68
  v_exp_f32 v69, v69
  v_exp_f32 v70, v70
  v_exp_f32 v71, v71
  s_waitcnt vmcnt(12)
  v_mfma_f32_32x32x16_bf16 v[116:131], v[168:171], v[224:227], v[116:131]
  v_cvt_pk_bf16_f32 v28, v68, v69
  v_exp_f32 v72, v72
  v_exp_f32 v73, v73
  v_cvt_pk_bf16_f32 v29, v70, v71
  s_waitcnt lgkmcnt(2)
  v_mfma_f32_32x32x16_bf16 v[84:99], v[24:27], v[32:35], v[84:99]
  v_exp_f32 v74, v74
  v_exp_f32 v75, v75
  v_cvt_pk_bf16_f32 v30, v72, v73
  v_exp_f32 v76, v76
  v_exp_f32 v77, v77
  v_cvt_pk_bf16_f32 v31, v74, v75
  v_exp_f32 v78, v78
  v_exp_f32 v79, v79
  s_waitcnt lgkmcnt(1)
  v_mfma_f32_32x32x16_bf16 v[84:99], v[20:23], v[28:31], v[84:99]
  s_mov_b64 exec, s[94:95]
  ds_read_b128 v[24:27], v4 offset:59904
  ds_read_b128 v[20:23], v4 offset:61440
  s_mov_b64 exec, -1
  s_add_u32 s54, s8, 10240
  buffer_load_dwordx4 v[220:223], v1, s[16:19], s54 offen sc1
  s_add_u32 s55, s9, 163840
  buffer_load_dwordx4 v[224:227], v1, s[16:19], s55 offen offset:0 sc1
  v_cvt_pk_bf16_f32 v32, v76, v77
  v_exp_f32 v80, v80
  v_exp_f32 v81, v81
  v_cvt_pk_bf16_f32 v33, v78, v79
  v_exp_f32 v82, v82
  v_exp_f32 v83, v83
  v_cvt_pk_bf16_f32 v34, v80, v81
  v_cvt_pk_bf16_f32 v35, v82, v83
  s_waitcnt lgkmcnt(2)
  v_mfma_f32_32x32x16_bf16 v[68:83], v[16:19], v[12:15], v[36:51]
  ds_read_b128 v[16:19], v3 offset:0
  buffer_load_dwordx4 v[164:167], v1, s[16:19], s55 offen offset:1024 sc1
  v_exp_f32 v52, v52
  v_exp_f32 v53, v53
  v_exp_f32 v54, v54
  v_exp_f32 v55, v55
  s_waitcnt vmcnt(13)
  v_mfma_f32_32x32x16_bf16 v[100:115], v[176:179], v[172:175], v[100:115]
  v_cvt_pk_bf16_f32 v28, v52, v53
  v_exp_f32 v56, v56
  v_exp_f32 v57, v57
  v_cvt_pk_bf16_f32 v29, v54, v55
  s_waitcnt lgkmcnt(2)
  v_mfma_f32_32x32x16_bf16 v[84:99], v[24:27], v[32:35], v[84:99]
  v_exp_f32 v58, v58
  v_exp_f32 v59, v59
  v_cvt_pk_bf16_f32 v30, v56, v57
  v_exp_f32 v60, v60
  v_exp_f32 v61, v61
  v_cvt_pk_bf16_f32 v31, v58, v59
  v_exp_f32 v62, v62
  v_exp_f32 v63, v63
  s_waitcnt lgkmcnt(1)
  v_mfma_f32_32x32x16_bf16 v[84:99], v[20:23], v[28:31], v[84:99]
  s_mov_b64 exec, s[94:95]
  ds_read_b128 v[24:27], v4 offset:61952
  ds_read_b128 v[20:23], v4 offset:63488
  s_mov_b64 exec, -1
  s_add_u32 s54, s8, 11264
  buffer_load_dwordx4 v[168:171], v1, s[16:19], s54 offen sc1
  v_cvt_pk_bf16_f32 v32, v60, v61
  v_exp_f32 v64, v64
  v_exp_f32 v65, v65
  v_cvt_pk_bf16_f32 v33, v62, v63
  s_waitcnt vmcnt(13)
  v_mfma_f32_32x32x16_bf16 v[116:131], v[180:183], v[172:175], v[116:131]
  v_exp_f32 v66, v66
  v_exp_f32 v67, v67
  v_cvt_pk_bf16_f32 v34, v64, v65
  v_cvt_pk_bf16_f32 v35, v66, v67
  s_waitcnt lgkmcnt(2)
  v_mfma_f32_32x32x16_bf16 v[52:67], v[16:19], v[12:15], v[36:51]
  ds_read_b128 v[16:19], v3 offset:2048
  s_add_u32 s55, s9, 180224
  buffer_load_dwordx4 v[172:175], v1, s[16:19], s55 offen offset:0 sc1
  v_exp_f32 v68, v68
  v_exp_f32 v69, v69
  v_exp_f32 v70, v70
  v_exp_f32 v71, v71
  s_waitcnt vmcnt(12)
  v_mfma_f32_32x32x16_bf16 v[100:115], v[188:191], v[184:187], v[100:115]
  v_cvt_pk_bf16_f32 v28, v68, v69
  v_exp_f32 v72, v72
  v_exp_f32 v73, v73
  v_cvt_pk_bf16_f32 v29, v70, v71
  s_waitcnt lgkmcnt(2)
  v_mfma_f32_32x32x16_bf16 v[84:99], v[24:27], v[32:35], v[84:99]
  v_exp_f32 v74, v74
  v_exp_f32 v75, v75
  v_cvt_pk_bf16_f32 v30, v72, v73
  v_exp_f32 v76, v76
  v_exp_f32 v77, v77
  v_cvt_pk_bf16_f32 v31, v74, v75
  v_exp_f32 v78, v78
  v_exp_f32 v79, v79
  s_waitcnt lgkmcnt(1)
  v_mfma_f32_32x32x16_bf16 v[84:99], v[20:23], v[28:31], v[84:99]
  s_mov_b64 exec, s[94:95]
  ds_read_b128 v[24:27], v4 offset:64000
  ds_read_b128 v[20:23], v5 offset:0
  s_mov_b64 exec, -1
  buffer_load_dwordx4 v[176:179], v1, s[16:19], s55 offen offset:1024 sc1
  v_cvt_pk_bf16_f32 v32, v76, v77
  v_exp_f32 v80, v80
  v_exp_f32 v81, v81
  v_cvt_pk_bf16_f32 v33, v78, v79
  s_waitcnt vmcnt(12)
  v_mfma_f32_32x32x16_bf16 v[116:131], v[192:195], v[184:187], v[116:131]
  v_exp_f32 v82, v82
  v_exp_f32 v83, v83
  v_cvt_pk_bf16_f32 v34, v80, v81
  v_cvt_pk_bf16_f32 v35, v82, v83
  s_waitcnt lgkmcnt(2)
  v_mfma_f32_32x32x16_bf16 v[68:83], v[16:19], v[12:15], v[36:51]
  ds_read_b128 v[16:19], v3 offset:4096
  s_add_u32 s54, s8, 12288
  buffer_load_dwordx4 v[180:183], v1, s[16:19], s54 offen sc1
  v_exp_f32 v52, v52
  v_exp_f32 v53, v53
  v_exp_f32 v54, v54
  v_exp_f32 v55, v55
  v_cvt_pk_bf16_f32 v28, v52, v53
  v_exp_f32 v56, v56
  v_exp_f32 v57, v57
  v_cvt_pk_bf16_f32 v29, v54, v55
  s_waitcnt lgkmcnt(2)
  v_mfma_f32_32x32x16_bf16 v[84:99], v[24:27], v[32:35], v[84:99]
  v_exp_f32 v58, v58
  v_exp_f32 v59, v59
  v_cvt_pk_bf16_f32 v30, v56, v57
  v_exp_f32 v60, v60
  v_exp_f32 v61, v61
  v_cvt_pk_bf16_f32 v31, v58, v59
  v_exp_f32 v62, v62
  v_exp_f32 v63, v63
  s_waitcnt lgkmcnt(1)
  v_mfma_f32_32x32x16_bf16 v[84:99], v[20:23], v[28:31], v[84:99]
  s_mov_b64 exec, s[94:95]
  ds_read_b128 v[24:27], v5 offset:512
  ds_read_b128 v[20:23], v5 offset:2048
  s_mov_b64 exec, -1
  s_add_u32 s55, s9, 196608
  buffer_load_dwordx4 v[184:187], v1, s[16:19], s55 offen offset:0 sc1
  v_cvt_pk_bf16_f32 v32, v60, v61
  v_exp_f32 v64, v64
  v_exp_f32 v65, v65
  v_cvt_pk_bf16_f32 v33, v62, v63
  s_waitcnt vmcnt(12)
  v_mfma_f32_32x32x16_bf16 v[100:115], v[200:203], v[196:199], v[100:115]
  v_exp_f32 v66, v66
  v_exp_f32 v67, v67
  v_cvt_pk_bf16_f32 v34, v64, v65
  v_cvt_pk_bf16_f32 v35, v66, v67
  s_waitcnt lgkmcnt(2)
  v_mfma_f32_32x32x16_bf16 v[52:67], v[16:19], v[12:15], v[36:51]
  ds_read_b128 v[16:19], v3 offset:6144
  buffer_load_dwordx4 v[188:191], v1, s[16:19], s55 offen offset:1024 sc1
  v_exp_f32 v68, v68
  v_exp_f32 v69, v69
  v_exp_f32 v70, v70
  v_exp_f32 v71, v71
  s_waitcnt vmcnt(12)
  v_mfma_f32_32x32x16_bf16 v[116:131], v[204:207], v[196:199], v[116:131]
  v_cvt_pk_bf16_f32 v28, v68, v69
  v_exp_f32 v72, v72
  v_exp_f32 v73, v73
  v_cvt_pk_bf16_f32 v29, v70, v71
  s_waitcnt lgkmcnt(2)
  v_mfma_f32_32x32x16_bf16 v[84:99], v[24:27], v[32:35], v[84:99]
  v_exp_f32 v74, v74
  v_exp_f32 v75, v75
  v_cvt_pk_bf16_f32 v30, v72, v73
  v_exp_f32 v76, v76
  v_exp_f32 v77, v77
  v_cvt_pk_bf16_f32 v31, v74, v75
  v_exp_f32 v78, v78
  v_exp_f32 v79, v79
  s_waitcnt lgkmcnt(1)
  v_mfma_f32_32x32x16_bf16 v[84:99], v[20:23], v[28:31], v[84:99]
  s_mov_b64 exec, s[94:95]
  ds_read_b128 v[24:27], v5 offset:2560
  ds_read_b128 v[20:23], v5 offset:4096
  s_mov_b64 exec, -1
  s_add_u32 s54, s8, 13312
  buffer_load_dwordx4 v[192:195], v1, s[16:19], s54 offen sc1
  v_cvt_pk_bf16_f32 v32, v76, v77
  v_exp_f32 v80, v80
  v_exp_f32 v81, v81
  v_cvt_pk_bf16_f32 v33, v78, v79
  v_exp_f32 v82, v82
  v_exp_f32 v83, v83
  v_cvt_pk_bf16_f32 v34, v80, v81
  v_cvt_pk_bf16_f32 v35, v82, v83
  s_waitcnt lgkmcnt(2)
  v_mfma_f32_32x32x16_bf16 v[68:83], v[16:19], v[12:15], v[36:51]
  ds_read_b128 v[16:19], v3 offset:8192
  s_add_u32 s55, s9, 212992
  buffer_load_dwordx4 v[196:199], v1, s[16:19], s55 offen offset:0 sc1
  buffer_load_dwordx4 v[200:203], v1, s[16:19], s55 offen offset:1024 sc1
  v_exp_f32 v52, v52
  v_exp_f32 v53, v53
  v_exp_f32 v54, v54
  v_exp_f32 v55, v55
  s_waitcnt vmcnt(13)
  v_mfma_f32_32x32x16_bf16 v[100:115], v[212:215], v[208:211], v[100:115]
  v_cvt_pk_bf16_f32 v28, v52, v53
  v_exp_f32 v56, v56
  v_exp_f32 v57, v57
  v_cvt_pk_bf16_f32 v29, v54, v55
  s_waitcnt lgkmcnt(2)
  v_mfma_f32_32x32x16_bf16 v[84:99], v[24:27], v[32:35], v[84:99]
  v_exp_f32 v58, v58
  v_exp_f32 v59, v59
  v_cvt_pk_bf16_f32 v30, v56, v57
  v_exp_f32 v60, v60
  v_exp_f32 v61, v61
  v_cvt_pk_bf16_f32 v31, v58, v59
  v_exp_f32 v62, v62
  v_exp_f32 v63, v63
  s_waitcnt lgkmcnt(1)
  v_mfma_f32_32x32x16_bf16 v[84:99], v[20:23], v[28:31], v[84:99]
  s_mov_b64 exec, s[94:95]
  ds_read_b128 v[24:27], v5 offset:4608
  ds_read_b128 v[20:23], v5 offset:6144
  s_mov_b64 exec, -1
  s_add_u32 s54, s8, 14336
  buffer_load_dwordx4 v[204:207], v1, s[16:19], s54 offen sc1
  v_cvt_pk_bf16_f32 v32, v60, v61
  v_exp_f32 v64, v64
  v_exp_f32 v65, v65
  v_cvt_pk_bf16_f32 v33, v62, v63
  s_waitcnt vmcnt(13)
  v_mfma_f32_32x32x16_bf16 v[116:131], v[216:219], v[208:211], v[116:131]
  v_exp_f32 v66, v66
  v_exp_f32 v67, v67
  v_cvt_pk_bf16_f32 v34, v64, v65
  v_cvt_pk_bf16_f32 v35, v66, v67
  s_waitcnt lgkmcnt(2)
  v_mfma_f32_32x32x16_bf16 v[52:67], v[16:19], v[12:15], v[36:51]
  ds_read_b128 v[16:19], v3 offset:10240
  s_add_u32 s55, s9, 229376
  buffer_load_dwordx4 v[208:211], v1, s[16:19], s55 offen offset:0 sc1
  v_exp_f32 v68, v68
  v_exp_f32 v69, v69
  v_exp_f32 v70, v70
  v_exp_f32 v71, v71
  s_waitcnt vmcnt(12)
  v_mfma_f32_32x32x16_bf16 v[100:115], v[224:227], v[220:223], v[100:115]
  v_cvt_pk_bf16_f32 v28, v68, v69
  v_exp_f32 v72, v72
  v_exp_f32 v73, v73
  v_cvt_pk_bf16_f32 v29, v70, v71
  s_waitcnt lgkmcnt(2)
  v_mfma_f32_32x32x16_bf16 v[84:99], v[24:27], v[32:35], v[84:99]
  v_exp_f32 v74, v74
  v_exp_f32 v75, v75
  v_cvt_pk_bf16_f32 v30, v72, v73
  v_exp_f32 v76, v76
  v_exp_f32 v77, v77
  v_cvt_pk_bf16_f32 v31, v74, v75
  v_exp_f32 v78, v78
  v_exp_f32 v79, v79
  s_waitcnt lgkmcnt(1)
  v_mfma_f32_32x32x16_bf16 v[84:99], v[20:23], v[28:31], v[84:99]
  s_mov_b64 exec, s[94:95]
  ds_read_b128 v[24:27], v5 offset:6656
  ds_read_b128 v[20:23], v5 offset:8192
  s_mov_b64 exec, -1
  buffer_load_dwordx4 v[212:215], v1, s[16:19], s55 offen offset:1024 sc1
  v_cvt_pk_bf16_f32 v32, v76, v77
  v_exp_f32 v80, v80
  v_exp_f32 v81, v81
  v_cvt_pk_bf16_f32 v33, v78, v79
  s_waitcnt vmcnt(12)
  v_mfma_f32_32x32x16_bf16 v[116:131], v[164:167], v[220:223], v[116:131]
  v_exp_f32 v82, v82
  v_exp_f32 v83, v83
  v_cvt_pk_bf16_f32 v34, v80, v81
  v_cvt_pk_bf16_f32 v35, v82, v83
  s_waitcnt lgkmcnt(2)
  v_mfma_f32_32x32x16_bf16 v[68:83], v[16:19], v[12:15], v[36:51]
  ds_read_b128 v[16:19], v3 offset:12288
  s_add_u32 s54, s8, 15360
  buffer_load_dwordx4 v[216:219], v1, s[16:19], s54 offen sc1
  v_exp_f32 v52, v52
  v_exp_f32 v53, v53
  v_exp_f32 v54, v54
  v_exp_f32 v55, v55
  v_cvt_pk_bf16_f32 v28, v52, v53
  v_exp_f32 v56, v56
  v_exp_f32 v57, v57
  v_cvt_pk_bf16_f32 v29, v54, v55
  s_waitcnt lgkmcnt(2)
  v_mfma_f32_32x32x16_bf16 v[84:99], v[24:27], v[32:35], v[84:99]
  v_exp_f32 v58, v58
  v_exp_f32 v59, v59
  v_cvt_pk_bf16_f32 v30, v56, v57
  v_exp_f32 v60, v60
  v_exp_f32 v61, v61
  v_cvt_pk_bf16_f32 v31, v58, v59
  v_exp_f32 v62, v62
  v_exp_f32 v63, v63
  s_waitcnt lgkmcnt(1)
  v_mfma_f32_32x32x16_bf16 v[84:99], v[20:23], v[28:31], v[84:99]
  s_mov_b64 exec, s[94:95]
  ds_read_b128 v[24:27], v5 offset:8704
  ds_read_b128 v[20:23], v5 offset:10240
  s_mov_b64 exec, -1
  s_add_u32 s55, s9, 245760
  buffer_load_dwordx4 v[220:223], v1, s[16:19], s55 offen offset:0 sc1
  v_cvt_pk_bf16_f32 v32, v60, v61
  v_exp_f32 v64, v64
  v_exp_f32 v65, v65
  v_cvt_pk_bf16_f32 v33, v62, v63
  s_waitcnt vmcnt(12)
  v_mfma_f32_32x32x16_bf16 v[100:115], v[172:175], v[168:171], v[100:115]
  v_exp_f32 v66, v66
  v_exp_f32 v67, v67
  v_cvt_pk_bf16_f32 v34, v64, v65
  v_cvt_pk_bf16_f32 v35, v66, v67
  s_waitcnt lgkmcnt(2)
  v_mfma_f32_32x32x16_bf16 v[52:67], v[16:19], v[12:15], v[36:51]
  ds_read_b128 v[16:19], v3 offset:14336
  buffer_load_dwordx4 v[224:227], v1, s[16:19], s55 offen offset:1024 sc1
  v_exp_f32 v68, v68
  v_exp_f32 v69, v69
  v_exp_f32 v70, v70
  v_exp_f32 v71, v71
  s_waitcnt vmcnt(12)
  v_mfma_f32_32x32x16_bf16 v[116:131], v[176:179], v[168:171], v[116:131]
  v_cvt_pk_bf16_f32 v28, v68, v69
  v_exp_f32 v72, v72
  v_exp_f32 v73, v73
  v_cvt_pk_bf16_f32 v29, v70, v71
  s_waitcnt lgkmcnt(2)
  v_mfma_f32_32x32x16_bf16 v[84:99], v[24:27], v[32:35], v[84:99]
  v_exp_f32 v74, v74
  v_exp_f32 v75, v75
  v_cvt_pk_bf16_f32 v30, v72, v73
  v_exp_f32 v76, v76
  v_exp_f32 v77, v77
  v_cvt_pk_bf16_f32 v31, v74, v75
  v_exp_f32 v78, v78
  v_exp_f32 v79, v79
  s_waitcnt lgkmcnt(1)
  v_mfma_f32_32x32x16_bf16 v[84:99], v[20:23], v[28:31], v[84:99]
  s_mov_b64 exec, s[94:95]
  ds_read_b128 v[24:27], v5 offset:10752
  ds_read_b128 v[20:23], v5 offset:12288
  s_mov_b64 exec, -1
  s_add_u32 s54, s8, 16384
  buffer_load_dwordx4 v[164:167], v1, s[16:19], s54 offen sc1
  v_cvt_pk_bf16_f32 v32, v76, v77
  v_exp_f32 v80, v80
  v_exp_f32 v81, v81
  v_cvt_pk_bf16_f32 v33, v78, v79
  v_exp_f32 v82, v82
  v_exp_f32 v83, v83
  v_cvt_pk_bf16_f32 v34, v80, v81
  v_cvt_pk_bf16_f32 v35, v82, v83
  s_waitcnt lgkmcnt(2)
  v_mfma_f32_32x32x16_bf16 v[68:83], v[16:19], v[12:15], v[36:51]
  ds_read_b128 v[16:19], v3 offset:16384
  s_add_u32 s55, s9, 262144
  buffer_load_dwordx4 v[168:171], v1, s[16:19], s55 offen offset:0 sc1
  v_exp_f32 v52, v52
  v_exp_f32 v53, v53
  v_exp_f32 v54, v54
  v_exp_f32 v55, v55
  s_waitcnt vmcnt(12)
  v_mfma_f32_32x32x16_bf16 v[100:115], v[184:187], v[180:183], v[100:115]
  v_cvt_pk_bf16_f32 v28, v52, v53
  v_exp_f32 v56, v56
  v_exp_f32 v57, v57
  v_cvt_pk_bf16_f32 v29, v54, v55
  s_waitcnt lgkmcnt(2)
  v_mfma_f32_32x32x16_bf16 v[84:99], v[24:27], v[32:35], v[84:99]
  v_exp_f32 v58, v58
  v_exp_f32 v59, v59
  v_cvt_pk_bf16_f32 v30, v56, v57
  v_exp_f32 v60, v60
  v_exp_f32 v61, v61
  v_cvt_pk_bf16_f32 v31, v58, v59
  v_exp_f32 v62, v62
  v_exp_f32 v63, v63
  s_waitcnt lgkmcnt(1)
  v_mfma_f32_32x32x16_bf16 v[84:99], v[20:23], v[28:31], v[84:99]
  s_mov_b64 exec, s[94:95]
  ds_read_b128 v[24:27], v5 offset:12800
  ds_read_b128 v[20:23], v5 offset:14336
  s_mov_b64 exec, -1
  buffer_load_dwordx4 v[172:175], v1, s[16:19], s55 offen offset:1024 sc1
  s_add_u32 s54, s8, 17408
  buffer_load_dwordx4 v[176:179], v1, s[16:19], s54 offen sc1
  v_cvt_pk_bf16_f32 v32, v60, v61
  v_exp_f32 v64, v64
  v_exp_f32 v65, v65
  v_cvt_pk_bf16_f32 v33, v62, v63
  s_waitcnt vmcnt(13)
  v_mfma_f32_32x32x16_bf16 v[116:131], v[188:191], v[180:183], v[116:131]
  v_exp_f32 v66, v66
  v_exp_f32 v67, v67
  v_cvt_pk_bf16_f32 v34, v64, v65
  v_cvt_pk_bf16_f32 v35, v66, v67
  s_waitcnt lgkmcnt(2)
  v_mfma_f32_32x32x16_bf16 v[52:67], v[16:19], v[12:15], v[36:51]
  ds_read_b128 v[16:19], v3 offset:18432
  s_add_u32 s55, s9, 278528
  buffer_load_dwordx4 v[180:183], v1, s[16:19], s55 offen offset:0 sc1
  v_exp_f32 v68, v68
  v_exp_f32 v69, v69
  v_exp_f32 v70, v70
  v_exp_f32 v71, v71
  v_cvt_pk_bf16_f32 v28, v68, v69
  v_exp_f32 v72, v72
  v_exp_f32 v73, v73
  v_cvt_pk_bf16_f32 v29, v70, v71
  s_waitcnt lgkmcnt(2)
  v_mfma_f32_32x32x16_bf16 v[84:99], v[24:27], v[32:35], v[84:99]
  v_exp_f32 v74, v74
  v_exp_f32 v75, v75
  v_cvt_pk_bf16_f32 v30, v72, v73
  v_exp_f32 v76, v76
  v_exp_f32 v77, v77
  v_cvt_pk_bf16_f32 v31, v74, v75
  v_exp_f32 v78, v78
  v_exp_f32 v79, v79
  s_waitcnt lgkmcnt(1)
  v_mfma_f32_32x32x16_bf16 v[84:99], v[20:23], v[28:31], v[84:99]
  s_mov_b64 exec, s[94:95]
  ds_read_b128 v[24:27], v5 offset:14848
  ds_read_b128 v[20:23], v5 offset:16384
  s_mov_b64 exec, -1
  buffer_load_dwordx4 v[184:187], v1, s[16:19], s55 offen offset:1024 sc1
  v_cvt_pk_bf16_f32 v32, v76, v77
  v_exp_f32 v80, v80
  v_exp_f32 v81, v81
  v_cvt_pk_bf16_f32 v33, v78, v79
  s_waitcnt vmcnt(13)
  v_mfma_f32_32x32x16_bf16 v[100:115], v[196:199], v[192:195], v[100:115]
  s_waitcnt vmcnt(12)
  v_mfma_f32_32x32x16_bf16 v[116:131], v[200:203], v[192:195], v[116:131]
  v_exp_f32 v82, v82
  v_exp_f32 v83, v83
  v_cvt_pk_bf16_f32 v34, v80, v81
  v_cvt_pk_bf16_f32 v35, v82, v83
  s_waitcnt lgkmcnt(2)
  v_mfma_f32_32x32x16_bf16 v[68:83], v[16:19], v[12:15], v[36:51]
  ds_read_b128 v[16:19], v3 offset:20480
  s_add_u32 s54, s8, 18432
  buffer_load_dwordx4 v[188:191], v1, s[16:19], s54 offen sc1
  v_exp_f32 v52, v52
  v_exp_f32 v53, v53
  v_exp_f32 v54, v54
  v_exp_f32 v55, v55
  v_cvt_pk_bf16_f32 v28, v52, v53
  v_exp_f32 v56, v56
  v_exp_f32 v57, v57
  v_cvt_pk_bf16_f32 v29, v54, v55
  s_waitcnt lgkmcnt(2)
  v_mfma_f32_32x32x16_bf16 v[84:99], v[24:27], v[32:35], v[84:99]
  v_exp_f32 v58, v58
  v_exp_f32 v59, v59
  v_cvt_pk_bf16_f32 v30, v56, v57
  v_exp_f32 v60, v60
  v_exp_f32 v61, v61
  v_cvt_pk_bf16_f32 v31, v58, v59
  v_exp_f32 v62, v62
  v_exp_f32 v63, v63
  s_waitcnt lgkmcnt(1)
  v_mfma_f32_32x32x16_bf16 v[84:99], v[20:23], v[28:31], v[84:99]
  s_mov_b64 exec, s[94:95]
  ds_read_b128 v[24:27], v5 offset:16896
  ds_read_b128 v[20:23], v5 offset:18432
  s_mov_b64 exec, -1
  s_add_u32 s55, s9, 294912
  buffer_load_dwordx4 v[192:195], v1, s[16:19], s55 offen offset:0 sc1
  v_cvt_pk_bf16_f32 v32, v60, v61
  v_exp_f32 v64, v64
  v_exp_f32 v65, v65
  v_cvt_pk_bf16_f32 v33, v62, v63
  s_waitcnt vmcnt(12)
  v_mfma_f32_32x32x16_bf16 v[100:115], v[208:211], v[204:207], v[100:115]
  v_exp_f32 v66, v66
  v_exp_f32 v67, v67
  v_cvt_pk_bf16_f32 v34, v64, v65
  v_cvt_pk_bf16_f32 v35, v66, v67
  s_waitcnt lgkmcnt(2)
  v_mfma_f32_32x32x16_bf16 v[52:67], v[16:19], v[12:15], v[36:51]
  ds_read_b128 v[16:19], v3 offset:22528
  buffer_load_dwordx4 v[196:199], v1, s[16:19], s55 offen offset:1024 sc1
  v_exp_f32 v68, v68
  v_exp_f32 v69, v69
  v_exp_f32 v70, v70
  v_exp_f32 v71, v71
  s_waitcnt vmcnt(12)
  v_mfma_f32_32x32x16_bf16 v[116:131], v[212:215], v[204:207], v[116:131]
  v_cvt_pk_bf16_f32 v28, v68, v69
  v_exp_f32 v72, v72
  v_exp_f32 v73, v73
  v_cvt_pk_bf16_f32 v29, v70, v71
  s_waitcnt lgkmcnt(2)
  v_mfma_f32_32x32x16_bf16 v[84:99], v[24:27], v[32:35], v[84:99]
  v_exp_f32 v74, v74
  v_exp_f32 v75, v75
  v_cvt_pk_bf16_f32 v30, v72, v73
  v_exp_f32 v76, v76
  v_exp_f32 v77, v77
  v_cvt_pk_bf16_f32 v31, v74, v75
  v_exp_f32 v78, v78
  v_exp_f32 v79, v79
  s_waitcnt lgkmcnt(1)
  v_mfma_f32_32x32x16_bf16 v[84:99], v[20:23], v[28:31], v[84:99]
  s_mov_b64 exec, s[94:95]
  ds_read_b128 v[24:27], v5 offset:18944
  ds_read_b128 v[20:23], v5 offset:20480
  s_mov_b64 exec, -1
  s_add_u32 s54, s8, 19456
  buffer_load_dwordx4 v[200:203], v1, s[16:19], s54 offen sc1
  v_cvt_pk_bf16_f32 v32, v76, v77
  v_exp_f32 v80, v80
  v_exp_f32 v81, v81
  v_cvt_pk_bf16_f32 v33, v78, v79
  v_exp_f32 v82, v82
  v_exp_f32 v83, v83
  v_cvt_pk_bf16_f32 v34, v80, v81
  v_cvt_pk_bf16_f32 v35, v82, v83
  s_waitcnt lgkmcnt(2)
  v_mfma_f32_32x32x16_bf16 v[68:83], v[16:19], v[12:15], v[36:51]
  ds_read_b128 v[16:19], v3 offset:24576
  s_add_u32 s55, s9, 311296
  buffer_load_dwordx4 v[204:207], v1, s[16:19], s55 offen offset:0 sc1
  v_exp_f32 v52, v52
  v_exp_f32 v53, v53
  v_exp_f32 v54, v54
  v_exp_f32 v55, v55
  s_waitcnt vmcnt(12)
  v_mfma_f32_32x32x16_bf16 v[100:115], v[220:223], v[216:219], v[100:115]
  v_cvt_pk_bf16_f32 v28, v52, v53
  v_exp_f32 v56, v56
  v_exp_f32 v57, v57
  v_cvt_pk_bf16_f32 v29, v54, v55
  s_waitcnt lgkmcnt(2)
  v_mfma_f32_32x32x16_bf16 v[84:99], v[24:27], v[32:35], v[84:99]
  v_exp_f32 v58, v58
  v_exp_f32 v59, v59
  v_cvt_pk_bf16_f32 v30, v56, v57
  v_exp_f32 v60, v60
  v_exp_f32 v61, v61
  v_cvt_pk_bf16_f32 v31, v58, v59
  v_exp_f32 v62, v62
  v_exp_f32 v63, v63
  s_waitcnt lgkmcnt(1)
  v_mfma_f32_32x32x16_bf16 v[84:99], v[20:23], v[28:31], v[84:99]
  s_mov_b64 exec, s[94:95]
  ds_read_b128 v[24:27], v5 offset:20992
  ds_read_b128 v[20:23], v5 offset:22528
  s_mov_b64 exec, -1
  buffer_load_dwordx4 v[208:211], v1, s[16:19], s55 offen offset:1024 sc1
  v_cvt_pk_bf16_f32 v32, v60, v61
  v_exp_f32 v64, v64
  v_exp_f32 v65, v65
  v_cvt_pk_bf16_f32 v33, v62, v63
  s_waitcnt vmcnt(12)
  v_mfma_f32_32x32x16_bf16 v[116:131], v[224:227], v[216:219], v[116:131]
  v_exp_f32 v66, v66
  v_exp_f32 v67, v67
  v_cvt_pk_bf16_f32 v34, v64, v65
  v_cvt_pk_bf16_f32 v35, v66, v67
  s_waitcnt lgkmcnt(2)
  v_mfma_f32_32x32x16_bf16 v[52:67], v[16:19], v[12:15], v[36:51]
  ds_read_b128 v[16:19], v3 offset:26624
  s_add_u32 s54, s8, 20480
  buffer_load_dwordx4 v[212:215], v1, s[16:19], s54 offen sc1
  s_add_u32 s55, s9, 327680
  buffer_load_dwordx4 v[216:219], v1, s[16:19], s55 offen offset:0 sc1
  v_exp_f32 v68, v68
  v_exp_f32 v69, v69
  v_exp_f32 v70, v70
  v_exp_f32 v71, v71
  v_cvt_pk_bf16_f32 v28, v68, v69
  v_exp_f32 v72, v72
  v_exp_f32 v73, v73
  v_cvt_pk_bf16_f32 v29, v70, v71
  s_waitcnt lgkmcnt(2)
  v_mfma_f32_32x32x16_bf16 v[84:99], v[24:27], v[32:35], v[84:99]
  v_exp_f32 v74, v74
  v_exp_f32 v75, v75
  v_cvt_pk_bf16_f32 v30, v72, v73
  v_exp_f32 v76, v76
  v_exp_f32 v77, v77
  v_cvt_pk_bf16_f32 v31, v74, v75
  v_exp_f32 v78, v78
  v_exp_f32 v79, v79
  s_waitcnt lgkmcnt(1)
  v_mfma_f32_32x32x16_bf16 v[84:99], v[20:23], v[28:31], v[84:99]
  s_mov_b64 exec, s[94:95]
  ds_read_b128 v[24:27], v5 offset:23040
  ds_read_b128 v[20:23], v5 offset:24576
  s_mov_b64 exec, -1
  buffer_load_dwordx4 v[220:223], v1, s[16:19], s55 offen offset:1024 sc1
  v_cvt_pk_bf16_f32 v32, v76, v77
  v_exp_f32 v80, v80
  v_exp_f32 v81, v81
  v_cvt_pk_bf16_f32 v33, v78, v79
  s_waitcnt vmcnt(13)
  v_mfma_f32_32x32x16_bf16 v[100:115], v[168:171], v[164:167], v[100:115]
  v_exp_f32 v82, v82
  v_exp_f32 v83, v83
  v_cvt_pk_bf16_f32 v34, v80, v81
  v_cvt_pk_bf16_f32 v35, v82, v83
  s_waitcnt lgkmcnt(2)
  v_mfma_f32_32x32x16_bf16 v[68:83], v[16:19], v[12:15], v[36:51]
  ds_read_b128 v[16:19], v3 offset:28672
  s_add_u32 s54, s8, 21504
  buffer_load_dwordx4 v[224:227], v1, s[16:19], s54 offen sc1
  v_exp_f32 v52, v52
  v_exp_f32 v53, v53
  v_exp_f32 v54, v54
  v_exp_f32 v55, v55
  s_waitcnt vmcnt(13)
  v_mfma_f32_32x32x16_bf16 v[116:131], v[172:175], v[164:167], v[116:131]
  v_cvt_pk_bf16_f32 v28, v52, v53
  v_exp_f32 v56, v56
  v_exp_f32 v57, v57
  v_cvt_pk_bf16_f32 v29, v54, v55
  s_waitcnt lgkmcnt(2)
  v_mfma_f32_32x32x16_bf16 v[84:99], v[24:27], v[32:35], v[84:99]
  v_exp_f32 v58, v58
  v_exp_f32 v59, v59
  v_cvt_pk_bf16_f32 v30, v56, v57
  v_exp_f32 v60, v60
  v_exp_f32 v61, v61
  v_cvt_pk_bf16_f32 v31, v58, v59
  v_exp_f32 v62, v62
  v_exp_f32 v63, v63
  s_waitcnt lgkmcnt(1)
  v_mfma_f32_32x32x16_bf16 v[84:99], v[20:23], v[28:31], v[84:99]
  s_mov_b64 exec, s[94:95]
  ds_read_b128 v[24:27], v5 offset:25088
  ds_read_b128 v[20:23], v5 offset:26624
  s_mov_b64 exec, -1
  s_add_u32 s55, s9, 344064
  buffer_load_dwordx4 v[164:167], v1, s[16:19], s55 offen offset:0 sc1
  v_cvt_pk_bf16_f32 v32, v60, v61
  v_exp_f32 v64, v64
  v_exp_f32 v65, v65
  v_cvt_pk_bf16_f32 v33, v62, v63
  s_waitcnt vmcnt(12)
  v_mfma_f32_32x32x16_bf16 v[100:115], v[180:183], v[176:179], v[100:115]
  v_exp_f32 v66, v66
  v_exp_f32 v67, v67
  v_cvt_pk_bf16_f32 v34, v64, v65
  v_cvt_pk_bf16_f32 v35, v66, v67
  s_waitcnt lgkmcnt(2)
  v_mfma_f32_32x32x16_bf16 v[52:67], v[16:19], v[12:15], v[36:51]
  ds_read_b128 v[16:19], v3 offset:30720
  buffer_load_dwordx4 v[168:171], v1, s[16:19], s55 offen offset:1024 sc1
  v_exp_f32 v68, v68
  v_exp_f32 v69, v69
  v_exp_f32 v70, v70
  v_exp_f32 v71, v71
  s_waitcnt vmcnt(12)
  v_mfma_f32_32x32x16_bf16 v[116:131], v[184:187], v[176:179], v[116:131]
  v_cvt_pk_bf16_f32 v28, v68, v69
  v_exp_f32 v72, v72
  v_exp_f32 v73, v73
  v_cvt_pk_bf16_f32 v29, v70, v71
  s_waitcnt lgkmcnt(2)
  v_mfma_f32_32x32x16_bf16 v[84:99], v[24:27], v[32:35], v[84:99]
  v_exp_f32 v74, v74
  v_exp_f32 v75, v75
  v_cvt_pk_bf16_f32 v30, v72, v73
  v_exp_f32 v76, v76
  v_exp_f32 v77, v77
  v_cvt_pk_bf16_f32 v31, v74, v75
  v_exp_f32 v78, v78
  v_exp_f32 v79, v79
  s_waitcnt lgkmcnt(1)
  v_mfma_f32_32x32x16_bf16 v[84:99], v[20:23], v[28:31], v[84:99]
  s_mov_b64 exec, s[94:95]
  ds_read_b128 v[24:27], v5 offset:27136
  ds_read_b128 v[20:23], v5 offset:28672
  s_mov_b64 exec, -1
  s_add_u32 s54, s8, 22528
  buffer_load_dwordx4 v[172:175], v1, s[16:19], s54 offen sc1
  v_cvt_pk_bf16_f32 v32, v76, v77
  v_exp_f32 v80, v80
  v_exp_f32 v81, v81
  v_cvt_pk_bf16_f32 v33, v78, v79
  v_exp_f32 v82, v82
  v_exp_f32 v83, v83
  v_cvt_pk_bf16_f32 v34, v80, v81
  v_cvt_pk_bf16_f32 v35, v82, v83
  s_waitcnt lgkmcnt(2)
  v_mfma_f32_32x32x16_bf16 v[68:83], v[16:19], v[12:15], v[36:51]
  ds_read_b128 v[16:19], v3 offset:32768
  s_add_u32 s55, s9, 360448
  buffer_load_dwordx4 v[176:179], v1, s[16:19], s55 offen offset:0 sc1
  v_exp_f32 v52, v52
  v_exp_f32 v53, v53
  v_exp_f32 v54, v54
  v_exp_f32 v55, v55
  s_waitcnt vmcnt(12)
  v_mfma_f32_32x32x16_bf16 v[100:115], v[192:195], v[188:191], v[100:115]
  v_cvt_pk_bf16_f32 v28, v52, v53
  v_exp_f32 v56, v56
  v_exp_f32 v57, v57
  v_cvt_pk_bf16_f32 v29, v54, v55
  s_waitcnt lgkmcnt(2)
  v_mfma_f32_32x32x16_bf16 v[84:99], v[24:27], v[32:35], v[84:99]
  v_exp_f32 v58, v58
  v_exp_f32 v59, v59
  v_cvt_pk_bf16_f32 v30, v56, v57
  v_exp_f32 v60, v60
  v_exp_f32 v61, v61
  v_cvt_pk_bf16_f32 v31, v58, v59
  v_exp_f32 v62, v62
  v_exp_f32 v63, v63
  s_waitcnt lgkmcnt(1)
  v_mfma_f32_32x32x16_bf16 v[84:99], v[20:23], v[28:31], v[84:99]
  s_mov_b64 exec, s[94:95]
  ds_read_b128 v[24:27], v5 offset:29184
  ds_read_b128 v[20:23], v5 offset:30720
  s_mov_b64 exec, -1
  buffer_load_dwordx4 v[180:183], v1, s[16:19], s55 offen offset:1024 sc1
  v_cvt_pk_bf16_f32 v32, v60, v61
  v_exp_f32 v64, v64
  v_exp_f32 v65, v65
  v_cvt_pk_bf16_f32 v33, v62, v63
  s_waitcnt vmcnt(12)
  v_mfma_f32_32x32x16_bf16 v[116:131], v[196:199], v[188:191], v[116:131]
  v_exp_f32 v66, v66
  v_exp_f32 v67, v67
  v_cvt_pk_bf16_f32 v34, v64, v65
  v_cvt_pk_bf16_f32 v35, v66, v67
  s_waitcnt lgkmcnt(2)
  v_mfma_f32_32x32x16_bf16 v[52:67], v[16:19], v[12:15], v[36:51]
  ds_read_b128 v[16:19], v3 offset:34816
  s_add_u32 s54, s8, 23552
  buffer_load_dwordx4 v[184:187], v1, s[16:19], s54 offen sc1
  v_exp_f32 v68, v68
  v_exp_f32 v69, v69
  v_exp_f32 v70, v70
  v_exp_f32 v71, v71
  v_cvt_pk_bf16_f32 v28, v68, v69
  v_exp_f32 v72, v72
  v_exp_f32 v73, v73
  v_cvt_pk_bf16_f32 v29, v70, v71
  s_waitcnt lgkmcnt(2)
  v_mfma_f32_32x32x16_bf16 v[84:99], v[24:27], v[32:35], v[84:99]
  v_exp_f32 v74, v74
  v_exp_f32 v75, v75
  v_cvt_pk_bf16_f32 v30, v72, v73
  v_exp_f32 v76, v76
  v_exp_f32 v77, v77
  v_cvt_pk_bf16_f32 v31, v74, v75
  v_exp_f32 v78, v78
  v_exp_f32 v79, v79
  s_waitcnt lgkmcnt(1)
  v_mfma_f32_32x32x16_bf16 v[84:99], v[20:23], v[28:31], v[84:99]
  s_mov_b64 exec, s[94:95]
  ds_read_b128 v[24:27], v5 offset:31232
  ds_read_b128 v[20:23], v5 offset:32768
  s_mov_b64 exec, -1
  s_add_u32 s55, s9, 376832
  buffer_load_dwordx4 v[188:191], v1, s[16:19], s55 offen offset:0 sc1
  buffer_load_dwordx4 v[192:195], v1, s[16:19], s55 offen offset:1024 sc1
  v_cvt_pk_bf16_f32 v32, v76, v77
  v_exp_f32 v80, v80
  v_exp_f32 v81, v81
  v_cvt_pk_bf16_f32 v33, v78, v79
  s_waitcnt vmcnt(13)
  v_mfma_f32_32x32x16_bf16 v[100:115], v[204:207], v[200:203], v[100:115]
  v_exp_f32 v82, v82
  v_exp_f32 v83, v83
  v_cvt_pk_bf16_f32 v34, v80, v81
  v_cvt_pk_bf16_f32 v35, v82, v83
  s_waitcnt lgkmcnt(2)
  v_mfma_f32_32x32x16_bf16 v[68:83], v[16:19], v[12:15], v[36:51]
  ds_read_b128 v[16:19], v3 offset:36864
  s_add_u32 s54, s8, 24576
  buffer_load_dwordx4 v[196:199], v1, s[16:19], s54 offen sc1
  v_exp_f32 v52, v52
  v_exp_f32 v53, v53
  v_exp_f32 v54, v54
  v_exp_f32 v55, v55
  s_waitcnt vmcnt(13)
  v_mfma_f32_32x32x16_bf16 v[116:131], v[208:211], v[200:203], v[116:131]
  v_cvt_pk_bf16_f32 v28, v52, v53
  v_exp_f32 v56, v56
  v_exp_f32 v57, v57
  v_cvt_pk_bf16_f32 v29, v54, v55
  s_waitcnt lgkmcnt(2)
  v_mfma_f32_32x32x16_bf16 v[84:99], v[24:27], v[32:35], v[84:99]
  v_exp_f32 v58, v58
  v_exp_f32 v59, v59
  v_cvt_pk_bf16_f32 v30, v56, v57
  v_exp_f32 v60, v60
  v_exp_f32 v61, v61
  v_cvt_pk_bf16_f32 v31, v58, v59
  v_exp_f32 v62, v62
  v_exp_f32 v63, v63
  s_waitcnt lgkmcnt(1)
  v_mfma_f32_32x32x16_bf16 v[84:99], v[20:23], v[28:31], v[84:99]
  s_mov_b64 exec, s[94:95]
  ds_read_b128 v[24:27], v5 offset:33280
  ds_read_b128 v[20:23], v5 offset:34816
  s_mov_b64 exec, -1
  s_add_u32 s55, s9, 393216
  buffer_load_dwordx4 v[200:203], v1, s[16:19], s55 offen offset:0 sc1
  v_cvt_pk_bf16_f32 v32, v60, v61
  v_exp_f32 v64, v64
  v_exp_f32 v65, v65
  v_cvt_pk_bf16_f32 v33, v62, v63
  s_waitcnt vmcnt(12)
  v_mfma_f32_32x32x16_bf16 v[100:115], v[216:219], v[212:215], v[100:115]
  v_exp_f32 v66, v66
  v_exp_f32 v67, v67
  v_cvt_pk_bf16_f32 v34, v64, v65
  v_cvt_pk_bf16_f32 v35, v66, v67
  s_waitcnt lgkmcnt(2)
  v_mfma_f32_32x32x16_bf16 v[52:67], v[16:19], v[12:15], v[36:51]
  ds_read_b128 v[16:19], v3 offset:38912
  buffer_load_dwordx4 v[204:207], v1, s[16:19], s55 offen offset:1024 sc1
  v_exp_f32 v68, v68
  v_exp_f32 v69, v69
  v_exp_f32 v70, v70
  v_exp_f32 v71, v71
  s_waitcnt vmcnt(12)
  v_mfma_f32_32x32x16_bf16 v[116:131], v[220:223], v[212:215], v[116:131]
  v_cvt_pk_bf16_f32 v28, v68, v69
  v_exp_f32 v72, v72
  v_exp_f32 v73, v73
  v_cvt_pk_bf16_f32 v29, v70, v71
  s_waitcnt lgkmcnt(2)
  v_mfma_f32_32x32x16_bf16 v[84:99], v[24:27], v[32:35], v[84:99]
  v_exp_f32 v74, v74
  v_exp_f32 v75, v75
  v_cvt_pk_bf16_f32 v30, v72, v73
  v_exp_f32 v76, v76
  v_exp_f32 v77, v77
  v_cvt_pk_bf16_f32 v31, v74, v75
  v_exp_f32 v78, v78
  v_exp_f32 v79, v79
  s_waitcnt lgkmcnt(1)
  v_mfma_f32_32x32x16_bf16 v[84:99], v[20:23], v[28:31], v[84:99]
  s_mov_b64 exec, s[94:95]
  ds_read_b128 v[24:27], v5 offset:35328
  ds_read_b128 v[20:23], v5 offset:36864
  s_mov_b64 exec, -1
  s_add_u32 s54, s8, 25600
  buffer_load_dwordx4 v[208:211], v1, s[16:19], s54 offen sc1
  v_cvt_pk_bf16_f32 v32, v76, v77
  v_exp_f32 v80, v80
  v_exp_f32 v81, v81
  v_cvt_pk_bf16_f32 v33, v78, v79
  v_exp_f32 v82, v82
  v_exp_f32 v83, v83
  v_cvt_pk_bf16_f32 v34, v80, v81
  v_cvt_pk_bf16_f32 v35, v82, v83
  s_waitcnt lgkmcnt(2)
  v_mfma_f32_32x32x16_bf16 v[68:83], v[16:19], v[12:15], v[36:51]
  ds_read_b128 v[16:19], v3 offset:40960
  s_add_u32 s55, s9, 409600
  buffer_load_dwordx4 v[212:215], v1, s[16:19], s55 offen offset:0 sc1
  v_exp_f32 v52, v52
  v_exp_f32 v53, v53
  v_exp_f32 v54, v54
  v_exp_f32 v55, v55
  s_waitcnt vmcnt(12)
  v_mfma_f32_32x32x16_bf16 v[100:115], v[164:167], v[224:227], v[100:115]
  v_cvt_pk_bf16_f32 v28, v52, v53
  v_exp_f32 v56, v56
  v_exp_f32 v57, v57
  v_cvt_pk_bf16_f32 v29, v54, v55
  s_waitcnt lgkmcnt(2)
  v_mfma_f32_32x32x16_bf16 v[84:99], v[24:27], v[32:35], v[84:99]
  v_exp_f32 v58, v58
  v_exp_f32 v59, v59
  v_cvt_pk_bf16_f32 v30, v56, v57
  v_exp_f32 v60, v60
  v_exp_f32 v61, v61
  v_cvt_pk_bf16_f32 v31, v58, v59
  v_exp_f32 v62, v62
  v_exp_f32 v63, v63
  s_waitcnt lgkmcnt(1)
  v_mfma_f32_32x32x16_bf16 v[84:99], v[20:23], v[28:31], v[84:99]
  s_mov_b64 exec, s[94:95]
  ds_read_b128 v[24:27], v5 offset:37376
  ds_read_b128 v[20:23], v5 offset:38912
  s_mov_b64 exec, -1
  buffer_load_dwordx4 v[216:219], v1, s[16:19], s55 offen offset:1024 sc1
  v_cvt_pk_bf16_f32 v32, v60, v61
  v_exp_f32 v64, v64
  v_exp_f32 v65, v65
  v_cvt_pk_bf16_f32 v33, v62, v63
  s_waitcnt vmcnt(12)
  v_mfma_f32_32x32x16_bf16 v[116:131], v[168:171], v[224:227], v[116:131]
  v_exp_f32 v66, v66
  v_exp_f32 v67, v67
  v_cvt_pk_bf16_f32 v34, v64, v65
  v_cvt_pk_bf16_f32 v35, v66, v67
  s_waitcnt lgkmcnt(2)
  v_mfma_f32_32x32x16_bf16 v[52:67], v[16:19], v[12:15], v[36:51]
  ds_read_b128 v[16:19], v3 offset:43008
  s_add_u32 s54, s8, 26624
  buffer_load_dwordx4 v[220:223], v1, s[16:19], s54 offen sc1
  v_exp_f32 v68, v68
  v_exp_f32 v69, v69
  v_exp_f32 v70, v70
  v_exp_f32 v71, v71
  v_cvt_pk_bf16_f32 v28, v68, v69
  v_exp_f32 v72, v72
  v_exp_f32 v73, v73
  v_cvt_pk_bf16_f32 v29, v70, v71
  s_waitcnt lgkmcnt(2)
  v_mfma_f32_32x32x16_bf16 v[84:99], v[24:27], v[32:35], v[84:99]
  v_exp_f32 v74, v74
  v_exp_f32 v75, v75
  v_cvt_pk_bf16_f32 v30, v72, v73
  v_exp_f32 v76, v76
  v_exp_f32 v77, v77
  v_cvt_pk_bf16_f32 v31, v74, v75
  v_exp_f32 v78, v78
  v_exp_f32 v79, v79
  s_waitcnt lgkmcnt(1)
  v_mfma_f32_32x32x16_bf16 v[84:99], v[20:23], v[28:31], v[84:99]
  s_mov_b64 exec, s[94:95]
  ds_read_b128 v[24:27], v5 offset:39424
  ds_read_b128 v[20:23], v5 offset:40960
  s_mov_b64 exec, -1
  s_add_u32 s55, s9, 425984
  buffer_load_dwordx4 v[224:227], v1, s[16:19], s55 offen offset:0 sc1
  v_cvt_pk_bf16_f32 v32, v76, v77
  v_exp_f32 v80, v80
  v_exp_f32 v81, v81
  v_cvt_pk_bf16_f32 v33, v78, v79
  s_waitcnt vmcnt(12)
  v_mfma_f32_32x32x16_bf16 v[100:115], v[176:179], v[172:175], v[100:115]
  v_exp_f32 v82, v82
  v_exp_f32 v83, v83
  v_cvt_pk_bf16_f32 v34, v80, v81
  v_cvt_pk_bf16_f32 v35, v82, v83
  s_waitcnt lgkmcnt(2)
  v_mfma_f32_32x32x16_bf16 v[68:83], v[16:19], v[12:15], v[36:51]
  ds_read_b128 v[16:19], v3 offset:45056
  buffer_load_dwordx4 v[164:167], v1, s[16:19], s55 offen offset:1024 sc1
  s_add_u32 s54, s8, 27648
  buffer_load_dwordx4 v[168:171], v1, s[16:19], s54 offen sc1
  v_exp_f32 v52, v52
  v_exp_f32 v53, v53
  v_exp_f32 v54, v54
  v_exp_f32 v55, v55
  s_waitcnt vmcnt(13)
  v_mfma_f32_32x32x16_bf16 v[116:131], v[180:183], v[172:175], v[116:131]
  v_cvt_pk_bf16_f32 v28, v52, v53
  v_exp_f32 v56, v56
  v_exp_f32 v57, v57
  v_cvt_pk_bf16_f32 v29, v54, v55
  s_waitcnt lgkmcnt(2)
  v_mfma_f32_32x32x16_bf16 v[84:99], v[24:27], v[32:35], v[84:99]
  v_exp_f32 v58, v58
  v_exp_f32 v59, v59
  v_cvt_pk_bf16_f32 v30, v56, v57
  v_exp_f32 v60, v60
  v_exp_f32 v61, v61
  v_cvt_pk_bf16_f32 v31, v58, v59
  v_exp_f32 v62, v62
  v_exp_f32 v63, v63
  s_waitcnt lgkmcnt(1)
  v_mfma_f32_32x32x16_bf16 v[84:99], v[20:23], v[28:31], v[84:99]
  s_mov_b64 exec, s[94:95]
  ds_read_b128 v[24:27], v5 offset:41472
  ds_read_b128 v[20:23], v5 offset:43008
  s_mov_b64 exec, -1
  s_add_u32 s55, s9, 442368
  buffer_load_dwordx4 v[172:175], v1, s[16:19], s55 offen offset:0 sc1
  v_cvt_pk_bf16_f32 v32, v60, v61
  v_exp_f32 v64, v64
  v_exp_f32 v65, v65
  v_cvt_pk_bf16_f32 v33, v62, v63
  v_exp_f32 v66, v66
  v_exp_f32 v67, v67
  v_cvt_pk_bf16_f32 v34, v64, v65
  v_cvt_pk_bf16_f32 v35, v66, v67
  s_waitcnt lgkmcnt(2)
  v_mfma_f32_32x32x16_bf16 v[52:67], v[16:19], v[12:15], v[36:51]
  ds_read_b128 v[16:19], v3 offset:47104
  buffer_load_dwordx4 v[176:179], v1, s[16:19], s55 offen offset:1024 sc1
  v_exp_f32 v68, v68
  v_exp_f32 v69, v69
  v_exp_f32 v70, v70
  v_exp_f32 v71, v71
  s_waitcnt vmcnt(13)
  v_mfma_f32_32x32x16_bf16 v[100:115], v[188:191], v[184:187], v[100:115]
  s_waitcnt vmcnt(12)
  v_mfma_f32_32x32x16_bf16 v[116:131], v[192:195], v[184:187], v[116:131]
  v_cvt_pk_bf16_f32 v28, v68, v69
  v_exp_f32 v72, v72
  v_exp_f32 v73, v73
  v_cvt_pk_bf16_f32 v29, v70, v71
  s_waitcnt lgkmcnt(2)
  v_mfma_f32_32x32x16_bf16 v[84:99], v[24:27], v[32:35], v[84:99]
  v_exp_f32 v74, v74
  v_exp_f32 v75, v75
  v_cvt_pk_bf16_f32 v30, v72, v73
  v_exp_f32 v76, v76
  v_exp_f32 v77, v77
  v_cvt_pk_bf16_f32 v31, v74, v75
  v_exp_f32 v78, v78
  v_exp_f32 v79, v79
  s_waitcnt lgkmcnt(1)
  v_mfma_f32_32x32x16_bf16 v[84:99], v[20:23], v[28:31], v[84:99]
  s_mov_b64 exec, s[94:95]
  ds_read_b128 v[24:27], v5 offset:43520
  ds_read_b128 v[20:23], v5 offset:45056
  s_mov_b64 exec, -1
  s_lshl_b32 s54, s45, 2
  s_add_u32 s54, s54, 0
  s_and_b32 s54, s54, 15
  s_lshl_b32 s54, s54, 14
  s_add_u32 s54, s54, s10
  buffer_load_dwordx4 v[180:183], v1, s[16:19], s54 offen sc1
  v_cvt_pk_bf16_f32 v32, v76, v77
  v_exp_f32 v80, v80
  v_exp_f32 v81, v81
  v_cvt_pk_bf16_f32 v33, v78, v79
  v_exp_f32 v82, v82
  v_exp_f32 v83, v83
  v_cvt_pk_bf16_f32 v34, v80, v81
  v_cvt_pk_bf16_f32 v35, v82, v83
  s_waitcnt lgkmcnt(2)
  v_mfma_f32_32x32x16_bf16 v[68:83], v[16:19], v[12:15], v[36:51]
  ds_read_b128 v[16:19], v3 offset:49152
  s_lshl_b32 s54, s45, 2
  s_add_u32 s54, s54, 1
  s_and_b32 s54, s54, 15
  s_lshl_b32 s54, s54, 14
  s_add_u32 s54, s54, s10
  buffer_load_dwordx4 v[184:187], v1, s[16:19], s54 offen sc1
  v_exp_f32 v52, v52
  v_exp_f32 v53, v53
  v_exp_f32 v54, v54
  v_exp_f32 v55, v55
  s_waitcnt vmcnt(12)
  v_mfma_f32_32x32x16_bf16 v[100:115], v[200:203], v[196:199], v[100:115]
  v_cvt_pk_bf16_f32 v28, v52, v53
  v_exp_f32 v56, v56
  v_exp_f32 v57, v57
  v_cvt_pk_bf16_f32 v29, v54, v55
  s_waitcnt lgkmcnt(2)
  v_mfma_f32_32x32x16_bf16 v[84:99], v[24:27], v[32:35], v[84:99]
  v_exp_f32 v58, v58
  v_exp_f32 v59, v59
  v_cvt_pk_bf16_f32 v30, v56, v57
  v_exp_f32 v60, v60
  v_exp_f32 v61, v61
  v_cvt_pk_bf16_f32 v31, v58, v59
  v_exp_f32 v62, v62
  v_exp_f32 v63, v63
  s_waitcnt lgkmcnt(1)
  v_mfma_f32_32x32x16_bf16 v[84:99], v[20:23], v[28:31], v[84:99]
  s_mov_b64 exec, s[94:95]
  ds_read_b128 v[24:27], v5 offset:45568
  ds_read_b128 v[20:23], v5 offset:47104
  s_mov_b64 exec, -1
  s_lshl_b32 s54, s45, 2
  s_add_u32 s54, s54, 2
  s_and_b32 s54, s54, 15
  s_lshl_b32 s54, s54, 14
  s_add_u32 s54, s54, s10
  buffer_load_dwordx4 v[188:191], v1, s[16:19], s54 offen sc1
  v_cvt_pk_bf16_f32 v32, v60, v61
  v_exp_f32 v64, v64
  v_exp_f32 v65, v65
  v_cvt_pk_bf16_f32 v33, v62, v63
  s_waitcnt vmcnt(12)
  v_mfma_f32_32x32x16_bf16 v[116:131], v[204:207], v[196:199], v[116:131]
  v_exp_f32 v66, v66
  v_exp_f32 v67, v67
  v_cvt_pk_bf16_f32 v34, v64, v65
  v_cvt_pk_bf16_f32 v35, v66, v67
  s_waitcnt lgkmcnt(2)
  v_mfma_f32_32x32x16_bf16 v[52:67], v[16:19], v[12:15], v[36:51]
  ds_read_b128 v[16:19], v3 offset:51200
  s_lshl_b32 s54, s45, 2
  s_add_u32 s54, s54, 3
  s_and_b32 s54, s54, 15
  s_lshl_b32 s54, s54, 14
  s_add_u32 s54, s54, s10
  buffer_load_dwordx4 v[192:195], v1, s[16:19], s54 offen sc1
  v_exp_f32 v68, v68
  v_exp_f32 v69, v69
  v_exp_f32 v70, v70
  v_exp_f32 v71, v71
  v_cvt_pk_bf16_f32 v28, v68, v69
  v_exp_f32 v72, v72
  v_exp_f32 v73, v73
  v_cvt_pk_bf16_f32 v29, v70, v71
  s_waitcnt lgkmcnt(2)
  v_mfma_f32_32x32x16_bf16 v[84:99], v[24:27], v[32:35], v[84:99]
  v_exp_f32 v74, v74
  v_exp_f32 v75, v75
  v_cvt_pk_bf16_f32 v30, v72, v73
  v_exp_f32 v76, v76
  v_exp_f32 v77, v77
  v_cvt_pk_bf16_f32 v31, v74, v75
  v_exp_f32 v78, v78
  v_exp_f32 v79, v79
  s_waitcnt lgkmcnt(1)
  v_mfma_f32_32x32x16_bf16 v[84:99], v[20:23], v[28:31], v[84:99]
  s_mov_b64 exec, s[94:95]
  ds_read_b128 v[24:27], v5 offset:47616
  ds_read_b128 v[20:23], v5 offset:49152
  s_mov_b64 exec, -1
  s_lshl_b32 s54, s45, 2
  s_add_u32 s54, s54, 4
  s_and_b32 s54, s54, 15
  s_lshl_b32 s54, s54, 14
  s_add_u32 s54, s54, s10
  buffer_load_dwordx4 v[196:199], v1, s[16:19], s54 offen sc1
  v_cvt_pk_bf16_f32 v32, v76, v77
  v_exp_f32 v80, v80
  v_exp_f32 v81, v81
  v_cvt_pk_bf16_f32 v33, v78, v79
  s_waitcnt vmcnt(12)
  v_mfma_f32_32x32x16_bf16 v[100:115], v[212:215], v[208:211], v[100:115]
  v_exp_f32 v82, v82
  v_exp_f32 v83, v83
  v_cvt_pk_bf16_f32 v34, v80, v81
  v_cvt_pk_bf16_f32 v35, v82, v83
  s_waitcnt lgkmcnt(2)
  v_mfma_f32_32x32x16_bf16 v[68:83], v[16:19], v[12:15], v[36:51]
  ds_read_b128 v[16:19], v3 offset:53248
  s_lshl_b32 s54, s45, 2
  s_add_u32 s54, s54, 5
  s_and_b32 s54, s54, 15
  s_lshl_b32 s54, s54, 14
  s_add_u32 s54, s54, s10
  buffer_load_dwordx4 v[200:203], v1, s[16:19], s54 offen sc1
  v_exp_f32 v52, v52
  v_exp_f32 v53, v53
  v_exp_f32 v54, v54
  v_exp_f32 v55, v55
  s_waitcnt vmcnt(12)
  v_mfma_f32_32x32x16_bf16 v[116:131], v[216:219], v[208:211], v[116:131]
  v_cvt_pk_bf16_f32 v28, v52, v53
  v_exp_f32 v56, v56
  v_exp_f32 v57, v57
  v_cvt_pk_bf16_f32 v29, v54, v55
  s_waitcnt lgkmcnt(2)
  v_mfma_f32_32x32x16_bf16 v[84:99], v[24:27], v[32:35], v[84:99]
  v_exp_f32 v58, v58
  v_exp_f32 v59, v59
  v_cvt_pk_bf16_f32 v30, v56, v57
  v_exp_f32 v60, v60
  v_exp_f32 v61, v61
  v_cvt_pk_bf16_f32 v31, v58, v59
  v_exp_f32 v62, v62
  v_exp_f32 v63, v63
  s_waitcnt lgkmcnt(1)
  v_mfma_f32_32x32x16_bf16 v[84:99], v[20:23], v[28:31], v[84:99]
  s_mov_b64 exec, s[94:95]
  ds_read_b128 v[24:27], v5 offset:49664
  ds_read_b128 v[20:23], v5 offset:51200
  s_mov_b64 exec, -1
  s_lshl_b32 s54, s45, 2
  s_add_u32 s54, s54, 6
  s_and_b32 s54, s54, 15
  s_lshl_b32 s54, s54, 14
  s_add_u32 s54, s54, s10
  buffer_load_dwordx4 v[204:207], v1, s[16:19], s54 offen sc1
  s_lshl_b32 s54, s45, 2
  s_add_u32 s54, s54, 7
  s_and_b32 s54, s54, 15
  s_lshl_b32 s54, s54, 14
  s_add_u32 s54, s54, s10
  buffer_load_dwordx4 v[208:211], v1, s[16:19], s54 offen sc1
  v_cvt_pk_bf16_f32 v32, v60, v61
  v_exp_f32 v64, v64
  v_exp_f32 v65, v65
  v_cvt_pk_bf16_f32 v33, v62, v63
  v_exp_f32 v66, v66
  v_exp_f32 v67, v67
  v_cvt_pk_bf16_f32 v34, v64, v65
  v_cvt_pk_bf16_f32 v35, v66, v67
  s_waitcnt lgkmcnt(2)
  v_mfma_f32_32x32x16_bf16 v[52:67], v[16:19], v[12:15], v[36:51]
  ds_read_b128 v[16:19], v3 offset:55296
  s_lshl_b32 s54, s45, 2
  s_add_u32 s54, s54, 8
  s_and_b32 s54, s54, 15
  s_lshl_b32 s54, s54, 14
  s_add_u32 s54, s54, s10
  buffer_load_dwordx4 v[212:215], v1, s[16:19], s54 offen sc1
  v_exp_f32 v68, v68
  v_exp_f32 v69, v69
  v_exp_f32 v70, v70
  v_exp_f32 v71, v71
  s_waitcnt vmcnt(13)
  v_mfma_f32_32x32x16_bf16 v[100:115], v[224:227], v[220:223], v[100:115]
  v_cvt_pk_bf16_f32 v28, v68, v69
  v_exp_f32 v72, v72
  v_exp_f32 v73, v73
  v_cvt_pk_bf16_f32 v29, v70, v71
  s_waitcnt lgkmcnt(2)
  v_mfma_f32_32x32x16_bf16 v[84:99], v[24:27], v[32:35], v[84:99]
  v_exp_f32 v74, v74
  v_exp_f32 v75, v75
  v_cvt_pk_bf16_f32 v30, v72, v73
  v_exp_f32 v76, v76
  v_exp_f32 v77, v77
  v_cvt_pk_bf16_f32 v31, v74, v75
  v_exp_f32 v78, v78
  v_exp_f32 v79, v79
  s_waitcnt lgkmcnt(1)
  v_mfma_f32_32x32x16_bf16 v[84:99], v[20:23], v[28:31], v[84:99]
  s_mov_b64 exec, s[94:95]
  ds_read_b128 v[24:27], v5 offset:51712
  ds_read_b128 v[20:23], v5 offset:53248
  s_mov_b64 exec, -1
  s_lshl_b32 s54, s45, 2
  s_add_u32 s54, s54, 9
  s_and_b32 s54, s54, 15
  s_lshl_b32 s54, s54, 14
  s_add_u32 s54, s54, s10
  buffer_load_dwordx4 v[216:219], v1, s[16:19], s54 offen sc1
  v_cvt_pk_bf16_f32 v32, v76, v77
  v_exp_f32 v80, v80
  v_exp_f32 v81, v81
  v_cvt_pk_bf16_f32 v33, v78, v79
  s_waitcnt vmcnt(13)
  v_mfma_f32_32x32x16_bf16 v[116:131], v[164:167], v[220:223], v[116:131]
  v_exp_f32 v82, v82
  v_exp_f32 v83, v83
  v_cvt_pk_bf16_f32 v34, v80, v81
  v_cvt_pk_bf16_f32 v35, v82, v83
  s_waitcnt lgkmcnt(2)
  v_mfma_f32_32x32x16_bf16 v[68:83], v[16:19], v[12:15], v[36:51]
  ds_read_b128 v[16:19], v3 offset:57344
  s_lshl_b32 s54, s45, 2
  s_add_u32 s54, s54, 10
  s_and_b32 s54, s54, 15
  s_lshl_b32 s54, s54, 14
  s_add_u32 s54, s54, s10
  buffer_load_dwordx4 v[220:223], v1, s[16:19], s54 offen sc1
  v_exp_f32 v52, v52
  v_exp_f32 v53, v53
  v_exp_f32 v54, v54
  v_exp_f32 v55, v55
  s_waitcnt vmcnt(12)
  v_mfma_f32_32x32x16_bf16 v[100:115], v[172:175], v[168:171], v[100:115]
  v_cvt_pk_bf16_f32 v28, v52, v53
  v_exp_f32 v56, v56
  v_exp_f32 v57, v57
  v_cvt_pk_bf16_f32 v29, v54, v55
  s_waitcnt lgkmcnt(2)
  v_mfma_f32_32x32x16_bf16 v[84:99], v[24:27], v[32:35], v[84:99]
  v_exp_f32 v58, v58
  v_exp_f32 v59, v59
  v_cvt_pk_bf16_f32 v30, v56, v57
  v_exp_f32 v60, v60
  v_exp_f32 v61, v61
  v_cvt_pk_bf16_f32 v31, v58, v59
  v_exp_f32 v62, v62
  v_exp_f32 v63, v63
  s_waitcnt lgkmcnt(1)
  v_mfma_f32_32x32x16_bf16 v[84:99], v[20:23], v[28:31], v[84:99]
  s_mov_b64 exec, s[94:95]
  ds_read_b128 v[24:27], v5 offset:53760
  ds_read_b128 v[20:23], v5 offset:55296
  s_mov_b64 exec, -1
  s_lshl_b32 s54, s45, 2
  s_add_u32 s54, s54, 11
  s_and_b32 s54, s54, 15
  s_lshl_b32 s54, s54, 14
  s_add_u32 s54, s54, s10
  buffer_load_dwordx4 v[224:227], v1, s[16:19], s54 offen sc1
  v_cvt_pk_bf16_f32 v32, v60, v61
  v_exp_f32 v64, v64
  v_exp_f32 v65, v65
  v_cvt_pk_bf16_f32 v33, v62, v63
  s_waitcnt vmcnt(12)
  v_mfma_f32_32x32x16_bf16 v[116:131], v[176:179], v[168:171], v[116:131]
  v_exp_f32 v66, v66
  v_exp_f32 v67, v67
  v_cvt_pk_bf16_f32 v34, v64, v65
  v_cvt_pk_bf16_f32 v35, v66, v67
  s_waitcnt lgkmcnt(2)
  v_mfma_f32_32x32x16_bf16 v[52:67], v[16:19], v[12:15], v[36:51]
  ds_read_b128 v[16:19], v3 offset:59392
  s_lshl_b32 s54, s45, 2
  s_add_u32 s54, s54, 12
  s_and_b32 s54, s54, 15
  s_lshl_b32 s54, s54, 14
  s_add_u32 s54, s54, s10
  buffer_load_dwordx4 v[164:167], v1, s[16:19], s54 offen sc1
  v_exp_f32 v68, v68
  v_exp_f32 v69, v69
  v_exp_f32 v70, v70
  v_exp_f32 v71, v71
  v_cvt_pk_bf16_f32 v28, v68, v69
  v_exp_f32 v72, v72
  v_exp_f32 v73, v73
  v_cvt_pk_bf16_f32 v29, v70, v71
  s_waitcnt lgkmcnt(2)
  v_mfma_f32_32x32x16_bf16 v[84:99], v[24:27], v[32:35], v[84:99]
  v_exp_f32 v74, v74
  v_exp_f32 v75, v75
  v_cvt_pk_bf16_f32 v30, v72, v73
  v_exp_f32 v76, v76
  v_exp_f32 v77, v77
  v_cvt_pk_bf16_f32 v31, v74, v75
  v_exp_f32 v78, v78
  v_exp_f32 v79, v79
  s_waitcnt lgkmcnt(1)
  v_mfma_f32_32x32x16_bf16 v[84:99], v[20:23], v[28:31], v[84:99]
  s_mov_b64 exec, s[94:95]
  ds_read_b128 v[24:27], v5 offset:55808
  ds_read_b128 v[20:23], v5 offset:57344
  s_mov_b64 exec, -1
  s_lshl_b32 s54, s45, 2
  s_add_u32 s54, s54, 13
  s_and_b32 s54, s54, 15
  s_lshl_b32 s54, s54, 14
  s_add_u32 s54, s54, s10
  buffer_load_dwordx4 v[168:171], v1, s[16:19], s54 offen sc1
  v_cvt_pk_bf16_f32 v32, v76, v77
  v_exp_f32 v80, v80
  v_exp_f32 v81, v81
  v_cvt_pk_bf16_f32 v33, v78, v79
  v_exp_f32 v82, v82
  v_exp_f32 v83, v83
  v_cvt_pk_bf16_f32 v34, v80, v81
  v_cvt_pk_bf16_f32 v35, v82, v83
  s_waitcnt lgkmcnt(2)
  v_mfma_f32_32x32x16_bf16 v[68:83], v[16:19], v[12:15], v[36:51]
  ds_read_b128 v[16:19], v3 offset:61440
  s_lshl_b32 s54, s45, 2
  s_add_u32 s54, s54, 14
  s_and_b32 s54, s54, 15
  s_lshl_b32 s54, s54, 14
  s_add_u32 s54, s54, s10
  buffer_load_dwordx4 v[172:175], v1, s[16:19], s54 offen sc1
  v_exp_f32 v52, v52
  v_exp_f32 v53, v53
  v_exp_f32 v54, v54
  v_exp_f32 v55, v55
  v_cvt_pk_bf16_f32 v28, v52, v53
  v_exp_f32 v56, v56
  v_exp_f32 v57, v57
  v_cvt_pk_bf16_f32 v29, v54, v55
  s_waitcnt lgkmcnt(2)
  v_mfma_f32_32x32x16_bf16 v[84:99], v[24:27], v[32:35], v[84:99]
  v_exp_f32 v58, v58
  v_exp_f32 v59, v59
  v_cvt_pk_bf16_f32 v30, v56, v57
  v_exp_f32 v60, v60
  v_exp_f32 v61, v61
  v_cvt_pk_bf16_f32 v31, v58, v59
  v_exp_f32 v62, v62
  v_exp_f32 v63, v63
  s_waitcnt lgkmcnt(1)
  v_mfma_f32_32x32x16_bf16 v[84:99], v[20:23], v[28:31], v[84:99]
  s_mov_b64 exec, s[94:95]
  ds_read_b128 v[24:27], v5 offset:57856
  ds_read_b128 v[20:23], v5 offset:59392
  s_mov_b64 exec, -1
  s_lshl_b32 s54, s45, 2
  s_add_u32 s54, s54, 15
  s_and_b32 s54, s54, 15
  s_lshl_b32 s54, s54, 14
  s_add_u32 s54, s54, s10
  buffer_load_dwordx4 v[176:179], v1, s[16:19], s54 offen sc1
  v_cvt_pk_bf16_f32 v32, v60, v61
  v_exp_f32 v64, v64
  v_exp_f32 v65, v65
  v_cvt_pk_bf16_f32 v33, v62, v63
  v_exp_f32 v66, v66
  v_exp_f32 v67, v67
  v_cvt_pk_bf16_f32 v34, v64, v65
  v_cvt_pk_bf16_f32 v35, v66, v67
  s_waitcnt lgkmcnt(2)
  v_mfma_f32_32x32x16_bf16 v[52:67], v[16:19], v[12:15], v[36:51]
  ds_read_b128 v[16:19], v3 offset:63488
  s_lshl_b32 s52, s25, 8
  s_lshl_b32 s53, s45, 6
  s_add_u32 s52, s52, s53
  s_lshl_b32 s53, s46, 5
  s_add_u32 s52, s52, s53
  v_lshrrev_b32 v6, 5, v0
  v_lshlrev_b32 v6, 3, v6
  v_add_u32 v6, s52, v6
  v_and_b32 v7, 31, v0
  v_lshlrev_b32 v7, 10, v7
  s_lshl_b32 s53, s24, 15
  v_add3_u32 v7, v7, v6, s53
  buffer_load_dwordx2 v[232:233], v6, s[32:35], 0 offen
  buffer_load_dwordx2 v[234:235], v6, s[32:35], 0 offen offset:16
  buffer_load_dwordx2 v[228:229], v7, s[4:7], 0 offen
  buffer_load_dwordx2 v[230:231], v7, s[4:7], 0 offen offset:16
  v_lshrrev_b32 v8, 5, v0
  v_lshlrev_b32 v8, 4, v8
  v_and_b32 v236, 31, v0
  v_lshlrev_b32 v236, 10, v236
  s_add_u32 s52, s52, s53
  v_add3_u32 v236, v236, v8, s52
  v_exp_f32 v68, v68
  v_exp_f32 v69, v69
  v_exp_f32 v70, v70
  v_exp_f32 v71, v71
  v_cvt_pk_bf16_f32 v28, v68, v69
  v_exp_f32 v72, v72
  v_exp_f32 v73, v73
  v_cvt_pk_bf16_f32 v29, v70, v71
  s_waitcnt lgkmcnt(2)
  v_mfma_f32_32x32x16_bf16 v[84:99], v[24:27], v[32:35], v[84:99]
  v_exp_f32 v74, v74
  v_exp_f32 v75, v75
  v_cvt_pk_bf16_f32 v30, v72, v73
  v_exp_f32 v76, v76
  v_exp_f32 v77, v77
  v_cvt_pk_bf16_f32 v31, v74, v75
  v_exp_f32 v78, v78
  v_exp_f32 v79, v79
  s_waitcnt lgkmcnt(1)
  v_mfma_f32_32x32x16_bf16 v[84:99], v[20:23], v[28:31], v[84:99]
  s_mov_b64 exec, s[94:95]
  ds_read_b128 v[24:27], v5 offset:59904
  ds_read_b128 v[20:23], v5 offset:61440
  s_mov_b64 exec, -1
  v_cvt_pk_bf16_f32 v32, v76, v77
  v_exp_f32 v80, v80
  v_exp_f32 v81, v81
  v_cvt_pk_bf16_f32 v33, v78, v79
  v_exp_f32 v82, v82
  v_exp_f32 v83, v83
  v_cvt_pk_bf16_f32 v34, v80, v81
  v_cvt_pk_bf16_f32 v35, v82, v83
  s_waitcnt lgkmcnt(2)
  v_mfma_f32_32x32x16_bf16 v[68:83], v[16:19], v[12:15], v[36:51]
  v_exp_f32 v52, v52
  v_exp_f32 v53, v53
  v_exp_f32 v54, v54
  v_exp_f32 v55, v55
  v_cvt_pk_bf16_f32 v28, v52, v53
  v_exp_f32 v56, v56
  v_exp_f32 v57, v57
  v_cvt_pk_bf16_f32 v29, v54, v55
  s_waitcnt lgkmcnt(1)
  v_mfma_f32_32x32x16_bf16 v[84:99], v[24:27], v[32:35], v[84:99]
  v_exp_f32 v58, v58
  v_exp_f32 v59, v59
  v_cvt_pk_bf16_f32 v30, v56, v57
  v_exp_f32 v60, v60
  v_exp_f32 v61, v61
  v_cvt_pk_bf16_f32 v31, v58, v59
  v_exp_f32 v62, v62
  v_exp_f32 v63, v63
  s_waitcnt lgkmcnt(0)
  v_mfma_f32_32x32x16_bf16 v[84:99], v[20:23], v[28:31], v[84:99]
  s_mov_b64 exec, s[94:95]
  ds_read_b128 v[24:27], v5 offset:61952
  ds_read_b128 v[20:23], v5 offset:63488
  s_mov_b64 exec, -1
  v_cvt_pk_bf16_f32 v32, v60, v61
  v_exp_f32 v64, v64
  v_exp_f32 v65, v65
  v_cvt_pk_bf16_f32 v33, v62, v63
  v_exp_f32 v66, v66
  v_exp_f32 v67, v67
  v_cvt_pk_bf16_f32 v34, v64, v65
  v_cvt_pk_bf16_f32 v35, v66, v67
  v_exp_f32 v68, v68
  v_exp_f32 v69, v69
  v_exp_f32 v70, v70
  v_exp_f32 v71, v71
  v_cvt_pk_bf16_f32 v28, v68, v69
  v_exp_f32 v72, v72
  v_exp_f32 v73, v73
  v_cvt_pk_bf16_f32 v29, v70, v71
  s_waitcnt lgkmcnt(1)
  v_mfma_f32_32x32x16_bf16 v[84:99], v[24:27], v[32:35], v[84:99]
  v_exp_f32 v74, v74
  v_exp_f32 v75, v75
  v_cvt_pk_bf16_f32 v30, v72, v73
  v_exp_f32 v76, v76
  v_exp_f32 v77, v77
  v_cvt_pk_bf16_f32 v31, v74, v75
  v_exp_f32 v78, v78
  v_exp_f32 v79, v79
  s_waitcnt lgkmcnt(0)
  v_mfma_f32_32x32x16_bf16 v[84:99], v[20:23], v[28:31], v[84:99]
  s_mov_b64 exec, s[94:95]
  ds_read_b128 v[24:27], v5 offset:64000
  s_mov_b64 exec, -1
  v_cvt_pk_bf16_f32 v32, v76, v77
  v_exp_f32 v80, v80
  v_exp_f32 v81, v81
  v_cvt_pk_bf16_f32 v33, v78, v79
  v_exp_f32 v82, v82
  v_exp_f32 v83, v83
  v_cvt_pk_bf16_f32 v34, v80, v81
  v_cvt_pk_bf16_f32 v35, v82, v83
  s_setprio 0
s_nop 0
recurrent_scan__softmax_full_mha__mixer_channel_mlp__prompt_kernel_att:
  s_waitcnt lgkmcnt(0)
  v_mfma_f32_32x32x16_bf16 v[84:99], v[24:27], v[32:35], v[84:99]
s_nop 11
  v_mul_f32 v6, 0, v92
  v_fma_f32 v6, v84, 0, v6
  v_fma_f32 v6, v85, 0, v6
  v_fma_f32 v6, v86, 0, v6
  v_fma_f32 v6, v87, 0, v6
  v_fma_f32 v6, v88, 0, v6
  v_fma_f32 v6, v89, 0, v6
  v_fma_f32 v6, v90, 0, v6
  v_fma_f32 v6, v91, 0, v6
  v_cmp_u_f32 vcc, v6, v6
s_nop 3
s_cbranch_vccnz recurrent_scan__softmax_full_mha__mixer_channel_mlp__prompt_kernel_fb
recurrent_scan__softmax_full_mha__mixer_channel_mlp__prompt_kernel_fin:
  v_rcp_f32 v6, v92
s_nop 0
  v_mul_f32 v84, v6, v84
  v_mul_f32 v85, v6, v85
  v_mul_f32 v86, v6, v86
  v_mul_f32 v87, v6, v87
  v_mul_f32 v88, v6, v88
  v_mul_f32 v89, v6, v89
  v_mul_f32 v90, v6, v90
  v_mul_f32 v91, v6, v91
  v_cvt_pk_bf16_f32 v84, v84, v85
  v_cvt_pk_bf16_f32 v85, v86, v87
  v_cvt_pk_bf16_f32 v86, v88, v89
  v_cvt_pk_bf16_f32 v87, v90, v91
  v_min_u32 v84, -2, v84
  v_min_u32 v85, -2, v85
  v_min_u32 v86, -2, v86
  v_min_u32 v87, -2, v87
  buffer_store_dwordx4 v[84:87], v1, s[16:19], s26 offen sc1
  s_lshl_b32 s52, s45, 13
  s_lshl_b32 s53, s46, 17
  s_add_u32 s52, s52, s53
  v_add_u32 v6, s52, v1
  ds_write_b128 v6, v[100:103] offset:0
  ds_write_b128 v6, v[104:107] offset:1024
  ds_write_b128 v6, v[108:111] offset:2048
  ds_write_b128 v6, v[112:115] offset:3072
  ds_write_b128 v6, v[116:119] offset:4096
  ds_write_b128 v6, v[120:123] offset:5120
  ds_write_b128 v6, v[124:127] offset:6144
  ds_write_b128 v6, v[128:131] offset:7168
  s_waitcnt lgkmcnt(0)
  s_barrier
  s_lshr_b32 s52, s45, 1
  s_lshl_b32 s52, s52, 17
  s_and_b32 s53, s45, 1
  s_lshl_b32 s53, s53, 12
  s_add_u32 s52, s52, s53
  s_lshl_b32 s53, s46, 11
  s_add_u32 s52, s52, s53
  v_add_u32 v6, s52, v1
  ds_read_b128 v[100:103], v6 offset:0
  ds_read_b128 v[104:107], v6 offset:1024
  ds_read_b128 v[108:111], v6 offset:8192
  ds_read_b128 v[112:115], v6 offset:9216
  ds_read_b128 v[116:119], v6 offset:16384
  ds_read_b128 v[120:123], v6 offset:17408
  ds_read_b128 v[124:127], v6 offset:24576
  ds_read_b128 v[128:131], v6 offset:25600
  s_waitcnt vmcnt(1)
  buffer_load_dwordx4 v[52:55], v1, s[16:19], s27 offen offset:0 sc1
  buffer_load_dwordx4 v[56:59], v1, s[16:19], s27 offen offset:1024 sc1
  buffer_load_dwordx4 v[60:63], v1, s[16:19], s27 offen offset:2048 sc1
  buffer_load_dwordx4 v[64:67], v1, s[16:19], s27 offen offset:3072 sc1
  v_lshlrev_b32 v240, 16, v232
  v_and_b32 v241, 0xffff0000, v232
  v_lshlrev_b32 v242, 16, v233
  v_and_b32 v243, 0xffff0000, v233
  v_lshlrev_b32 v244, 16, v234
  v_and_b32 v245, 0xffff0000, v234
  v_lshlrev_b32 v246, 16, v235
  v_and_b32 v247, 0xffff0000, v235
  s_waitcnt lgkmcnt(6)
  v_add_f32 v240, v240, v100
  v_add_f32 v241, v241, v101
  v_add_f32 v242, v242, v102
  v_add_f32 v243, v243, v103
  v_add_f32 v244, v244, v104
  v_add_f32 v245, v245, v105
  v_add_f32 v246, v246, v106
  v_add_f32 v247, v247, v107
  s_waitcnt lgkmcnt(4)
  v_add_f32 v240, v240, v108
  v_add_f32 v241, v241, v109
  v_add_f32 v242, v242, v110
  v_add_f32 v243, v243, v111
  v_add_f32 v244, v244, v112
  v_add_f32 v245, v245, v113
  v_add_f32 v246, v246, v114
  v_add_f32 v247, v247, v115
  s_waitcnt lgkmcnt(2)
  v_add_f32 v240, v240, v116
  v_add_f32 v241, v241, v117
  v_add_f32 v242, v242, v118
  v_add_f32 v243, v243, v119
  v_add_f32 v244, v244, v120
  v_add_f32 v245, v245, v121
  v_add_f32 v246, v246, v122
  v_add_f32 v247, v247, v123
  s_waitcnt lgkmcnt(0)
  v_add_f32 v240, v240, v124
  v_add_f32 v241, v241, v125
  v_add_f32 v242, v242, v126
  v_add_f32 v243, v243, v127
  v_add_f32 v244, v244, v128
  v_add_f32 v245, v245, v129
  v_add_f32 v246, v246, v130
  v_add_f32 v247, v247, v131
  v_mul_f32 v100, 0xbfb8aa3b, v240
  v_mul_f32 v101, 0xbfb8aa3b, v241
  v_mul_f32 v102, 0xbfb8aa3b, v242
  v_mul_f32 v103, 0xbfb8aa3b, v243
  v_mul_f32 v104, 0xbfb8aa3b, v244
  v_mul_f32 v105, 0xbfb8aa3b, v245
  v_mul_f32 v106, 0xbfb8aa3b, v246
  v_mul_f32 v107, 0xbfb8aa3b, v247
  v_exp_f32 v100, v100
  v_exp_f32 v101, v101
  v_exp_f32 v102, v102
  v_exp_f32 v103, v103
  v_exp_f32 v104, v104
  v_exp_f32 v105, v105
  v_exp_f32 v106, v106
  v_exp_f32 v107, v107
  v_add_f32 v100, 1.0, v100
  v_add_f32 v101, 1.0, v101
  v_add_f32 v102, 1.0, v102
  v_add_f32 v103, 1.0, v103
  v_add_f32 v104, 1.0, v104
  v_add_f32 v105, 1.0, v105
  v_add_f32 v106, 1.0, v106
  v_add_f32 v107, 1.0, v107
  v_rcp_f32 v100, v100
  v_rcp_f32 v101, v101
  v_rcp_f32 v102, v102
  v_rcp_f32 v103, v103
  v_rcp_f32 v104, v104
  v_rcp_f32 v105, v105
  v_rcp_f32 v106, v106
  v_rcp_f32 v107, v107
  v_mul_f32 v240, v240, v100
  v_mul_f32 v241, v241, v101
  v_mul_f32 v242, v242, v102
  v_mul_f32 v243, v243, v103
  v_mul_f32 v244, v244, v104
  v_mul_f32 v245, v245, v105
  v_mul_f32 v246, v246, v106
  v_mul_f32 v247, v247, v107
  s_waitcnt vmcnt(0)
  v_max3_u32 v6, v52, v53, v54
  v_max_u32 v6, v6, v55
  v_max3_u32 v7, v56, v57, v58
  v_max_u32 v7, v7, v59
  v_max3_u32 v8, v60, v61, v62
  v_max_u32 v8, v8, v63
  v_max3_u32 v9, v64, v65, v66
  v_max_u32 v9, v9, v67
  v_max3_u32 v6, v6, v7, v8
  v_max_u32 v6, v6, v9
  v_cmp_eq_u32 vcc, -1, v6
s_nop 3
s_cbranch_vccz ok_24
  s_mov_b32 s11, 20000
spin_25:
  s_sleep 1
  buffer_load_dwordx4 v[52:55], v1, s[16:19], s27 offen offset:0 sc1
  buffer_load_dwordx4 v[56:59], v1, s[16:19], s27 offen offset:1024 sc1
  buffer_load_dwordx4 v[60:63], v1, s[16:19], s27 offen offset:2048 sc1
  buffer_load_dwordx4 v[64:67], v1, s[16:19], s27 offen offset:3072 sc1
  s_waitcnt vmcnt(0)
  v_max3_u32 v6, v52, v53, v54
  v_max_u32 v6, v6, v55
  v_max3_u32 v7, v56, v57, v58
  v_max_u32 v7, v7, v59
  v_max3_u32 v8, v60, v61, v62
  v_max_u32 v8, v8, v63
  v_max3_u32 v9, v64, v65, v66
  v_max_u32 v9, v9, v67
  v_max3_u32 v6, v6, v7, v8
  v_max_u32 v6, v6, v9
  v_cmp_eq_u32 vcc, -1, v6
s_nop 3
s_cbranch_vccz ok_24
  s_sub_u32 s11, s11, 1
  s_cmp_lg_u32 s11, 0
s_cbranch_scc1 spin_25
  v_mov_b32 v6, 4
  buffer_store_dword v6, off, s[40:43], 0 offset:16
s_nop 0
ok_24:
  s_lshl_b32 s52, s44, 12
  s_add_u32 s52, s52, 32768
  v_add_u32 v6, s52, v1
  ds_write_b128 v6, v[52:55] offset:0
  ds_write_b128 v6, v[56:59] offset:1024
  ds_write_b128 v6, v[60:63] offset:2048
  ds_write_b128 v6, v[64:67] offset:3072
  s_add_u32 s52, s45, 1
  s_and_b32 s52, s52, 3
  s_lshl_b32 s52, s52, 12
  s_lshl_b32 s53, s46, 14
  s_add_u32 s52, s52, s53
  s_add_u32 s52, s52, 32768
  v_add_u32 v7, s52, v1
  s_add_u32 s52, s45, 2
  s_and_b32 s52, s52, 3
  s_lshl_b32 s52, s52, 12
  s_lshl_b32 s53, s46, 14
  s_add_u32 s52, s52, s53
  s_add_u32 s52, s52, 32768
  v_add_u32 v8, s52, v1
  s_add_u32 s52, s45, 3
  s_and_b32 s52, s52, 3
  s_lshl_b32 s52, s52, 12
  s_lshl_b32 s53, s46, 14
  s_add_u32 s52, s52, s53
  s_add_u32 s52, s52, 32768
  v_add_u32 v9, s52, v1
  v_mfma_f32_32x32x16_bf16 v[84:99], v[180:183], v[52:55], 0
  v_mfma_f32_32x32x16_bf16 v[84:99], v[184:187], v[56:59], v[84:99]
  v_mfma_f32_32x32x16_bf16 v[84:99], v[188:191], v[60:63], v[84:99]
  v_mfma_f32_32x32x16_bf16 v[84:99], v[192:195], v[64:67], v[84:99]
  s_waitcnt lgkmcnt(0)
  s_barrier
  ds_read_b128 v[116:119], v7 offset:0
  ds_read_b128 v[120:123], v7 offset:1024
  ds_read_b128 v[124:127], v7 offset:2048
  ds_read_b128 v[128:131], v7 offset:3072
  ds_read_b128 v[132:135], v8 offset:0
  ds_read_b128 v[136:139], v8 offset:1024
  ds_read_b128 v[140:143], v8 offset:2048
  ds_read_b128 v[144:147], v8 offset:3072
  ds_read_b128 v[148:151], v9 offset:0
  ds_read_b128 v[152:155], v9 offset:1024
  ds_read_b128 v[156:159], v9 offset:2048
  ds_read_b128 v[160:163], v9 offset:3072
  s_waitcnt lgkmcnt(11)
  v_mfma_f32_32x32x16_bf16 v[84:99], v[196:199], v[116:119], v[84:99]
  s_waitcnt lgkmcnt(10)
  v_mfma_f32_32x32x16_bf16 v[84:99], v[200:203], v[120:123], v[84:99]
  s_waitcnt lgkmcnt(9)
  v_mfma_f32_32x32x16_bf16 v[84:99], v[204:207], v[124:127], v[84:99]
  s_waitcnt lgkmcnt(8)
  v_mfma_f32_32x32x16_bf16 v[84:99], v[208:211], v[128:131], v[84:99]
  s_waitcnt lgkmcnt(7)
  v_mfma_f32_32x32x16_bf16 v[84:99], v[212:215], v[132:135], v[84:99]
  s_waitcnt lgkmcnt(6)
  v_mfma_f32_32x32x16_bf16 v[84:99], v[216:219], v[136:139], v[84:99]
  s_waitcnt lgkmcnt(5)
  v_mfma_f32_32x32x16_bf16 v[84:99], v[220:223], v[140:143], v[84:99]
  s_waitcnt lgkmcnt(4)
  v_mfma_f32_32x32x16_bf16 v[84:99], v[224:227], v[144:147], v[84:99]
  s_waitcnt lgkmcnt(3)
  v_mfma_f32_32x32x16_bf16 v[84:99], v[164:167], v[148:151], v[84:99]
  s_waitcnt lgkmcnt(2)
  v_mfma_f32_32x32x16_bf16 v[84:99], v[168:171], v[152:155], v[84:99]
  s_waitcnt lgkmcnt(1)
  v_mfma_f32_32x32x16_bf16 v[84:99], v[172:175], v[156:159], v[84:99]
  s_waitcnt lgkmcnt(0)
  v_mfma_f32_32x32x16_bf16 v[84:99], v[176:179], v[160:163], v[84:99]
  s_waitcnt lgkmcnt(0)
  s_lshl_b32 s52, s44, 11
  v_add_u32 v6, s52, v1
  s_xor_b32 s52, s44, 4
  s_lshl_b32 s52, s52, 11
  v_add_u32 v7, s52, v1
  s_cmp_eq_u32 s46, 1
s_nop 3
s_cbranch_scc1 recurrent_scan__softmax_full_mha__mixer_channel_mlp__prompt_kernel_kh1
  ds_write_b128 v6, v[92:95]
  ds_write_b128 v6, v[96:99] offset:1024
  v_mov_b32 v248, v84
  v_mov_b32 v249, v85
  v_mov_b32 v250, v86
  v_mov_b32 v251, v87
  v_mov_b32 v252, v88
  v_mov_b32 v253, v89
  v_mov_b32 v254, v90
  v_mov_b32 v255, v91
s_nop 0
s_branch recurrent_scan__softmax_full_mha__mixer_channel_mlp__prompt_kernel_khj
recurrent_scan__softmax_full_mha__mixer_channel_mlp__prompt_kernel_kh1:
  ds_write_b128 v6, v[84:87]
  ds_write_b128 v6, v[88:91] offset:1024
  v_mov_b32 v248, v92
  v_mov_b32 v249, v93
  v_mov_b32 v250, v94
  v_mov_b32 v251, v95
  v_mov_b32 v252, v96
  v_mov_b32 v253, v97
  v_mov_b32 v254, v98
  v_mov_b32 v255, v99
s_nop 1
recurrent_scan__softmax_full_mha__mixer_channel_mlp__prompt_kernel_khj:
  s_waitcnt lgkmcnt(0)
  s_barrier
  ds_read_b128 v[100:103], v7
  ds_read_b128 v[104:107], v7 offset:1024
  v_lshlrev_b32 v132, 16, v228
  v_and_b32 v133, 0xffff0000, v228
  v_lshlrev_b32 v134, 16, v229
  v_and_b32 v135, 0xffff0000, v229
  v_lshlrev_b32 v136, 16, v230
  v_and_b32 v137, 0xffff0000, v230
  v_lshlrev_b32 v138, 16, v231
  v_and_b32 v139, 0xffff0000, v231
  s_waitcnt lgkmcnt(0)
  v_add_f32 v248, v248, v100
  v_add_f32 v249, v249, v101
  v_add_f32 v250, v250, v102
  v_add_f32 v251, v251, v103
  v_add_f32 v252, v252, v104
  v_add_f32 v253, v253, v105
  v_add_f32 v254, v254, v106
  v_add_f32 v255, v255, v107
  v_fma_f32 v248, v248, v240, v132
  v_fma_f32 v249, v249, v241, v133
  v_fma_f32 v250, v250, v242, v134
  v_fma_f32 v251, v251, v243, v135
  v_fma_f32 v252, v252, v244, v136
  v_fma_f32 v253, v253, v245, v137
  v_fma_f32 v254, v254, v246, v138
  v_fma_f32 v255, v255, v247, v139
  v_cvt_pk_bf16_f32 v248, v248, v249
  v_cvt_pk_bf16_f32 v249, v250, v251
  v_cvt_pk_bf16_f32 v250, v252, v253
  v_cvt_pk_bf16_f32 v251, v254, v255
s_nop 0
  v_permlane32_swap_b32 v248, v250
  v_permlane32_swap_b32 v249, v251
  buffer_store_dwordx4 v[248:251], v236, s[36:39], 0 offen
  s_waitcnt vmcnt(0)
  s_endpgm
recurrent_scan__softmax_full_mha__mixer_channel_mlp__prompt_kernel_fb:
  v_mov_b32 v6, 0xff800000
  v_mov_b32 v84, 0
  v_mov_b32 v85, 0
  v_mov_b32 v86, 0
  v_mov_b32 v87, 0
  v_mov_b32 v88, 0
  v_mov_b32 v89, 0
  v_mov_b32 v90, 0
  v_mov_b32 v91, 0
  v_mov_b32 v92, 0
  v_mov_b32 v93, 0
  v_mov_b32 v94, 0
  v_mov_b32 v95, 0
  v_mov_b32 v96, 0
  v_mov_b32 v97, 0
  v_mov_b32 v98, 0
  v_mov_b32 v99, 0
  v_mov_b32 v9, v2
  v_mov_b32 v10, v4
  s_mov_b32 s52, 64
s_nop 0
fb_loop_26:
  ds_read_b128 v[16:19], v9
  s_mov_b64 exec, s[94:95]
  ds_read_b128 v[20:23], v10
  ds_read_b128 v[24:27], v10 offset:512
  s_mov_b64 exec, -1
  s_waitcnt lgkmcnt(0)
  v_mfma_f32_32x32x16_bf16 v[52:67], v[16:19], v[12:15], 0
  v_add_u32 v9, 0x800, v9
  v_add_u32 v10, 0x800, v10
s_nop 9
  v_max3_f32 v7, v52, v53, v54
  v_max3_f32 v8, v55, v56, v57
  v_max3_f32 v7, v7, v58, v59
  v_max3_f32 v8, v8, v60, v61
  v_max3_f32 v7, v7, v62, v63
  v_max3_f32 v8, v8, v64, v65
  v_max3_f32 v7, v7, v66, v67
  v_max_f32 v7, v7, v8
  v_mov_b32 v8, v7
s_nop 1
  v_permlane32_swap_b32 v7, v8
  v_max_f32 v7, v7, v8
  v_max_f32 v7, v7, v6
  v_sub_f32 v8, v6, v7
  v_exp_f32 v8, v8
  v_mov_b32 v6, v7
  v_sub_f32 v52, v52, v7
  v_sub_f32 v53, v53, v7
  v_sub_f32 v54, v54, v7
  v_sub_f32 v55, v55, v7
  v_sub_f32 v56, v56, v7
  v_sub_f32 v57, v57, v7
  v_sub_f32 v58, v58, v7
  v_sub_f32 v59, v59, v7
  v_sub_f32 v60, v60, v7
  v_sub_f32 v61, v61, v7
  v_sub_f32 v62, v62, v7
  v_sub_f32 v63, v63, v7
  v_sub_f32 v64, v64, v7
  v_sub_f32 v65, v65, v7
  v_sub_f32 v66, v66, v7
  v_sub_f32 v67, v67, v7
  v_exp_f32 v52, v52
  v_exp_f32 v53, v53
  v_exp_f32 v54, v54
  v_exp_f32 v55, v55
  v_exp_f32 v56, v56
  v_exp_f32 v57, v57
  v_exp_f32 v58, v58
  v_exp_f32 v59, v59
  v_exp_f32 v60, v60
  v_exp_f32 v61, v61
  v_exp_f32 v62, v62
  v_exp_f32 v63, v63
  v_exp_f32 v64, v64
  v_exp_f32 v65, v65
  v_exp_f32 v66, v66
  v_exp_f32 v67, v67
  v_mul_f32 v84, v8, v84
  v_mul_f32 v85, v8, v85
  v_mul_f32 v86, v8, v86
  v_mul_f32 v87, v8, v87
  v_mul_f32 v88, v8, v88
  v_mul_f32 v89, v8, v89
  v_mul_f32 v90, v8, v90
  v_mul_f32 v91, v8, v91
  v_mul_f32 v92, v8, v92
  v_mul_f32 v93, v8, v93
  v_mul_f32 v94, v8, v94
  v_mul_f32 v95, v8, v95
  v_mul_f32 v96, v8, v96
  v_mul_f32 v97, v8, v97
  v_mul_f32 v98, v8, v98
  v_mul_f32 v99, v8, v99
  v_cvt_pk_bf16_f32 v28, v52, v53
  v_cvt_pk_bf16_f32 v29, v54, v55
  v_cvt_pk_bf16_f32 v30, v56, v57
  v_cvt_pk_bf16_f32 v31, v58, v59
  v_cvt_pk_bf16_f32 v32, v60, v61
  v_cvt_pk_bf16_f32 v33, v62, v63
  v_cvt_pk_bf16_f32 v34, v64, v65
  v_cvt_pk_bf16_f32 v35, v66, v67
  v_mfma_f32_32x32x16_bf16 v[84:99], v[20:23], v[28:31], v[84:99]
s_nop 0
  v_mfma_f32_32x32x16_bf16 v[84:99], v[24:27], v[32:35], v[84:99]
  s_sub_u32 s52, s52, 1
  s_cmp_lg_u32 s52, 0
s_nop 8
s_cbranch_scc1 fb_loop_26
s_branch recurrent_scan__softmax_full_mha__mixer_channel_mlp__prompt_kernel_fin
recurrent_scan__softmax_full_mha__mixer_channel_mlp__prompt_kernel_end:
  s_endpgm
.section .rodata,"a"
.p2align 6
.amdhsa_kernel recurrent_scan__softmax_full_mha__mixer_channel_mlp__prompt_kernel
  .amdhsa_next_free_vgpr 256
  .amdhsa_next_free_sgpr 102
  .amdhsa_accum_offset 256
  .amdhsa_group_segment_fixed_size 0
  .amdhsa_kernarg_size 88
  .amdhsa_user_sgpr_count 2
  .amdhsa_user_sgpr_kernarg_segment_ptr 1
  .amdhsa_system_sgpr_workgroup_id_x 1
.end_amdhsa_kernel
```
